```python
import torch

def _softmax(x, axis=-1):
    return torch.softmax(x, dim=axis)
def _gelu(x):
    return torch.nn.functional.gelu(x, approximate="tanh")
def _silu(x):
    return torch.nn.functional.silu(x)
def _sigmoid(x):
    return torch.sigmoid(x)
def _layernorm(x, axis=-1, eps=1e-5):
    m = x.mean(dim=axis, keepdim=True)
    v = x.var(dim=axis, keepdim=True, unbiased=False)
    return (x - m) / torch.sqrt(v + eps)
def _scatter_add(tgt, idx, src, axis=0):
    return tgt.clone().index_add_(axis, idx, src)
def _segment_sum(src, seg, n):
    out = torch.zeros((n,) + src.shape[1:], dtype=src.dtype)
    return out.index_add_(0, seg, src)
def _pad(x, pw):
    flat = tuple(v for pair in reversed(pw) for v in pair)
    return torch.nn.functional.pad(x, flat)

kernel_name = 'gated_mix__ssm_conv_s4__grouped_kv_mqa__prompt'

def setup_inputs():

    _w = (lambda a: (lambda t: t.to(torch.bfloat16) if t.is_floating_point() else t)(torch.as_tensor(a)))
    def _A_setup():
        B, L, D, N = 1, 2048, 640, 128
        A_re = -(lambda _x: torch.exp(torch.as_tensor(_x)))((lambda *s: torch.randn(*s, dtype=torch.bfloat16) * 3.2)(D, N))
        A_im = torch.pi * (lambda *s: torch.randn(*s, dtype=torch.bfloat16) * 0.05)(D, N)
        B_re = (lambda *s: torch.randn(*s, dtype=torch.bfloat16) * 0.1)(D, N)
        B_im = (lambda *s: torch.randn(*s, dtype=torch.bfloat16) * 0.1)(D, N)
        C_re = (lambda *s: torch.randn(*s, dtype=torch.bfloat16) * 0.1)(D, N)
        C_im = (lambda *s: torch.randn(*s, dtype=torch.bfloat16) * 0.1)(D, N)
        log_dt = (lambda *s: torch.randn(*s, dtype=torch.bfloat16) * 0.05)(D) * 0.5 - 4.0
        Dskip = (lambda *s: torch.randn(*s, dtype=torch.bfloat16) * 0.05)(D)
        return {
            "u": _w((lambda *s: torch.randn(*s, dtype=torch.bfloat16) * 0.05)(B, L, D)),
            "A_re": _w(A_re),
            "A_im": _w(A_im),
            "B_re": _w(B_re),
            "B_im": _w(B_im),
            "C_re": _w(C_re),
            "C_im": _w(C_im),
            "log_dt": _w(log_dt),
            "Dskip": _w(Dskip),
        }
    _A_in = _A_setup()

    def _B_setup():
        B, S, D, H = 1, 2048, 640, 32
        Dh = D // H
        return {
            "x": _w((lambda *s: torch.randn(*s, dtype=torch.bfloat16) * 0.05)(B, S, D)),
            "wq": _w((lambda *s: torch.randn(*s, dtype=torch.bfloat16) * 0.8)(D, H * Dh)),
            "wk": _w((lambda *s: torch.randn(*s, dtype=torch.bfloat16) * 0.8)(D, Dh)),
            "wv": _w((lambda *s: torch.randn(*s, dtype=torch.bfloat16) * 0.05)(D, Dh)),
            "wo": _w((lambda *s: torch.randn(*s, dtype=torch.bfloat16) * 0.05)(H * Dh, D)),
        }
    _B_in = _B_setup()

    return {
        "A_u": _A_in["u"],
        "A_A_re": _A_in["A_re"],
        "A_A_im": _A_in["A_im"],
        "A_B_re": _A_in["B_re"],
        "A_B_im": _A_in["B_im"],
        "A_C_re": _A_in["C_re"],
        "A_C_im": _A_in["C_im"],
        "A_log_dt": _A_in["log_dt"],
        "A_Dskip": _A_in["Dskip"],
        "B_x": _B_in["x"],
        "B_wq": _B_in["wq"],
        "B_wk": _B_in["wk"],
        "B_wv": _B_in["wv"],
        "B_wo": _B_in["wo"],
        "gate_w": _w((lambda *s: torch.randn(*s, dtype=torch.bfloat16) * 0.05)(640) * 16.0),
    }

def reference(A_u, A_A_re, A_A_im, A_B_re, A_B_im, A_C_re, A_C_im, A_log_dt, A_Dskip, B_x, B_wq, B_wk, B_wv, B_wo, gate_w):
    def _A_ref(u, A_re, A_im, B_re, B_im, C_re, C_im, log_dt, Dskip):
        Bsz, L, D = u.shape
        dt = torch.exp(log_dt)[:, None]
        A = A_re + 1j * A_im
        Bc = B_re + 1j * B_im
        Cc = C_re + 1j * C_im
        logdA = dt * A
        dB = dt * Bc
        l = (lambda x, dt: x.to(dt))(torch.arange(L), A_re.dtype)
        P = torch.exp(logdA[:, :, None] * l[None, None, :])
        K = torch.einsum("dn,dnl,dn->dl", Cc, P, dB).real
        L2 = 2 * L
        Kp = _pad(K, ((0, 0), (0, L)))
        up = (lambda x, *d: x.permute(*d))(u, 0, 2, 1)
        up = _pad(up, ((0, 0), (0, 0), (0, L)))
        Kf = (lambda x, axes=(-2,-1): torch.fft.rfft2(x.float(), dim=axes))(Kp[:, None, :], axes=(-2, -1))
        Uf = (lambda x, axes=(-2,-1): torch.fft.rfft2(x.float(), dim=axes))(up[:, :, None, :], axes=(-2, -1))
        Yf = Uf * Kf[None, :, :, :]
        y = (lambda x, s, axes=(-2,-1): torch.fft.irfft2(x, s=s, dim=axes).to(torch.bfloat16))(Yf, (1, L2), axes=(-2, -1))[:, :, 0, :L]
        y = (lambda x, *d: x.permute(*d))(y, 0, 2, 1) + u * Dskip[None, None, :]
        return y

    def _B_ref(x, wq, wk, wv, wo):
        B, S, D = x.shape
        H = 32
        Dh = D // H
        q = (lambda x, *d: x.permute(*d))((x @ wq).reshape(B, S, H, Dh), 0, 2, 1, 3)
        k = x @ wk
        v = x @ wv
        scores = torch.einsum("bhqd,bkd->bhqk", q, k) * (Dh ** -0.5)
        p = _softmax(scores, axis=-1)
        o = torch.einsum("bhqk,bkd->bhqd", p, v)
        return (lambda x, *d: x.permute(*d))(o, 0, 2, 1, 3).reshape(B, S, H * Dh) @ wo

    x = A_u
    g = _sigmoid((x * gate_w).sum(-1, keepdims=True))
    a = _A_ref(x, A_A_re, A_A_im, A_B_re, A_B_im, A_C_re, A_C_im, A_log_dt, A_Dskip)
    b = _B_ref(x, B_wq, B_wk, B_wv, B_wo)
    return g * a + (1 - g) * b
```

```asm
; @launch kernel=gated_mix__ssm_conv_s4__grouped_kv_mqa__prompt_kernel grid=(256,1,1) block=(1024,1,1) lds=163840
.amdgcn_target "amdgcn-amd-amdhsa--gfx950"
.text
.globl gated_mix__ssm_conv_s4__grouped_kv_mqa__prompt_kernel
.p2align 8
.type gated_mix__ssm_conv_s4__grouped_kv_mqa__prompt_kernel,@function
gated_mix__ssm_conv_s4__grouped_kv_mqa__prompt_kernel:
    s_cmp_ge_u32 s2, 256
    s_cbranch_scc1 gated_mix__ssm_conv_s4__grouped_kv_mqa__prompt_kernel_end
    s_add_u32 s2, s2, 160
    s_and_b32 s2, s2, 255
    v_lshrrev_b32 v2, 6, v0
    v_and_b32 v1, 63, v0
    v_readfirstlane_b32 s6, v2
    s_cmp_lt_u32 s2, 160
    s_cbranch_scc1 k1_ssm
    s_cmp_lt_u32 s2, 240
    s_cbranch_scc1 k1_q
    s_cmp_ge_u32 s6, 12
    s_cbranch_scc1 kv_idle
    s_load_dwordx2 s[32:33], s[0:1], 0
    s_load_dwordx4 s[36:39], s[0:1], 88
    s_load_dwordx2 s[4:5], s[0:1], 136
    s_sub_u32 s24, s2, 240
    s_lshl_b32 s24, s24, 7
    s_cmp_lt_u32 s6, 4
    s_cbranch_scc1 kv_comp
    s_sub_u32 s25, s6, 4
    v_lshrrev_b32 v2, 3, v1
    v_mul_u32_u24 v8, 1280, v2
    v_lshrrev_b32 v2, 4, v1
    v_and_b32 v3, 7, v1
    v_xor_b32 v2, v2, v3
    v_lshl_add_u32 v8, v2, 4, v8
    v_lshrrev_b32 v2, 3, v1
    v_add_u32 v2, 8, v2
    v_mul_u32_u24 v9, 1280, v2
    v_lshrrev_b32 v2, 4, v1
    v_add_u32 v2, 4, v2
    v_and_b32 v3, 7, v1
    v_xor_b32 v2, v2, v3
    v_lshl_add_u32 v9, v2, 4, v9
    v_lshlrev_b32 v10, 4, v1
    s_lshl_b32 s28, s25, 4
    s_add_u32 s28, s28, s24
    s_mul_i32 s26, s28, 1280
    s_lshl_b32 s27, s25, 11
    s_waitcnt lgkmcnt(0)
    s_mov_b32 s8, s32
    s_mov_b32 s9, s33
    s_mov_b32 s10, 0x280000
    s_mov_b32 s11, 0x00020000
    s_mov_b32 s12, s36
    s_mov_b32 s13, s37
    s_mov_b32 s14, 0x6400
    s_mov_b32 s15, 0x00020000
    s_mov_b32 s16, s38
    s_mov_b32 s17, s39
    s_mov_b32 s18, 0x6400
    s_mov_b32 s19, 0x00020000
    s_lshl_b32 s30, s25, 10
    s_add_u32 s29, s30, 0
    s_add_u32 m0, s29, 0
    s_nop 0
    buffer_load_dwordx4 v10, s[12:15], s29 offen lds
    s_add_u32 s29, s30, 0
    s_add_u32 m0, s29, 32768
    s_nop 0
    buffer_load_dwordx4 v10, s[16:19], s29 offen lds
    s_add_u32 s29, s30, 8192
    s_add_u32 m0, s29, 0
    s_nop 0
    buffer_load_dwordx4 v10, s[12:15], s29 offen lds
    s_add_u32 s29, s30, 8192
    s_add_u32 m0, s29, 32768
    s_nop 0
    buffer_load_dwordx4 v10, s[16:19], s29 offen lds
    s_add_u32 s29, s30, 16384
    s_add_u32 m0, s29, 0
    s_nop 0
    buffer_load_dwordx4 v10, s[12:15], s29 offen lds
    s_add_u32 s29, s30, 16384
    s_add_u32 m0, s29, 32768
    s_nop 0
    buffer_load_dwordx4 v10, s[16:19], s29 offen lds
    s_add_u32 s29, s30, 24576
    s_add_u32 m0, s29, 0
    s_nop 0
    buffer_load_dwordx4 v10, s[12:15], s29 offen lds
    s_add_u32 s29, s30, 24576
    s_add_u32 m0, s29, 32768
    s_nop 0
    buffer_load_dwordx4 v10, s[16:19], s29 offen lds
    s_add_u32 m0, s27, 65536
    s_add_u32 s29, s26, 0
    buffer_load_dwordx4 v8, s[8:11], s29 offen lds
    s_add_u32 m0, s27, 66560
    s_add_u32 s29, s26, 0
    buffer_load_dwordx4 v9, s[8:11], s29 offen lds
    s_add_u32 m0, s27, 81920
    s_add_u32 s29, s26, 128
    buffer_load_dwordx4 v8, s[8:11], s29 offen lds
    s_add_u32 m0, s27, 82944
    s_add_u32 s29, s26, 128
    buffer_load_dwordx4 v9, s[8:11], s29 offen lds
    s_add_u32 m0, s27, 98304
    s_add_u32 s29, s26, 256
    buffer_load_dwordx4 v8, s[8:11], s29 offen lds
    s_add_u32 m0, s27, 99328
    s_add_u32 s29, s26, 256
    buffer_load_dwordx4 v9, s[8:11], s29 offen lds
    s_add_u32 m0, s27, 114688
    s_add_u32 s29, s26, 384
    buffer_load_dwordx4 v8, s[8:11], s29 offen lds
    s_add_u32 m0, s27, 115712
    s_add_u32 s29, s26, 384
    buffer_load_dwordx4 v9, s[8:11], s29 offen lds
    s_add_u32 m0, s27, 131072
    s_add_u32 s29, s26, 512
    buffer_load_dwordx4 v8, s[8:11], s29 offen lds
    s_add_u32 m0, s27, 132096
    s_add_u32 s29, s26, 512
    buffer_load_dwordx4 v9, s[8:11], s29 offen lds
    s_waitcnt vmcnt(8)
    s_barrier
    s_waitcnt vmcnt(6)
    s_barrier
    s_waitcnt vmcnt(4)
    s_barrier
    s_add_u32 m0, s27, 65536
    s_add_u32 s29, s26, 640
    buffer_load_dwordx4 v8, s[8:11], s29 offen lds
    s_add_u32 m0, s27, 66560
    s_add_u32 s29, s26, 640
    buffer_load_dwordx4 v9, s[8:11], s29 offen lds
    s_waitcnt vmcnt(4)
    s_barrier
    s_add_u32 m0, s27, 81920
    s_add_u32 s29, s26, 768
    buffer_load_dwordx4 v8, s[8:11], s29 offen lds
    s_add_u32 m0, s27, 82944
    s_add_u32 s29, s26, 768
    buffer_load_dwordx4 v9, s[8:11], s29 offen lds
    s_waitcnt vmcnt(4)
    s_barrier
    s_add_u32 m0, s27, 98304
    s_add_u32 s29, s26, 896
    buffer_load_dwordx4 v8, s[8:11], s29 offen lds
    s_add_u32 m0, s27, 99328
    s_add_u32 s29, s26, 896
    buffer_load_dwordx4 v9, s[8:11], s29 offen lds
    s_waitcnt vmcnt(4)
    s_barrier
    s_add_u32 m0, s27, 114688
    s_add_u32 s29, s26, 1024
    buffer_load_dwordx4 v8, s[8:11], s29 offen lds
    s_add_u32 m0, s27, 115712
    s_add_u32 s29, s26, 1024
    buffer_load_dwordx4 v9, s[8:11], s29 offen lds
    s_waitcnt vmcnt(4)
    s_barrier
    s_add_u32 m0, s27, 131072
    s_add_u32 s29, s26, 1152
    buffer_load_dwordx4 v8, s[8:11], s29 offen lds
    s_add_u32 m0, s27, 132096
    s_add_u32 s29, s26, 1152
    buffer_load_dwordx4 v9, s[8:11], s29 offen lds
    s_waitcnt vmcnt(4)
    s_barrier
    s_waitcnt vmcnt(2)
    s_barrier
    s_waitcnt vmcnt(0)
    s_barrier
    s_branch kv_tail
kv_idle:
    s_barrier
    s_barrier
    s_barrier
    s_barrier
    s_barrier
    s_barrier
    s_barrier
    s_barrier
    s_barrier
    s_barrier
kv_tail:
    s_barrier
    s_cmp_eq_u32 s6, 8
    s_cbranch_scc0 kv_np
    s_load_dwordx2 s[12:13], s[0:1], 128
    s_waitcnt lgkmcnt(0)
    v_mov_b32 v2, 4
    v_mov_b32 v3, 1
    s_mov_b64 exec, 1
    global_atomic_add v5, v2, v3, s[12:13] sc0 sc1
    s_waitcnt vmcnt(0)
    v_readfirstlane_b32 s24, v5
    s_cmp_eq_u32 s24, 15
    s_cbranch_scc0 kv_ar
    global_store_dword v2, v3, s[12:13] offset:128 sc1
kv_ar:
    s_mov_b64 exec, -1
    v_min_u32 v2, 1, v1
    v_lshlrev_b32 v2, 2, v2
    s_mov_b32 s24, 0
kv_pf:
    global_load_dword v5, v2, s[12:13] offset:128 sc1
    s_waitcnt vmcnt(0)
    v_cmp_eq_u32 vcc, 1, v5
    s_add_u32 s24, s24, 1
    s_nop 3
    s_cmp_eq_u64 vcc, -1
    s_cbranch_scc1 kv_pf_d
    s_cmp_lt_u32 s24, 20000
    s_cbranch_scc0 kv_pf_d
    s_sleep 4
    s_branch kv_pf
kv_pf_d:
kv_np:
    s_barrier
    s_branch gated_mix__ssm_conv_s4__grouped_kv_mqa__prompt_kernel_ph2
kv_comp:
    s_lshl_b32 s26, s6, 12
    v_and_b32 v2, 31, v1
    v_bfe_u32 v3, v1, 1, 3
    v_lshrrev_b32 v4, 5, v1
    v_xor_b32 v3, v3, v4
    v_lshlrev_b32 v2, 7, v2
    v_add_u32 v2, s26, v2
    v_add_u32 v2, 65536, v2
    v_xor_b32 v4, 0, v3
    v_lshl_add_u32 v8, v4, 4, v2
    v_xor_b32 v4, 2, v3
    v_lshl_add_u32 v9, v4, 4, v2
    v_xor_b32 v4, 4, v3
    v_lshl_add_u32 v10, v4, 4, v2
    v_xor_b32 v4, 6, v3
    v_lshl_add_u32 v11, v4, 4, v2
    v_lshrrev_b32 v2, 5, v1
    v_bfe_u32 v3, v1, 2, 2
    v_lshl_add_u32 v2, v2, 3, v3
    v_mul_u32_u24 v12, 40, v2
    v_bfe_u32 v2, v1, 4, 1
    v_lshl_add_u32 v12, v2, 5, v12
    v_and_b32 v2, 3, v1
    v_lshl_add_u32 v12, v2, 3, v12
    s_barrier
    ds_read_b128 v[16:19], v8 offset:0
    ds_read_b64_tr_b16 v[24:25], v12 offset:0
    ds_read_b64_tr_b16 v[26:27], v12 offset:160
    ds_read_b64_tr_b16 v[32:33], v12 offset:32768
    ds_read_b64_tr_b16 v[34:35], v12 offset:32928
    ds_read_b128 v[20:23], v9 offset:0
    ds_read_b64_tr_b16 v[28:29], v12 offset:640
    ds_read_b64_tr_b16 v[30:31], v12 offset:800
    ds_read_b64_tr_b16 v[36:37], v12 offset:33408
    ds_read_b64_tr_b16 v[38:39], v12 offset:33568
    s_waitcnt lgkmcnt(5)
    v_mfma_f32_32x32x16_bf16 v[64:79], v[24:27], v[16:19], 0
    v_mfma_f32_32x32x16_bf16 v[80:95], v[16:19], v[32:35], 0
    ds_read_b128 v[16:19], v10 offset:0
    ds_read_b64_tr_b16 v[24:25], v12 offset:1280
    ds_read_b64_tr_b16 v[26:27], v12 offset:1440
    ds_read_b64_tr_b16 v[32:33], v12 offset:34048
    ds_read_b64_tr_b16 v[34:35], v12 offset:34208
    s_waitcnt lgkmcnt(5)
    v_mfma_f32_32x32x16_bf16 v[64:79], v[28:31], v[20:23], v[64:79]
    v_mfma_f32_32x32x16_bf16 v[80:95], v[20:23], v[36:39], v[80:95]
    ds_read_b128 v[20:23], v11 offset:0
    ds_read_b64_tr_b16 v[28:29], v12 offset:1920
    ds_read_b64_tr_b16 v[30:31], v12 offset:2080
    ds_read_b64_tr_b16 v[36:37], v12 offset:34688
    ds_read_b64_tr_b16 v[38:39], v12 offset:34848
    s_waitcnt lgkmcnt(5)
    v_mfma_f32_32x32x16_bf16 v[64:79], v[24:27], v[16:19], v[64:79]
    s_barrier
    v_mfma_f32_32x32x16_bf16 v[80:95], v[16:19], v[32:35], v[80:95]
    ds_read_b128 v[16:19], v8 offset:16384
    ds_read_b64_tr_b16 v[24:25], v12 offset:2560
    ds_read_b64_tr_b16 v[26:27], v12 offset:2720
    ds_read_b64_tr_b16 v[32:33], v12 offset:35328
    ds_read_b64_tr_b16 v[34:35], v12 offset:35488
    s_waitcnt lgkmcnt(5)
    v_mfma_f32_32x32x16_bf16 v[64:79], v[28:31], v[20:23], v[64:79]
    v_mfma_f32_32x32x16_bf16 v[80:95], v[20:23], v[36:39], v[80:95]
    ds_read_b128 v[20:23], v9 offset:16384
    ds_read_b64_tr_b16 v[28:29], v12 offset:3200
    ds_read_b64_tr_b16 v[30:31], v12 offset:3360
    ds_read_b64_tr_b16 v[36:37], v12 offset:35968
    ds_read_b64_tr_b16 v[38:39], v12 offset:36128
    s_waitcnt lgkmcnt(5)
    v_mfma_f32_32x32x16_bf16 v[64:79], v[24:27], v[16:19], v[64:79]
    v_mfma_f32_32x32x16_bf16 v[80:95], v[16:19], v[32:35], v[80:95]
    ds_read_b128 v[16:19], v10 offset:16384
    ds_read_b64_tr_b16 v[24:25], v12 offset:3840
    ds_read_b64_tr_b16 v[26:27], v12 offset:4000
    ds_read_b64_tr_b16 v[32:33], v12 offset:36608
    ds_read_b64_tr_b16 v[34:35], v12 offset:36768
    s_waitcnt lgkmcnt(5)
    v_mfma_f32_32x32x16_bf16 v[64:79], v[28:31], v[20:23], v[64:79]
    v_mfma_f32_32x32x16_bf16 v[80:95], v[20:23], v[36:39], v[80:95]
    ds_read_b128 v[20:23], v11 offset:16384
    ds_read_b64_tr_b16 v[28:29], v12 offset:4480
    ds_read_b64_tr_b16 v[30:31], v12 offset:4640
    ds_read_b64_tr_b16 v[36:37], v12 offset:37248
    ds_read_b64_tr_b16 v[38:39], v12 offset:37408
    s_waitcnt lgkmcnt(5)
    v_mfma_f32_32x32x16_bf16 v[64:79], v[24:27], v[16:19], v[64:79]
    s_barrier
    v_mfma_f32_32x32x16_bf16 v[80:95], v[16:19], v[32:35], v[80:95]
    ds_read_b128 v[16:19], v8 offset:32768
    ds_read_b64_tr_b16 v[24:25], v12 offset:5120
    ds_read_b64_tr_b16 v[26:27], v12 offset:5280
    ds_read_b64_tr_b16 v[32:33], v12 offset:37888
    ds_read_b64_tr_b16 v[34:35], v12 offset:38048
    s_waitcnt lgkmcnt(5)
    v_mfma_f32_32x32x16_bf16 v[64:79], v[28:31], v[20:23], v[64:79]
    v_mfma_f32_32x32x16_bf16 v[80:95], v[20:23], v[36:39], v[80:95]
    ds_read_b128 v[20:23], v9 offset:32768
    ds_read_b64_tr_b16 v[28:29], v12 offset:5760
    ds_read_b64_tr_b16 v[30:31], v12 offset:5920
    ds_read_b64_tr_b16 v[36:37], v12 offset:38528
    ds_read_b64_tr_b16 v[38:39], v12 offset:38688
    s_waitcnt lgkmcnt(5)
    v_mfma_f32_32x32x16_bf16 v[64:79], v[24:27], v[16:19], v[64:79]
    v_mfma_f32_32x32x16_bf16 v[80:95], v[16:19], v[32:35], v[80:95]
    ds_read_b128 v[16:19], v10 offset:32768
    ds_read_b64_tr_b16 v[24:25], v12 offset:6400
    ds_read_b64_tr_b16 v[26:27], v12 offset:6560
    ds_read_b64_tr_b16 v[32:33], v12 offset:39168
    ds_read_b64_tr_b16 v[34:35], v12 offset:39328
    s_waitcnt lgkmcnt(5)
    v_mfma_f32_32x32x16_bf16 v[64:79], v[28:31], v[20:23], v[64:79]
    v_mfma_f32_32x32x16_bf16 v[80:95], v[20:23], v[36:39], v[80:95]
    ds_read_b128 v[20:23], v11 offset:32768
    ds_read_b64_tr_b16 v[28:29], v12 offset:7040
    ds_read_b64_tr_b16 v[30:31], v12 offset:7200
    ds_read_b64_tr_b16 v[36:37], v12 offset:39808
    ds_read_b64_tr_b16 v[38:39], v12 offset:39968
    s_waitcnt lgkmcnt(5)
    v_mfma_f32_32x32x16_bf16 v[64:79], v[24:27], v[16:19], v[64:79]
    s_barrier
    v_mfma_f32_32x32x16_bf16 v[80:95], v[16:19], v[32:35], v[80:95]
    ds_read_b128 v[16:19], v8 offset:49152
    ds_read_b64_tr_b16 v[24:25], v12 offset:7680
    ds_read_b64_tr_b16 v[26:27], v12 offset:7840
    ds_read_b64_tr_b16 v[32:33], v12 offset:40448
    ds_read_b64_tr_b16 v[34:35], v12 offset:40608
    s_waitcnt lgkmcnt(5)
    v_mfma_f32_32x32x16_bf16 v[64:79], v[28:31], v[20:23], v[64:79]
    v_mfma_f32_32x32x16_bf16 v[80:95], v[20:23], v[36:39], v[80:95]
    ds_read_b128 v[20:23], v9 offset:49152
    ds_read_b64_tr_b16 v[28:29], v12 offset:8320
    ds_read_b64_tr_b16 v[30:31], v12 offset:8480
    ds_read_b64_tr_b16 v[36:37], v12 offset:41088
    ds_read_b64_tr_b16 v[38:39], v12 offset:41248
    s_waitcnt lgkmcnt(5)
    v_mfma_f32_32x32x16_bf16 v[64:79], v[24:27], v[16:19], v[64:79]
    v_mfma_f32_32x32x16_bf16 v[80:95], v[16:19], v[32:35], v[80:95]
    ds_read_b128 v[16:19], v10 offset:49152
    ds_read_b64_tr_b16 v[24:25], v12 offset:8960
    ds_read_b64_tr_b16 v[26:27], v12 offset:9120
    ds_read_b64_tr_b16 v[32:33], v12 offset:41728
    ds_read_b64_tr_b16 v[34:35], v12 offset:41888
    s_waitcnt lgkmcnt(5)
    v_mfma_f32_32x32x16_bf16 v[64:79], v[28:31], v[20:23], v[64:79]
    v_mfma_f32_32x32x16_bf16 v[80:95], v[20:23], v[36:39], v[80:95]
    ds_read_b128 v[20:23], v11 offset:49152
    ds_read_b64_tr_b16 v[28:29], v12 offset:9600
    ds_read_b64_tr_b16 v[30:31], v12 offset:9760
    ds_read_b64_tr_b16 v[36:37], v12 offset:42368
    ds_read_b64_tr_b16 v[38:39], v12 offset:42528
    s_waitcnt lgkmcnt(5)
    v_mfma_f32_32x32x16_bf16 v[64:79], v[24:27], v[16:19], v[64:79]
    s_barrier
    v_mfma_f32_32x32x16_bf16 v[80:95], v[16:19], v[32:35], v[80:95]
    v_add_u32 v2, 65536, v8
    ds_read_b128 v[16:19], v2 offset:0
    ds_read_b64_tr_b16 v[24:25], v12 offset:10240
    ds_read_b64_tr_b16 v[26:27], v12 offset:10400
    ds_read_b64_tr_b16 v[32:33], v12 offset:43008
    ds_read_b64_tr_b16 v[34:35], v12 offset:43168
    s_waitcnt lgkmcnt(5)
    v_mfma_f32_32x32x16_bf16 v[64:79], v[28:31], v[20:23], v[64:79]
    v_mfma_f32_32x32x16_bf16 v[80:95], v[20:23], v[36:39], v[80:95]
    v_add_u32 v2, 65536, v9
    ds_read_b128 v[20:23], v2 offset:0
    ds_read_b64_tr_b16 v[28:29], v12 offset:10880
    ds_read_b64_tr_b16 v[30:31], v12 offset:11040
    ds_read_b64_tr_b16 v[36:37], v12 offset:43648
    ds_read_b64_tr_b16 v[38:39], v12 offset:43808
    s_waitcnt lgkmcnt(5)
    v_mfma_f32_32x32x16_bf16 v[64:79], v[24:27], v[16:19], v[64:79]
    v_mfma_f32_32x32x16_bf16 v[80:95], v[16:19], v[32:35], v[80:95]
    v_add_u32 v2, 65536, v10
    ds_read_b128 v[16:19], v2 offset:0
    ds_read_b64_tr_b16 v[24:25], v12 offset:11520
    ds_read_b64_tr_b16 v[26:27], v12 offset:11680
    ds_read_b64_tr_b16 v[32:33], v12 offset:44288
    ds_read_b64_tr_b16 v[34:35], v12 offset:44448
    s_waitcnt lgkmcnt(5)
    v_mfma_f32_32x32x16_bf16 v[64:79], v[28:31], v[20:23], v[64:79]
    v_mfma_f32_32x32x16_bf16 v[80:95], v[20:23], v[36:39], v[80:95]
    v_add_u32 v2, 65536, v11
    ds_read_b128 v[20:23], v2 offset:0
    ds_read_b64_tr_b16 v[28:29], v12 offset:12160
    ds_read_b64_tr_b16 v[30:31], v12 offset:12320
    ds_read_b64_tr_b16 v[36:37], v12 offset:44928
    ds_read_b64_tr_b16 v[38:39], v12 offset:45088
    s_waitcnt lgkmcnt(5)
    v_mfma_f32_32x32x16_bf16 v[64:79], v[24:27], v[16:19], v[64:79]
    s_barrier
    v_mfma_f32_32x32x16_bf16 v[80:95], v[16:19], v[32:35], v[80:95]
    ds_read_b128 v[16:19], v8 offset:0
    ds_read_b64_tr_b16 v[24:25], v12 offset:12800
    ds_read_b64_tr_b16 v[26:27], v12 offset:12960
    ds_read_b64_tr_b16 v[32:33], v12 offset:45568
    ds_read_b64_tr_b16 v[34:35], v12 offset:45728
    s_waitcnt lgkmcnt(5)
    v_mfma_f32_32x32x16_bf16 v[64:79], v[28:31], v[20:23], v[64:79]
    v_mfma_f32_32x32x16_bf16 v[80:95], v[20:23], v[36:39], v[80:95]
    ds_read_b128 v[20:23], v9 offset:0
    ds_read_b64_tr_b16 v[28:29], v12 offset:13440
    ds_read_b64_tr_b16 v[30:31], v12 offset:13600
    ds_read_b64_tr_b16 v[36:37], v12 offset:46208
    ds_read_b64_tr_b16 v[38:39], v12 offset:46368
    s_waitcnt lgkmcnt(5)
    v_mfma_f32_32x32x16_bf16 v[64:79], v[24:27], v[16:19], v[64:79]
    v_mfma_f32_32x32x16_bf16 v[80:95], v[16:19], v[32:35], v[80:95]
    ds_read_b128 v[16:19], v10 offset:0
    ds_read_b64_tr_b16 v[24:25], v12 offset:14080
    ds_read_b64_tr_b16 v[26:27], v12 offset:14240
    ds_read_b64_tr_b16 v[32:33], v12 offset:46848
    ds_read_b64_tr_b16 v[34:35], v12 offset:47008
    s_waitcnt lgkmcnt(5)
    v_mfma_f32_32x32x16_bf16 v[64:79], v[28:31], v[20:23], v[64:79]
    v_mfma_f32_32x32x16_bf16 v[80:95], v[20:23], v[36:39], v[80:95]
    ds_read_b128 v[20:23], v11 offset:0
    ds_read_b64_tr_b16 v[28:29], v12 offset:14720
    ds_read_b64_tr_b16 v[30:31], v12 offset:14880
    ds_read_b64_tr_b16 v[36:37], v12 offset:47488
    ds_read_b64_tr_b16 v[38:39], v12 offset:47648
    s_waitcnt lgkmcnt(5)
    v_mfma_f32_32x32x16_bf16 v[64:79], v[24:27], v[16:19], v[64:79]
    s_barrier
    v_mfma_f32_32x32x16_bf16 v[80:95], v[16:19], v[32:35], v[80:95]
    ds_read_b128 v[16:19], v8 offset:16384
    ds_read_b64_tr_b16 v[24:25], v12 offset:15360
    ds_read_b64_tr_b16 v[26:27], v12 offset:15520
    ds_read_b64_tr_b16 v[32:33], v12 offset:48128
    ds_read_b64_tr_b16 v[34:35], v12 offset:48288
    s_waitcnt lgkmcnt(5)
    v_mfma_f32_32x32x16_bf16 v[64:79], v[28:31], v[20:23], v[64:79]
    v_mfma_f32_32x32x16_bf16 v[80:95], v[20:23], v[36:39], v[80:95]
    ds_read_b128 v[20:23], v9 offset:16384
    ds_read_b64_tr_b16 v[28:29], v12 offset:16000
    ds_read_b64_tr_b16 v[30:31], v12 offset:16160
    ds_read_b64_tr_b16 v[36:37], v12 offset:48768
    ds_read_b64_tr_b16 v[38:39], v12 offset:48928
    s_waitcnt lgkmcnt(5)
    v_mfma_f32_32x32x16_bf16 v[64:79], v[24:27], v[16:19], v[64:79]
    v_mfma_f32_32x32x16_bf16 v[80:95], v[16:19], v[32:35], v[80:95]
    ds_read_b128 v[16:19], v10 offset:16384
    ds_read_b64_tr_b16 v[24:25], v12 offset:16640
    ds_read_b64_tr_b16 v[26:27], v12 offset:16800
    ds_read_b64_tr_b16 v[32:33], v12 offset:49408
    ds_read_b64_tr_b16 v[34:35], v12 offset:49568
    s_waitcnt lgkmcnt(5)
    v_mfma_f32_32x32x16_bf16 v[64:79], v[28:31], v[20:23], v[64:79]
    v_mfma_f32_32x32x16_bf16 v[80:95], v[20:23], v[36:39], v[80:95]
    ds_read_b128 v[20:23], v11 offset:16384
    ds_read_b64_tr_b16 v[28:29], v12 offset:17280
    ds_read_b64_tr_b16 v[30:31], v12 offset:17440
    ds_read_b64_tr_b16 v[36:37], v12 offset:50048
    ds_read_b64_tr_b16 v[38:39], v12 offset:50208
    s_waitcnt lgkmcnt(5)
    v_mfma_f32_32x32x16_bf16 v[64:79], v[24:27], v[16:19], v[64:79]
    s_barrier
    v_mfma_f32_32x32x16_bf16 v[80:95], v[16:19], v[32:35], v[80:95]
    ds_read_b128 v[16:19], v8 offset:32768
    ds_read_b64_tr_b16 v[24:25], v12 offset:17920
    ds_read_b64_tr_b16 v[26:27], v12 offset:18080
    ds_read_b64_tr_b16 v[32:33], v12 offset:50688
    ds_read_b64_tr_b16 v[34:35], v12 offset:50848
    s_waitcnt lgkmcnt(5)
    v_mfma_f32_32x32x16_bf16 v[64:79], v[28:31], v[20:23], v[64:79]
    v_mfma_f32_32x32x16_bf16 v[80:95], v[20:23], v[36:39], v[80:95]
    ds_read_b128 v[20:23], v9 offset:32768
    ds_read_b64_tr_b16 v[28:29], v12 offset:18560
    ds_read_b64_tr_b16 v[30:31], v12 offset:18720
    ds_read_b64_tr_b16 v[36:37], v12 offset:51328
    ds_read_b64_tr_b16 v[38:39], v12 offset:51488
    s_waitcnt lgkmcnt(5)
    v_mfma_f32_32x32x16_bf16 v[64:79], v[24:27], v[16:19], v[64:79]
    v_mfma_f32_32x32x16_bf16 v[80:95], v[16:19], v[32:35], v[80:95]
    ds_read_b128 v[16:19], v10 offset:32768
    ds_read_b64_tr_b16 v[24:25], v12 offset:19200
    ds_read_b64_tr_b16 v[26:27], v12 offset:19360
    ds_read_b64_tr_b16 v[32:33], v12 offset:51968
    ds_read_b64_tr_b16 v[34:35], v12 offset:52128
    s_waitcnt lgkmcnt(5)
    v_mfma_f32_32x32x16_bf16 v[64:79], v[28:31], v[20:23], v[64:79]
    v_mfma_f32_32x32x16_bf16 v[80:95], v[20:23], v[36:39], v[80:95]
    ds_read_b128 v[20:23], v11 offset:32768
    ds_read_b64_tr_b16 v[28:29], v12 offset:19840
    ds_read_b64_tr_b16 v[30:31], v12 offset:20000
    ds_read_b64_tr_b16 v[36:37], v12 offset:52608
    ds_read_b64_tr_b16 v[38:39], v12 offset:52768
    s_waitcnt lgkmcnt(5)
    v_mfma_f32_32x32x16_bf16 v[64:79], v[24:27], v[16:19], v[64:79]
    s_barrier
    v_mfma_f32_32x32x16_bf16 v[80:95], v[16:19], v[32:35], v[80:95]
    ds_read_b128 v[16:19], v8 offset:49152
    ds_read_b64_tr_b16 v[24:25], v12 offset:20480
    ds_read_b64_tr_b16 v[26:27], v12 offset:20640
    ds_read_b64_tr_b16 v[32:33], v12 offset:53248
    ds_read_b64_tr_b16 v[34:35], v12 offset:53408
    s_waitcnt lgkmcnt(5)
    v_mfma_f32_32x32x16_bf16 v[64:79], v[28:31], v[20:23], v[64:79]
    v_mfma_f32_32x32x16_bf16 v[80:95], v[20:23], v[36:39], v[80:95]
    ds_read_b128 v[20:23], v9 offset:49152
    ds_read_b64_tr_b16 v[28:29], v12 offset:21120
    ds_read_b64_tr_b16 v[30:31], v12 offset:21280
    ds_read_b64_tr_b16 v[36:37], v12 offset:53888
    ds_read_b64_tr_b16 v[38:39], v12 offset:54048
    s_waitcnt lgkmcnt(5)
    v_mfma_f32_32x32x16_bf16 v[64:79], v[24:27], v[16:19], v[64:79]
    v_mfma_f32_32x32x16_bf16 v[80:95], v[16:19], v[32:35], v[80:95]
    ds_read_b128 v[16:19], v10 offset:49152
    ds_read_b64_tr_b16 v[24:25], v12 offset:21760
    ds_read_b64_tr_b16 v[26:27], v12 offset:21920
    ds_read_b64_tr_b16 v[32:33], v12 offset:54528
    ds_read_b64_tr_b16 v[34:35], v12 offset:54688
    s_waitcnt lgkmcnt(5)
    v_mfma_f32_32x32x16_bf16 v[64:79], v[28:31], v[20:23], v[64:79]
    v_mfma_f32_32x32x16_bf16 v[80:95], v[20:23], v[36:39], v[80:95]
    ds_read_b128 v[20:23], v11 offset:49152
    ds_read_b64_tr_b16 v[28:29], v12 offset:22400
    ds_read_b64_tr_b16 v[30:31], v12 offset:22560
    ds_read_b64_tr_b16 v[36:37], v12 offset:55168
    ds_read_b64_tr_b16 v[38:39], v12 offset:55328
    s_waitcnt lgkmcnt(5)
    v_mfma_f32_32x32x16_bf16 v[64:79], v[24:27], v[16:19], v[64:79]
    s_barrier
    v_mfma_f32_32x32x16_bf16 v[80:95], v[16:19], v[32:35], v[80:95]
    v_add_u32 v2, 65536, v8
    ds_read_b128 v[16:19], v2 offset:0
    ds_read_b64_tr_b16 v[24:25], v12 offset:23040
    ds_read_b64_tr_b16 v[26:27], v12 offset:23200
    ds_read_b64_tr_b16 v[32:33], v12 offset:55808
    ds_read_b64_tr_b16 v[34:35], v12 offset:55968
    s_waitcnt lgkmcnt(5)
    v_mfma_f32_32x32x16_bf16 v[64:79], v[28:31], v[20:23], v[64:79]
    v_mfma_f32_32x32x16_bf16 v[80:95], v[20:23], v[36:39], v[80:95]
    v_add_u32 v2, 65536, v9
    ds_read_b128 v[20:23], v2 offset:0
    ds_read_b64_tr_b16 v[28:29], v12 offset:23680
    ds_read_b64_tr_b16 v[30:31], v12 offset:23840
    ds_read_b64_tr_b16 v[36:37], v12 offset:56448
    ds_read_b64_tr_b16 v[38:39], v12 offset:56608
    s_waitcnt lgkmcnt(5)
    v_mfma_f32_32x32x16_bf16 v[64:79], v[24:27], v[16:19], v[64:79]
    v_mfma_f32_32x32x16_bf16 v[80:95], v[16:19], v[32:35], v[80:95]
    v_add_u32 v2, 65536, v10
    ds_read_b128 v[16:19], v2 offset:0
    ds_read_b64_tr_b16 v[24:25], v12 offset:24320
    ds_read_b64_tr_b16 v[26:27], v12 offset:24480
    ds_read_b64_tr_b16 v[32:33], v12 offset:57088
    ds_read_b64_tr_b16 v[34:35], v12 offset:57248
    s_waitcnt lgkmcnt(5)
    v_mfma_f32_32x32x16_bf16 v[64:79], v[28:31], v[20:23], v[64:79]
    v_mfma_f32_32x32x16_bf16 v[80:95], v[20:23], v[36:39], v[80:95]
    v_add_u32 v2, 65536, v11
    ds_read_b128 v[20:23], v2 offset:0
    ds_read_b64_tr_b16 v[28:29], v12 offset:24960
    ds_read_b64_tr_b16 v[30:31], v12 offset:25120
    ds_read_b64_tr_b16 v[36:37], v12 offset:57728
    ds_read_b64_tr_b16 v[38:39], v12 offset:57888
    s_waitcnt lgkmcnt(5)
    v_mfma_f32_32x32x16_bf16 v[64:79], v[24:27], v[16:19], v[64:79]
    v_mfma_f32_32x32x16_bf16 v[80:95], v[16:19], v[32:35], v[80:95]
    s_waitcnt lgkmcnt(0)
    v_mfma_f32_32x32x16_bf16 v[64:79], v[28:31], v[20:23], v[64:79]
    v_mfma_f32_32x32x16_bf16 v[80:95], v[20:23], v[36:39], v[80:95]
    s_waitcnt lgkmcnt(0)
    s_add_u32 s20, s4, 0x280000
    s_addc_u32 s21, s5, 0
    s_mov_b32 s22, 0x28000
    s_mov_b32 s23, 0x00020000
    s_lshr_b32 s26, s24, 5
    s_add_u32 s26, s26, s6
    s_mul_i32 s26, s26, 2560
    v_and_b32 v2, 31, v1
    v_lshrrev_b32 v3, 5, v1
    v_lshlrev_b32 v8, 4, v2
    v_lshl_add_u32 v8, v3, 3, v8
    v_lshlrev_b32 v9, 30, v3
    v_lshl_add_u32 v9, v2, 3, v9
    v_mul_u32_u24 v10, 320, v3
    v_lshl_add_u32 v10, v2, 4, v10
    v_cmp_gt_u32 vcc, 20, v2
    v_mov_b32 v4, 0x40000000
    s_nop 1
    v_cndmask_b32 v10, v4, v10, vcc
    s_nop 7
    v_cvt_pk_bf16_f32 v16, v64, v65
    v_cvt_pk_bf16_f32 v17, v66, v67
    v_cvt_pk_bf16_f32 v18, v68, v69
    v_cvt_pk_bf16_f32 v19, v70, v71
    v_cvt_pk_bf16_f32 v20, v72, v73
    v_cvt_pk_bf16_f32 v21, v74, v75
    v_lshlrev_b32 v64, 16, v16
    v_and_b32 v65, 0xffff0000, v16
    v_lshlrev_b32 v66, 16, v17
    v_and_b32 v67, 0xffff0000, v17
    v_lshlrev_b32 v68, 16, v18
    v_and_b32 v69, 0xffff0000, v18
    v_lshlrev_b32 v70, 16, v19
    v_and_b32 v71, 0xffff0000, v19
    v_lshlrev_b32 v72, 16, v20
    v_and_b32 v73, 0xffff0000, v20
    v_lshlrev_b32 v74, 16, v21
    v_and_b32 v75, 0xffff0000, v21
    s_mov_b32 s27, 0x3ea52b5c
    v_mul_f32 v64, s27, v64
    v_mul_f32 v65, s27, v65
    v_mul_f32 v66, s27, v66
    v_mul_f32 v67, s27, v67
    v_mul_f32 v68, s27, v68
    v_mul_f32 v69, s27, v69
    v_mul_f32 v70, s27, v70
    v_mul_f32 v71, s27, v71
    v_mul_f32 v72, s27, v72
    v_mul_f32 v73, s27, v73
    v_mul_f32 v74, s27, v74
    v_mul_f32 v75, s27, v75
    v_cvt_pk_bf16_f32 v16, v64, v65
    v_cvt_pk_bf16_f32 v17, v66, v67
    v_cvt_pk_bf16_f32 v18, v68, v69
    v_cvt_pk_bf16_f32 v19, v70, v71
    v_cvt_pk_bf16_f32 v20, v72, v73
    v_cvt_pk_bf16_f32 v21, v74, v75
    v_cvt_pk_bf16_f32 v24, v80, v81
    v_cvt_pk_bf16_f32 v25, v82, v83
    v_cvt_pk_bf16_f32 v26, v84, v85
    v_cvt_pk_bf16_f32 v27, v86, v87
    v_cvt_pk_bf16_f32 v28, v88, v89
    v_cvt_pk_bf16_f32 v29, v90, v91
    v_cvt_pk_bf16_f32 v30, v92, v93
    v_cvt_pk_bf16_f32 v31, v94, v95
    buffer_store_dwordx2 v[16:17], v8, s[20:23], s26 offen sc1
    buffer_store_dwordx2 v[18:19], v8, s[20:23], s26 offen offset:512 sc1
    buffer_store_dwordx2 v[20:21], v9, s[20:23], s26 offen offset:1024 sc1
    buffer_store_dwordx4 v[24:27], v10, s[20:23], s26 offen offset:1280 sc1
    buffer_store_dwordx4 v[28:31], v10, s[20:23], s26 offen offset:1920 sc1
    s_waitcnt vmcnt(0)
    s_branch kv_tail
    s_branch gated_mix__ssm_conv_s4__grouped_kv_mqa__prompt_kernel_ph2
k1_q:
    s_cmp_ge_u32 s6, 12
    s_cbranch_scc1 q_poison
    s_load_dwordx2 s[32:33], s[0:1], 0
    s_load_dwordx2 s[34:35], s[0:1], 80
    s_load_dwordx2 s[4:5], s[0:1], 136
    s_sub_u32 s23, s2, 160
    s_and_b32 s20, s23, 15
    s_lshl_b32 s20, s20, 7
    s_lshr_b32 s21, s23, 4
    s_lshl_b32 s21, s21, 8
    s_cmp_lt_u32 s6, 4
    s_cbranch_scc1 q_comp
    s_sub_u32 s22, s6, 4
    v_lshrrev_b32 v2, 3, v1
    v_mul_u32_u24 v8, 1280, v2
    v_lshrrev_b32 v2, 4, v1
    v_and_b32 v3, 7, v1
    v_xor_b32 v2, v2, v3
    v_lshl_add_u32 v8, v2, 4, v8
    v_lshrrev_b32 v2, 3, v1
    v_add_u32 v2, 8, v2
    v_mul_u32_u24 v9, 1280, v2
    v_lshrrev_b32 v2, 4, v1
    v_add_u32 v2, 4, v2
    v_and_b32 v3, 7, v1
    v_xor_b32 v2, v2, v3
    v_lshl_add_u32 v9, v2, 4, v9
    v_lshrrev_b32 v2, 4, v1
    v_mul_u32_u24 v10, 1280, v2
    v_and_b32 v3, 1, v2
    v_lshlrev_b32 v3, 1, v3
    v_lshrrev_b32 v2, 1, v2
    v_lshl_add_u32 v3, v2, 3, v3
    v_and_b32 v2, 15, v1
    v_xor_b32 v2, v2, v3
    v_lshl_add_u32 v10, v2, 4, v10
    s_lshl_b32 s27, s22, 4
    s_add_u32 s27, s27, s20
    s_mul_i32 s24, s27, 1280
    s_mul_i32 s25, s22, 10240
    s_add_u32 s25, s25, s21
    s_lshl_b32 s26, s22, 11
    s_waitcnt lgkmcnt(0)
    s_mov_b32 s8, s32
    s_mov_b32 s9, s33
    s_mov_b32 s10, 0x280000
    s_mov_b32 s11, 0x00020000
    s_mov_b32 s12, s34
    s_mov_b32 s13, s35
    s_mov_b32 s14, 0xc8000
    s_mov_b32 s15, 0x00020000
    s_mov_b32 s16, s4
    s_mov_b32 s17, s5
    s_mov_b32 s18, 0x280000
    s_mov_b32 s19, 0x00020000
    s_lshr_b32 s36, s23, 4
    s_lshl_b32 s36, s36, 1
    s_bfe_u32 s37, s23, 0x10003
    s_cmp_eq_u32 s37, 1
    s_cselect_b32 s29, 2, 0
    s_add_u32 s29, s29, s36
    s_cmp_ge_u32 s29, 10
    s_cselect_b32 s30, 10, 0
    s_sub_u32 s29, s29, s30
    s_lshl_b32 s30, s29, 7
    s_add_u32 s30, s30, s24
    s_mul_i32 s31, s29, 81920
    s_add_u32 s31, s31, s25
    s_add_u32 m0, s26, 0
    s_nop 0
    buffer_load_dwordx4 v8, s[8:11], s30 offen lds
    s_add_u32 m0, s26, 1024
    s_nop 0
    buffer_load_dwordx4 v9, s[8:11], s30 offen lds
    s_add_u32 m0, s26, 16384
    s_add_u32 s28, s31, 0
    buffer_load_dwordx4 v10, s[12:15], s28 offen lds
    s_add_u32 m0, s26, 17408
    s_add_u32 s28, s31, 5120
    buffer_load_dwordx4 v10, s[12:15], s28 offen lds
    s_cmp_eq_u32 s37, 1
    s_cselect_b32 s29, 0, 2
    s_add_u32 s29, s29, s36
    s_cmp_ge_u32 s29, 10
    s_cselect_b32 s30, 10, 0
    s_sub_u32 s29, s29, s30
    s_lshl_b32 s30, s29, 7
    s_add_u32 s30, s30, s24
    s_mul_i32 s31, s29, 81920
    s_add_u32 s31, s31, s25
    s_add_u32 m0, s26, 32768
    s_nop 0
    buffer_load_dwordx4 v8, s[8:11], s30 offen lds
    s_add_u32 m0, s26, 33792
    s_nop 0
    buffer_load_dwordx4 v9, s[8:11], s30 offen lds
    s_add_u32 m0, s26, 49152
    s_add_u32 s28, s31, 0
    buffer_load_dwordx4 v10, s[12:15], s28 offen lds
    s_add_u32 m0, s26, 50176
    s_add_u32 s28, s31, 5120
    buffer_load_dwordx4 v10, s[12:15], s28 offen lds
    v_lshrrev_b32 v2, 4, v1
    v_and_b32 v3, 15, v1
    v_mul_u32_u24 v12, 272, v2
    v_lshl_add_u32 v12, v3, 4, v12
    s_mul_i32 s27, s22, 4352
    s_cmp_ge_u32 s22, 4
    s_cselect_b32 s28, 19456, 0
    s_add_u32 s27, s27, s28
    v_add_u32 v12, s27, v12
    v_mul_u32_u24 v13, 1280, v2
    v_lshl_add_u32 v13, v3, 4, v13
    s_waitcnt vmcnt(4)
    s_barrier
    s_cmp_eq_u32 s37, 1
    s_cselect_b32 s29, 3, 1
    s_add_u32 s29, s29, s36
    s_cmp_ge_u32 s29, 10
    s_cselect_b32 s30, 10, 0
    s_sub_u32 s29, s29, s30
    s_lshl_b32 s30, s29, 7
    s_add_u32 s30, s30, s24
    s_mul_i32 s31, s29, 81920
    s_add_u32 s31, s31, s25
    s_add_u32 m0, s26, 65536
    s_nop 0
    buffer_load_dwordx4 v8, s[8:11], s30 offen lds
    s_add_u32 m0, s26, 66560
    s_nop 0
    buffer_load_dwordx4 v9, s[8:11], s30 offen lds
    s_add_u32 m0, s26, 81920
    s_add_u32 s28, s31, 0
    buffer_load_dwordx4 v10, s[12:15], s28 offen lds
    s_add_u32 m0, s26, 82944
    s_add_u32 s28, s31, 5120
    buffer_load_dwordx4 v10, s[12:15], s28 offen lds
    s_waitcnt vmcnt(4)
    s_barrier
    s_cmp_eq_u32 s37, 1
    s_cselect_b32 s29, 1, 3
    s_add_u32 s29, s29, s36
    s_cmp_ge_u32 s29, 10
    s_cselect_b32 s30, 10, 0
    s_sub_u32 s29, s29, s30
    s_lshl_b32 s30, s29, 7
    s_add_u32 s30, s30, s24
    s_mul_i32 s31, s29, 81920
    s_add_u32 s31, s31, s25
    s_add_u32 m0, s26, 98304
    s_nop 0
    buffer_load_dwordx4 v8, s[8:11], s30 offen lds
    s_add_u32 m0, s26, 99328
    s_nop 0
    buffer_load_dwordx4 v9, s[8:11], s30 offen lds
    s_add_u32 m0, s26, 114688
    s_add_u32 s28, s31, 0
    buffer_load_dwordx4 v10, s[12:15], s28 offen lds
    s_add_u32 m0, s26, 115712
    s_add_u32 s28, s31, 5120
    buffer_load_dwordx4 v10, s[12:15], s28 offen lds
    s_waitcnt vmcnt(4)
    s_barrier
    s_cmp_eq_u32 s37, 1
    s_cselect_b32 s29, 6, 4
    s_add_u32 s29, s29, s36
    s_cmp_ge_u32 s29, 10
    s_cselect_b32 s30, 10, 0
    s_sub_u32 s29, s29, s30
    s_lshl_b32 s30, s29, 7
    s_add_u32 s30, s30, s24
    s_mul_i32 s31, s29, 81920
    s_add_u32 s31, s31, s25
    s_add_u32 m0, s26, 131072
    s_nop 0
    buffer_load_dwordx4 v8, s[8:11], s30 offen lds
    s_add_u32 m0, s26, 132096
    s_nop 0
    buffer_load_dwordx4 v9, s[8:11], s30 offen lds
    s_add_u32 m0, s26, 147456
    s_add_u32 s28, s31, 0
    buffer_load_dwordx4 v10, s[12:15], s28 offen lds
    s_add_u32 m0, s26, 148480
    s_add_u32 s28, s31, 5120
    buffer_load_dwordx4 v10, s[12:15], s28 offen lds
    s_waitcnt vmcnt(4)
    s_barrier
    s_cmp_eq_u32 s37, 1
    s_cselect_b32 s29, 4, 6
    s_add_u32 s29, s29, s36
    s_cmp_ge_u32 s29, 10
    s_cselect_b32 s30, 10, 0
    s_sub_u32 s29, s29, s30
    s_lshl_b32 s30, s29, 7
    s_add_u32 s30, s30, s24
    s_mul_i32 s31, s29, 81920
    s_add_u32 s31, s31, s25
    s_add_u32 m0, s26, 0
    s_nop 0
    buffer_load_dwordx4 v8, s[8:11], s30 offen lds
    s_add_u32 m0, s26, 1024
    s_nop 0
    buffer_load_dwordx4 v9, s[8:11], s30 offen lds
    s_add_u32 m0, s26, 16384
    s_add_u32 s28, s31, 0
    buffer_load_dwordx4 v10, s[12:15], s28 offen lds
    s_add_u32 m0, s26, 17408
    s_add_u32 s28, s31, 5120
    buffer_load_dwordx4 v10, s[12:15], s28 offen lds
    s_waitcnt vmcnt(4)
    s_barrier
    s_cmp_eq_u32 s37, 1
    s_cselect_b32 s29, 7, 5
    s_add_u32 s29, s29, s36
    s_cmp_ge_u32 s29, 10
    s_cselect_b32 s30, 10, 0
    s_sub_u32 s29, s29, s30
    s_lshl_b32 s30, s29, 7
    s_add_u32 s30, s30, s24
    s_mul_i32 s31, s29, 81920
    s_add_u32 s31, s31, s25
    s_add_u32 m0, s26, 32768
    s_nop 0
    buffer_load_dwordx4 v8, s[8:11], s30 offen lds
    s_add_u32 m0, s26, 33792
    s_nop 0
    buffer_load_dwordx4 v9, s[8:11], s30 offen lds
    s_add_u32 m0, s26, 49152
    s_add_u32 s28, s31, 0
    buffer_load_dwordx4 v10, s[12:15], s28 offen lds
    s_add_u32 m0, s26, 50176
    s_add_u32 s28, s31, 5120
    buffer_load_dwordx4 v10, s[12:15], s28 offen lds
    s_waitcnt vmcnt(4)
    s_barrier
    s_cmp_eq_u32 s37, 1
    s_cselect_b32 s29, 5, 7
    s_add_u32 s29, s29, s36
    s_cmp_ge_u32 s29, 10
    s_cselect_b32 s30, 10, 0
    s_sub_u32 s29, s29, s30
    s_lshl_b32 s30, s29, 7
    s_add_u32 s30, s30, s24
    s_mul_i32 s31, s29, 81920
    s_add_u32 s31, s31, s25
    s_add_u32 m0, s26, 65536
    s_nop 0
    buffer_load_dwordx4 v8, s[8:11], s30 offen lds
    s_add_u32 m0, s26, 66560
    s_nop 0
    buffer_load_dwordx4 v9, s[8:11], s30 offen lds
    s_add_u32 m0, s26, 81920
    s_add_u32 s28, s31, 0
    buffer_load_dwordx4 v10, s[12:15], s28 offen lds
    s_add_u32 m0, s26, 82944
    s_add_u32 s28, s31, 5120
    buffer_load_dwordx4 v10, s[12:15], s28 offen lds
    s_waitcnt vmcnt(4)
    s_barrier
    s_cmp_eq_u32 s37, 1
    s_cselect_b32 s29, 9, 8
    s_add_u32 s29, s29, s36
    s_cmp_ge_u32 s29, 10
    s_cselect_b32 s30, 10, 0
    s_sub_u32 s29, s29, s30
    s_lshl_b32 s30, s29, 7
    s_add_u32 s30, s30, s24
    s_mul_i32 s31, s29, 81920
    s_add_u32 s31, s31, s25
    s_add_u32 m0, s26, 98304
    s_nop 0
    buffer_load_dwordx4 v8, s[8:11], s30 offen lds
    s_add_u32 m0, s26, 99328
    s_nop 0
    buffer_load_dwordx4 v9, s[8:11], s30 offen lds
    s_add_u32 m0, s26, 114688
    s_add_u32 s28, s31, 0
    buffer_load_dwordx4 v10, s[12:15], s28 offen lds
    s_add_u32 m0, s26, 115712
    s_add_u32 s28, s31, 5120
    buffer_load_dwordx4 v10, s[12:15], s28 offen lds
    s_waitcnt vmcnt(4)
    s_barrier
    s_cmp_eq_u32 s37, 1
    s_cselect_b32 s29, 8, 9
    s_add_u32 s29, s29, s36
    s_cmp_ge_u32 s29, 10
    s_cselect_b32 s30, 10, 0
    s_sub_u32 s29, s29, s30
    s_lshl_b32 s30, s29, 7
    s_add_u32 s30, s30, s24
    s_mul_i32 s31, s29, 81920
    s_add_u32 s31, s31, s25
    s_add_u32 m0, s26, 131072
    s_nop 0
    buffer_load_dwordx4 v8, s[8:11], s30 offen lds
    s_add_u32 m0, s26, 132096
    s_nop 0
    buffer_load_dwordx4 v9, s[8:11], s30 offen lds
    s_add_u32 m0, s26, 147456
    s_add_u32 s28, s31, 0
    buffer_load_dwordx4 v10, s[12:15], s28 offen lds
    s_add_u32 m0, s26, 148480
    s_add_u32 s28, s31, 5120
    buffer_load_dwordx4 v10, s[12:15], s28 offen lds
    s_waitcnt vmcnt(4)
    s_barrier
    s_waitcnt vmcnt(0)
    s_barrier
    s_barrier
    ds_read_b128 v[16:19], v12 offset:0
    ds_read_b128 v[20:23], v12 offset:1088
    ds_read_b128 v[24:27], v12 offset:2176
    ds_read_b128 v[28:31], v12 offset:3264
    s_add_u32 s28, s24, s21
    s_waitcnt lgkmcnt(3)
    buffer_store_dwordx4 v[16:19], v13, s[16:19], s28 offen offset:0 sc1
    s_waitcnt lgkmcnt(2)
    s_add_u32 s29, s28, 5120
    buffer_store_dwordx4 v[20:23], v13, s[16:19], s29 offen sc1
    s_nop 0
    s_waitcnt lgkmcnt(1)
    s_add_u32 s29, s28, 10240
    buffer_store_dwordx4 v[24:27], v13, s[16:19], s29 offen sc1
    s_nop 0
    s_waitcnt lgkmcnt(0)
    s_add_u32 s29, s28, 15360
    buffer_store_dwordx4 v[28:31], v13, s[16:19], s29 offen sc1
    s_nop 0
    s_lshr_b32 s28, s20, 4
    s_add_u32 s28, s28, s22
    s_lshl_b32 s28, s28, 8
    s_lshr_b32 s29, s21, 6
    s_add_u32 s28, s28, s29
    s_add_u32 s28, s28, 0x2d0000
    v_mov_b32 v2, s28
    v_mov_b32 v3, 1
    s_mov_b64 exec, 1
    s_waitcnt vmcnt(0)
    global_store_dword v2, v3, s[4:5] sc1
    s_mov_b64 exec, -1
    s_branch gated_mix__ssm_conv_s4__grouped_kv_mqa__prompt_kernel_ph2
q_poison:
    s_load_dwordx2 s[4:5], s[0:1], 136
    s_load_dwordx2 s[12:13], s[0:1], 128
    s_load_dwordx2 s[30:31], s[0:1], 112
    s_sub_u32 s23, s2, 160
    s_and_b32 s20, s23, 15
    s_lshr_b32 s21, s23, 4
    s_lshl_b32 s25, s20, 11
    s_lshl_b32 s24, s21, 2
    s_add_u32 s25, s25, s24
    s_add_u32 s25, s25, 0x2d0000
    v_lshlrev_b32 v8, 8, v1
    v_add_u32 v8, s25, v8
    v_mov_b32 v9, 0
    s_and_b32 s27, s2, 7
    s_lshl_b32 s27, s27, 5
    s_lshr_b32 s28, s2, 6
    s_lshl_b32 s28, s28, 3
    s_or_b32 s27, s27, s28
    s_bfe_u32 s28, s2, 0x30003
    s_or_b32 s26, s27, s28
    v_lshrrev_b32 v2, 3, v1
    v_lshlrev_b32 v2, 8, v2
    v_and_b32 v3, 7, v1
    v_lshl_add_u32 v2, v3, 4, v2
    v_mov_b32 v4, -1
    v_mov_b32 v5, -1
    v_mov_b32 v6, -1
    v_mov_b32 v7, -1
    s_lshr_b32 s27, s26, 1
    s_mul_i32 s27, s27, 20480
    s_and_b32 s28, s26, 1
    s_lshl_b32 s28, s28, 7
    s_add_u32 s27, s27, s28
    s_sub_u32 s24, s6, 12
    s_lshl_b32 s28, s24, 11
    s_add_u32 s27, s27, s28
    s_lshl_b32 s32, s21, 5
    s_lshl_b32 s33, s24, 3
    s_add_u32 s32, s32, s33
    v_lshrrev_b32 v14, 3, v1
    v_add_u32 v14, s32, v14
    v_and_b32 v15, 7, v1
    v_lshlrev_b32 v10, 7, v14
    v_bfe_u32 v14, v14, 1, 3
    v_xor_b32 v13, v14, v15
    v_lshl_add_u32 v10, v13, 4, v10
    v_and_b32 v10, 0x3fff, v10
    v_add_u32 v11, 0x10000, v10
    v_add_u32 v12, 0x20000, v10
    v_lshlrev_b32 v13, 4, v13
    s_bfe_u32 s37, s23, 0x10003
    s_cmp_eq_u32 s37, 1
    s_mov_b32 s34, 0x75643120
    s_mov_b32 s35, 0x57461302
    s_cselect_b32 s34, s35, s34
    s_mov_b32 s35, 0x98
    s_mov_b32 s38, 0x89
    s_cselect_b32 s35, s38, s35
    s_lshl_b32 s36, s21, 1
    v_bfe_u32 v18, v1, 3, 3
    v_lshlrev_b32 v18, 2, v18
    v_bfe_u32 v18, s34, v18, 4
    v_add_u32 v18, s36, v18
    v_subrev_u32 v20, 10, v18
    v_min_u32 v18, v18, v20
    v_lshlrev_b32 v18, 7, v18
    v_lshl_add_u32 v18, v15, 4, v18
    v_bfe_u32 v19, v1, 3, 1
    v_lshlrev_b32 v19, 2, v19
    v_bfe_u32 v19, s35, v19, 4
    v_add_u32 v19, s36, v19
    v_subrev_u32 v20, 10, v19
    v_min_u32 v19, v19, v20
    v_lshlrev_b32 v19, 7, v19
    v_lshl_add_u32 v19, v15, 4, v19
    s_lshl_b32 s33, s20, 7
    s_add_u32 s32, s32, s33
    s_lshl_b32 s32, s32, 2
    v_lshrrev_b32 v14, 3, v1
    v_lshlrev_b32 v14, 2, v14
    s_lshl_b32 s36, s21, 1
    s_bfe_u32 s37, s23, 0x10003
    v_mov_b32 v104, 0
    v_mov_b32 v105, 0
    v_mov_b32 v106, 0
    v_mov_b32 v107, 0
    v_mov_b32 v108, 0
    v_mov_b32 v109, 0
    v_mov_b32 v110, 0
    v_mov_b32 v111, 0
    s_waitcnt lgkmcnt(0)
    s_add_u32 s8, s4, 0x800000
    s_addc_u32 s9, s5, 0
    s_mov_b32 s10, 0x280000
    s_mov_b32 s11, 0x00020000
    s_mov_b32 s16, s30
    s_mov_b32 s17, s31
    s_mov_b32 s18, 0x500
    s_mov_b32 s19, 0x00020000
    buffer_load_dwordx4 v[32:35], v18, s[16:19], 0 offen
    buffer_load_dwordx4 v[36:39], v19, s[16:19], 0 offen
    s_add_u32 s16, s4, 0x2b0000
    s_addc_u32 s17, s5, 0
    s_mov_b32 s18, 0x2000
    s_mov_b32 s19, 0x00020000
    s_cmp_eq_u32 s6, 12
    s_cbranch_scc0 q_nz
    s_mov_b64 exec, 0xff
    global_store_dword v8, v9, s[4:5] sc1
    s_mov_b64 exec, -1
q_nz:
    s_waitcnt lgkmcnt(0)
    s_barrier
    ds_read_b128 v[84:87], v10 offset:0
    buffer_store_dwordx4 v[4:7], v2, s[8:11], s27 offen sc1
    s_add_u32 s27, s27, 8192
    buffer_store_dwordx4 v[4:7], v2, s[8:11], s27 offen sc1
    s_cmp_lt_u32 s24, 2
    s_cbranch_scc0 q_n3
    s_add_u32 s27, s27, 8192
    buffer_store_dwordx4 v[4:7], v2, s[8:11], s27 offen sc1
q_n3:
    s_waitcnt lgkmcnt(0)
    s_barrier
    ds_read_b128 v[88:91], v10 offset:32768
    s_waitcnt vmcnt(0)
    s_waitcnt lgkmcnt(0)
    s_barrier
    ds_read_b128 v[92:95], v11 offset:0
    v_mov_b32 v2, 0
    v_mov_b32 v3, 1
    v_mov_b32 v5, 0
    s_cmp_eq_u32 s6, 12
    s_cbranch_scc0 q_na
    s_mov_b64 exec, 1
    global_atomic_add v5, v2, v3, s[12:13] sc0 sc1
    s_mov_b64 exec, -1
q_na:
    v_mov_b32 v44, v32
    v_mov_b32 v45, v33
    v_mov_b32 v46, v34
    v_mov_b32 v47, v35
    v_mov_b32 v76, v36
    v_mov_b32 v77, v37
    v_mov_b32 v78, v38
    v_mov_b32 v79, v39
    v_mov_b32_dpp v44, v32 row_shr:8 row_mask:0xf bank_mask:0xc
    v_mov_b32_dpp v45, v33 row_shr:8 row_mask:0xf bank_mask:0xc
    v_mov_b32_dpp v46, v34 row_shr:8 row_mask:0xf bank_mask:0xc
    v_mov_b32_dpp v47, v35 row_shr:8 row_mask:0xf bank_mask:0xc
    v_mov_b32_dpp v76, v36 row_shr:8 row_mask:0xf bank_mask:0xc
    v_mov_b32_dpp v77, v37 row_shr:8 row_mask:0xf bank_mask:0xc
    v_mov_b32_dpp v78, v38 row_shr:8 row_mask:0xf bank_mask:0xc
    v_mov_b32_dpp v79, v39 row_shr:8 row_mask:0xf bank_mask:0xc
    v_mov_b32 v52, v44
    v_mov_b32 v53, v45
    v_mov_b32 v54, v46
    v_mov_b32 v55, v47
    s_nop 1
    v_permlane16_swap_b32 v44, v52
    v_permlane16_swap_b32 v45, v53
    v_permlane16_swap_b32 v46, v54
    v_permlane16_swap_b32 v47, v55
    s_nop 1
    v_mov_b32 v60, v44
    v_mov_b32 v61, v45
    v_mov_b32 v62, v46
    v_mov_b32 v63, v47
    v_mov_b32 v68, v52
    v_mov_b32 v69, v53
    v_mov_b32 v70, v54
    v_mov_b32 v71, v55
    s_nop 1
    v_permlane32_swap_b32 v44, v60
    v_permlane32_swap_b32 v45, v61
    v_permlane32_swap_b32 v46, v62
    v_permlane32_swap_b32 v47, v63
    v_permlane32_swap_b32 v52, v68
    v_permlane32_swap_b32 v53, v69
    v_permlane32_swap_b32 v54, v70
    v_permlane32_swap_b32 v55, v71
    v_lshlrev_b32 v16, 16, v84
    v_and_b32 v17, 0xffff0000, v84
    v_lshlrev_b32 v24, 16, v44
    v_and_b32 v25, 0xffff0000, v44
    v_lshlrev_b32 v18, 16, v85
    v_and_b32 v19, 0xffff0000, v85
    v_lshlrev_b32 v26, 16, v45
    v_and_b32 v27, 0xffff0000, v45
    v_lshlrev_b32 v20, 16, v86
    v_and_b32 v21, 0xffff0000, v86
    v_lshlrev_b32 v28, 16, v46
    v_and_b32 v29, 0xffff0000, v46
    v_lshlrev_b32 v22, 16, v87
    v_and_b32 v23, 0xffff0000, v87
    v_lshlrev_b32 v30, 16, v47
    v_and_b32 v31, 0xffff0000, v47
    v_pk_mul_f32 v[16:17], v[16:17], v[24:25]
    v_pk_mul_f32 v[18:19], v[18:19], v[26:27]
    v_pk_mul_f32 v[20:21], v[20:21], v[28:29]
    v_pk_mul_f32 v[22:23], v[22:23], v[30:31]
    v_cvt_pk_bf16_f32 v24, v16, v17
    v_cvt_pk_bf16_f32 v25, v18, v19
    v_cvt_pk_bf16_f32 v26, v20, v21
    v_cvt_pk_bf16_f32 v27, v22, v23
    v_lshlrev_b32 v16, 16, v24
    v_and_b32 v17, 0xffff0000, v24
    v_lshlrev_b32 v18, 16, v25
    v_and_b32 v19, 0xffff0000, v25
    v_lshlrev_b32 v20, 16, v26
    v_and_b32 v21, 0xffff0000, v26
    v_lshlrev_b32 v22, 16, v27
    v_and_b32 v23, 0xffff0000, v27
    v_pk_add_f32 v[104:105], v[104:105], v[16:17]
    v_pk_add_f32 v[106:107], v[106:107], v[18:19]
    v_pk_add_f32 v[108:109], v[108:109], v[20:21]
    v_pk_add_f32 v[110:111], v[110:111], v[22:23]
    s_waitcnt lgkmcnt(0)
    s_barrier
    ds_read_b128 v[96:99], v11 offset:32768
    v_mov_b32 v48, v32
    v_mov_b32 v49, v33
    v_mov_b32 v50, v34
    v_mov_b32 v51, v35
    v_mov_b32 v80, v36
    v_mov_b32 v81, v37
    v_mov_b32 v82, v38
    v_mov_b32 v83, v39
    v_mov_b32_dpp v48, v32 row_shl:8 row_mask:0xf bank_mask:0x3
    v_mov_b32_dpp v49, v33 row_shl:8 row_mask:0xf bank_mask:0x3
    v_mov_b32_dpp v50, v34 row_shl:8 row_mask:0xf bank_mask:0x3
    v_mov_b32_dpp v51, v35 row_shl:8 row_mask:0xf bank_mask:0x3
    v_mov_b32_dpp v80, v36 row_shl:8 row_mask:0xf bank_mask:0x3
    v_mov_b32_dpp v81, v37 row_shl:8 row_mask:0xf bank_mask:0x3
    v_mov_b32_dpp v82, v38 row_shl:8 row_mask:0xf bank_mask:0x3
    v_mov_b32_dpp v83, v39 row_shl:8 row_mask:0xf bank_mask:0x3
    v_mov_b32 v56, v48
    v_mov_b32 v57, v49
    v_mov_b32 v58, v50
    v_mov_b32 v59, v51
    s_nop 1
    v_permlane16_swap_b32 v48, v56
    v_permlane16_swap_b32 v49, v57
    v_permlane16_swap_b32 v50, v58
    v_permlane16_swap_b32 v51, v59
    s_nop 1
    v_mov_b32 v64, v48
    v_mov_b32 v65, v49
    v_mov_b32 v66, v50
    v_mov_b32 v67, v51
    v_mov_b32 v72, v56
    v_mov_b32 v73, v57
    v_mov_b32 v74, v58
    v_mov_b32 v75, v59
    s_nop 1
    v_permlane32_swap_b32 v48, v64
    v_permlane32_swap_b32 v49, v65
    v_permlane32_swap_b32 v50, v66
    v_permlane32_swap_b32 v51, v67
    v_permlane32_swap_b32 v56, v72
    v_permlane32_swap_b32 v57, v73
    v_permlane32_swap_b32 v58, v74
    v_permlane32_swap_b32 v59, v75
    v_lshlrev_b32 v16, 16, v88
    v_and_b32 v17, 0xffff0000, v88
    v_lshlrev_b32 v24, 16, v48
    v_and_b32 v25, 0xffff0000, v48
    v_lshlrev_b32 v18, 16, v89
    v_and_b32 v19, 0xffff0000, v89
    v_lshlrev_b32 v26, 16, v49
    v_and_b32 v27, 0xffff0000, v49
    v_lshlrev_b32 v20, 16, v90
    v_and_b32 v21, 0xffff0000, v90
    v_lshlrev_b32 v28, 16, v50
    v_and_b32 v29, 0xffff0000, v50
    v_lshlrev_b32 v22, 16, v91
    v_and_b32 v23, 0xffff0000, v91
    v_lshlrev_b32 v30, 16, v51
    v_and_b32 v31, 0xffff0000, v51
    v_pk_mul_f32 v[16:17], v[16:17], v[24:25]
    v_pk_mul_f32 v[18:19], v[18:19], v[26:27]
    v_pk_mul_f32 v[20:21], v[20:21], v[28:29]
    v_pk_mul_f32 v[22:23], v[22:23], v[30:31]
    v_cvt_pk_bf16_f32 v24, v16, v17
    v_cvt_pk_bf16_f32 v25, v18, v19
    v_cvt_pk_bf16_f32 v26, v20, v21
    v_cvt_pk_bf16_f32 v27, v22, v23
    v_lshlrev_b32 v16, 16, v24
    v_and_b32 v17, 0xffff0000, v24
    v_lshlrev_b32 v18, 16, v25
    v_and_b32 v19, 0xffff0000, v25
    v_lshlrev_b32 v20, 16, v26
    v_and_b32 v21, 0xffff0000, v26
    v_lshlrev_b32 v22, 16, v27
    v_and_b32 v23, 0xffff0000, v27
    v_pk_add_f32 v[104:105], v[104:105], v[16:17]
    v_pk_add_f32 v[106:107], v[106:107], v[18:19]
    v_pk_add_f32 v[108:109], v[108:109], v[20:21]
    v_pk_add_f32 v[110:111], v[110:111], v[22:23]
    s_waitcnt lgkmcnt(0)
    s_barrier
    ds_read_b128 v[100:103], v12 offset:0
    v_lshlrev_b32 v16, 16, v92
    v_and_b32 v17, 0xffff0000, v92
    v_lshlrev_b32 v24, 16, v52
    v_and_b32 v25, 0xffff0000, v52
    v_lshlrev_b32 v18, 16, v93
    v_and_b32 v19, 0xffff0000, v93
    v_lshlrev_b32 v26, 16, v53
    v_and_b32 v27, 0xffff0000, v53
    v_lshlrev_b32 v20, 16, v94
    v_and_b32 v21, 0xffff0000, v94
    v_lshlrev_b32 v28, 16, v54
    v_and_b32 v29, 0xffff0000, v54
    v_lshlrev_b32 v22, 16, v95
    v_and_b32 v23, 0xffff0000, v95
    v_lshlrev_b32 v30, 16, v55
    v_and_b32 v31, 0xffff0000, v55
    v_pk_mul_f32 v[16:17], v[16:17], v[24:25]
    v_pk_mul_f32 v[18:19], v[18:19], v[26:27]
    v_pk_mul_f32 v[20:21], v[20:21], v[28:29]
    v_pk_mul_f32 v[22:23], v[22:23], v[30:31]
    v_cvt_pk_bf16_f32 v24, v16, v17
    v_cvt_pk_bf16_f32 v25, v18, v19
    v_cvt_pk_bf16_f32 v26, v20, v21
    v_cvt_pk_bf16_f32 v27, v22, v23
    v_lshlrev_b32 v16, 16, v24
    v_and_b32 v17, 0xffff0000, v24
    v_lshlrev_b32 v18, 16, v25
    v_and_b32 v19, 0xffff0000, v25
    v_lshlrev_b32 v20, 16, v26
    v_and_b32 v21, 0xffff0000, v26
    v_lshlrev_b32 v22, 16, v27
    v_and_b32 v23, 0xffff0000, v27
    v_pk_add_f32 v[104:105], v[104:105], v[16:17]
    v_pk_add_f32 v[106:107], v[106:107], v[18:19]
    v_pk_add_f32 v[108:109], v[108:109], v[20:21]
    v_pk_add_f32 v[110:111], v[110:111], v[22:23]
    s_waitcnt lgkmcnt(0)
    s_barrier
    ds_read_b128 v[84:87], v10 offset:0
    v_lshlrev_b32 v16, 16, v96
    v_and_b32 v17, 0xffff0000, v96
    v_lshlrev_b32 v24, 16, v56
    v_and_b32 v25, 0xffff0000, v56
    v_lshlrev_b32 v18, 16, v97
    v_and_b32 v19, 0xffff0000, v97
    v_lshlrev_b32 v26, 16, v57
    v_and_b32 v27, 0xffff0000, v57
    v_lshlrev_b32 v20, 16, v98
    v_and_b32 v21, 0xffff0000, v98
    v_lshlrev_b32 v28, 16, v58
    v_and_b32 v29, 0xffff0000, v58
    v_lshlrev_b32 v22, 16, v99
    v_and_b32 v23, 0xffff0000, v99
    v_lshlrev_b32 v30, 16, v59
    v_and_b32 v31, 0xffff0000, v59
    v_pk_mul_f32 v[16:17], v[16:17], v[24:25]
    v_pk_mul_f32 v[18:19], v[18:19], v[26:27]
    v_pk_mul_f32 v[20:21], v[20:21], v[28:29]
    v_pk_mul_f32 v[22:23], v[22:23], v[30:31]
    v_cvt_pk_bf16_f32 v24, v16, v17
    v_cvt_pk_bf16_f32 v25, v18, v19
    v_cvt_pk_bf16_f32 v26, v20, v21
    v_cvt_pk_bf16_f32 v27, v22, v23
    v_lshlrev_b32 v16, 16, v24
    v_and_b32 v17, 0xffff0000, v24
    v_lshlrev_b32 v18, 16, v25
    v_and_b32 v19, 0xffff0000, v25
    v_lshlrev_b32 v20, 16, v26
    v_and_b32 v21, 0xffff0000, v26
    v_lshlrev_b32 v22, 16, v27
    v_and_b32 v23, 0xffff0000, v27
    v_pk_add_f32 v[104:105], v[104:105], v[16:17]
    v_pk_add_f32 v[106:107], v[106:107], v[18:19]
    v_pk_add_f32 v[108:109], v[108:109], v[20:21]
    v_pk_add_f32 v[110:111], v[110:111], v[22:23]
    s_waitcnt lgkmcnt(0)
    s_barrier
    ds_read_b128 v[88:91], v10 offset:32768
    v_lshlrev_b32 v16, 16, v100
    v_and_b32 v17, 0xffff0000, v100
    v_lshlrev_b32 v24, 16, v60
    v_and_b32 v25, 0xffff0000, v60
    v_lshlrev_b32 v18, 16, v101
    v_and_b32 v19, 0xffff0000, v101
    v_lshlrev_b32 v26, 16, v61
    v_and_b32 v27, 0xffff0000, v61
    v_lshlrev_b32 v20, 16, v102
    v_and_b32 v21, 0xffff0000, v102
    v_lshlrev_b32 v28, 16, v62
    v_and_b32 v29, 0xffff0000, v62
    v_lshlrev_b32 v22, 16, v103
    v_and_b32 v23, 0xffff0000, v103
    v_lshlrev_b32 v30, 16, v63
    v_and_b32 v31, 0xffff0000, v63
    v_pk_mul_f32 v[16:17], v[16:17], v[24:25]
    v_pk_mul_f32 v[18:19], v[18:19], v[26:27]
    v_pk_mul_f32 v[20:21], v[20:21], v[28:29]
    v_pk_mul_f32 v[22:23], v[22:23], v[30:31]
    v_cvt_pk_bf16_f32 v24, v16, v17
    v_cvt_pk_bf16_f32 v25, v18, v19
    v_cvt_pk_bf16_f32 v26, v20, v21
    v_cvt_pk_bf16_f32 v27, v22, v23
    v_lshlrev_b32 v16, 16, v24
    v_and_b32 v17, 0xffff0000, v24
    v_lshlrev_b32 v18, 16, v25
    v_and_b32 v19, 0xffff0000, v25
    v_lshlrev_b32 v20, 16, v26
    v_and_b32 v21, 0xffff0000, v26
    v_lshlrev_b32 v22, 16, v27
    v_and_b32 v23, 0xffff0000, v27
    v_pk_add_f32 v[104:105], v[104:105], v[16:17]
    v_pk_add_f32 v[106:107], v[106:107], v[18:19]
    v_pk_add_f32 v[108:109], v[108:109], v[20:21]
    v_pk_add_f32 v[110:111], v[110:111], v[22:23]
    s_waitcnt vmcnt(0)
    v_readfirstlane_b32 s24, v5
    s_cmp_eq_u32 s24, 79
    s_cbranch_scc0 q_ar
    s_mov_b64 exec, 1
    global_store_dword v2, v3, s[12:13] offset:128 sc1
    s_mov_b64 exec, -1
q_ar:
    s_waitcnt lgkmcnt(0)
    s_barrier
    ds_read_b128 v[92:95], v11 offset:0
    v_min_u32 v2, 1, v1
    v_lshlrev_b32 v2, 2, v2
    global_load_dword v5, v2, s[12:13] offset:128 sc1
    v_lshlrev_b32 v16, 16, v84
    v_and_b32 v17, 0xffff0000, v84
    v_lshlrev_b32 v24, 16, v64
    v_and_b32 v25, 0xffff0000, v64
    v_lshlrev_b32 v18, 16, v85
    v_and_b32 v19, 0xffff0000, v85
    v_lshlrev_b32 v26, 16, v65
    v_and_b32 v27, 0xffff0000, v65
    v_lshlrev_b32 v20, 16, v86
    v_and_b32 v21, 0xffff0000, v86
    v_lshlrev_b32 v28, 16, v66
    v_and_b32 v29, 0xffff0000, v66
    v_lshlrev_b32 v22, 16, v87
    v_and_b32 v23, 0xffff0000, v87
    v_lshlrev_b32 v30, 16, v67
    v_and_b32 v31, 0xffff0000, v67
    v_pk_mul_f32 v[16:17], v[16:17], v[24:25]
    v_pk_mul_f32 v[18:19], v[18:19], v[26:27]
    v_pk_mul_f32 v[20:21], v[20:21], v[28:29]
    v_pk_mul_f32 v[22:23], v[22:23], v[30:31]
    v_cvt_pk_bf16_f32 v24, v16, v17
    v_cvt_pk_bf16_f32 v25, v18, v19
    v_cvt_pk_bf16_f32 v26, v20, v21
    v_cvt_pk_bf16_f32 v27, v22, v23
    v_lshlrev_b32 v16, 16, v24
    v_and_b32 v17, 0xffff0000, v24
    v_lshlrev_b32 v18, 16, v25
    v_and_b32 v19, 0xffff0000, v25
    v_lshlrev_b32 v20, 16, v26
    v_and_b32 v21, 0xffff0000, v26
    v_lshlrev_b32 v22, 16, v27
    v_and_b32 v23, 0xffff0000, v27
    v_pk_add_f32 v[104:105], v[104:105], v[16:17]
    v_pk_add_f32 v[106:107], v[106:107], v[18:19]
    v_pk_add_f32 v[108:109], v[108:109], v[20:21]
    v_pk_add_f32 v[110:111], v[110:111], v[22:23]
    s_waitcnt lgkmcnt(0)
    s_barrier
    ds_read_b128 v[96:99], v11 offset:32768
    v_lshlrev_b32 v16, 16, v88
    v_and_b32 v17, 0xffff0000, v88
    v_lshlrev_b32 v24, 16, v68
    v_and_b32 v25, 0xffff0000, v68
    v_lshlrev_b32 v18, 16, v89
    v_and_b32 v19, 0xffff0000, v89
    v_lshlrev_b32 v26, 16, v69
    v_and_b32 v27, 0xffff0000, v69
    v_lshlrev_b32 v20, 16, v90
    v_and_b32 v21, 0xffff0000, v90
    v_lshlrev_b32 v28, 16, v70
    v_and_b32 v29, 0xffff0000, v70
    v_lshlrev_b32 v22, 16, v91
    v_and_b32 v23, 0xffff0000, v91
    v_lshlrev_b32 v30, 16, v71
    v_and_b32 v31, 0xffff0000, v71
    v_pk_mul_f32 v[16:17], v[16:17], v[24:25]
    v_pk_mul_f32 v[18:19], v[18:19], v[26:27]
    v_pk_mul_f32 v[20:21], v[20:21], v[28:29]
    v_pk_mul_f32 v[22:23], v[22:23], v[30:31]
    v_cvt_pk_bf16_f32 v24, v16, v17
    v_cvt_pk_bf16_f32 v25, v18, v19
    v_cvt_pk_bf16_f32 v26, v20, v21
    v_cvt_pk_bf16_f32 v27, v22, v23
    v_lshlrev_b32 v16, 16, v24
    v_and_b32 v17, 0xffff0000, v24
    v_lshlrev_b32 v18, 16, v25
    v_and_b32 v19, 0xffff0000, v25
    v_lshlrev_b32 v20, 16, v26
    v_and_b32 v21, 0xffff0000, v26
    v_lshlrev_b32 v22, 16, v27
    v_and_b32 v23, 0xffff0000, v27
    v_pk_add_f32 v[104:105], v[104:105], v[16:17]
    v_pk_add_f32 v[106:107], v[106:107], v[18:19]
    v_pk_add_f32 v[108:109], v[108:109], v[20:21]
    v_pk_add_f32 v[110:111], v[110:111], v[22:23]
    s_waitcnt lgkmcnt(0)
    s_barrier
    ds_read_b128 v[100:103], v12 offset:0
    v_lshlrev_b32 v16, 16, v92
    v_and_b32 v17, 0xffff0000, v92
    v_lshlrev_b32 v24, 16, v72
    v_and_b32 v25, 0xffff0000, v72
    v_lshlrev_b32 v18, 16, v93
    v_and_b32 v19, 0xffff0000, v93
    v_lshlrev_b32 v26, 16, v73
    v_and_b32 v27, 0xffff0000, v73
    v_lshlrev_b32 v20, 16, v94
    v_and_b32 v21, 0xffff0000, v94
    v_lshlrev_b32 v28, 16, v74
    v_and_b32 v29, 0xffff0000, v74
    v_lshlrev_b32 v22, 16, v95
    v_and_b32 v23, 0xffff0000, v95
    v_lshlrev_b32 v30, 16, v75
    v_and_b32 v31, 0xffff0000, v75
    v_pk_mul_f32 v[16:17], v[16:17], v[24:25]
    v_pk_mul_f32 v[18:19], v[18:19], v[26:27]
    v_pk_mul_f32 v[20:21], v[20:21], v[28:29]
    v_pk_mul_f32 v[22:23], v[22:23], v[30:31]
    v_cvt_pk_bf16_f32 v24, v16, v17
    v_cvt_pk_bf16_f32 v25, v18, v19
    v_cvt_pk_bf16_f32 v26, v20, v21
    v_cvt_pk_bf16_f32 v27, v22, v23
    v_lshlrev_b32 v16, 16, v24
    v_and_b32 v17, 0xffff0000, v24
    v_lshlrev_b32 v18, 16, v25
    v_and_b32 v19, 0xffff0000, v25
    v_lshlrev_b32 v20, 16, v26
    v_and_b32 v21, 0xffff0000, v26
    v_lshlrev_b32 v22, 16, v27
    v_and_b32 v23, 0xffff0000, v27
    v_pk_add_f32 v[104:105], v[104:105], v[16:17]
    v_pk_add_f32 v[106:107], v[106:107], v[18:19]
    v_pk_add_f32 v[108:109], v[108:109], v[20:21]
    v_pk_add_f32 v[110:111], v[110:111], v[22:23]
    s_waitcnt lgkmcnt(0)
    s_waitcnt vmcnt(0)
    v_readfirstlane_b32 s24, v5
    s_cmp_eq_u32 s24, 1
    s_cbranch_scc1 q_fq
    v_min_u32 v2, 0, v1
    v_lshlrev_b32 v2, 2, v2
    s_mov_b32 s24, 0
q_pf1:
    global_load_dword v5, v2, s[12:13] offset:128 sc1
    s_waitcnt vmcnt(0)
    v_cmp_eq_u32 vcc, 1, v5
    s_add_u32 s24, s24, 1
    s_nop 3
    s_cmp_eq_u64 vcc, -1
    s_cbranch_scc1 q_pf1_d
    s_cmp_lt_u32 s24, 20000
    s_cbranch_scc0 q_pf1_d
    s_sleep 4
    s_branch q_pf1
q_pf1_d:
q_fq:
    v_min_u32 v2, 1, v1
    v_lshlrev_b32 v2, 2, v2
    global_load_dword v5, v2, s[12:13] offset:128 sc1
    s_barrier
    v_lshlrev_b32 v16, 16, v96
    v_and_b32 v17, 0xffff0000, v96
    v_lshlrev_b32 v24, 16, v76
    v_and_b32 v25, 0xffff0000, v76
    v_lshlrev_b32 v18, 16, v97
    v_and_b32 v19, 0xffff0000, v97
    v_lshlrev_b32 v26, 16, v77
    v_and_b32 v27, 0xffff0000, v77
    v_lshlrev_b32 v20, 16, v98
    v_and_b32 v21, 0xffff0000, v98
    v_lshlrev_b32 v28, 16, v78
    v_and_b32 v29, 0xffff0000, v78
    v_lshlrev_b32 v22, 16, v99
    v_and_b32 v23, 0xffff0000, v99
    v_lshlrev_b32 v30, 16, v79
    v_and_b32 v31, 0xffff0000, v79
    v_pk_mul_f32 v[16:17], v[16:17], v[24:25]
    v_pk_mul_f32 v[18:19], v[18:19], v[26:27]
    v_pk_mul_f32 v[20:21], v[20:21], v[28:29]
    v_pk_mul_f32 v[22:23], v[22:23], v[30:31]
    v_cvt_pk_bf16_f32 v24, v16, v17
    v_cvt_pk_bf16_f32 v25, v18, v19
    v_cvt_pk_bf16_f32 v26, v20, v21
    v_cvt_pk_bf16_f32 v27, v22, v23
    v_lshlrev_b32 v16, 16, v24
    v_and_b32 v17, 0xffff0000, v24
    v_lshlrev_b32 v18, 16, v25
    v_and_b32 v19, 0xffff0000, v25
    v_lshlrev_b32 v20, 16, v26
    v_and_b32 v21, 0xffff0000, v26
    v_lshlrev_b32 v22, 16, v27
    v_and_b32 v23, 0xffff0000, v27
    v_pk_add_f32 v[104:105], v[104:105], v[16:17]
    v_pk_add_f32 v[106:107], v[106:107], v[18:19]
    v_pk_add_f32 v[108:109], v[108:109], v[20:21]
    v_pk_add_f32 v[110:111], v[110:111], v[22:23]
    v_lshlrev_b32 v16, 16, v100
    v_and_b32 v17, 0xffff0000, v100
    v_lshlrev_b32 v24, 16, v80
    v_and_b32 v25, 0xffff0000, v80
    v_lshlrev_b32 v18, 16, v101
    v_and_b32 v19, 0xffff0000, v101
    v_lshlrev_b32 v26, 16, v81
    v_and_b32 v27, 0xffff0000, v81
    v_lshlrev_b32 v20, 16, v102
    v_and_b32 v21, 0xffff0000, v102
    v_lshlrev_b32 v28, 16, v82
    v_and_b32 v29, 0xffff0000, v82
    v_lshlrev_b32 v22, 16, v103
    v_and_b32 v23, 0xffff0000, v103
    v_lshlrev_b32 v30, 16, v83
    v_and_b32 v31, 0xffff0000, v83
    v_pk_mul_f32 v[16:17], v[16:17], v[24:25]
    v_pk_mul_f32 v[18:19], v[18:19], v[26:27]
    v_pk_mul_f32 v[20:21], v[20:21], v[28:29]
    v_pk_mul_f32 v[22:23], v[22:23], v[30:31]
    v_cvt_pk_bf16_f32 v24, v16, v17
    v_cvt_pk_bf16_f32 v25, v18, v19
    v_cvt_pk_bf16_f32 v26, v20, v21
    v_cvt_pk_bf16_f32 v27, v22, v23
    v_lshlrev_b32 v16, 16, v24
    v_and_b32 v17, 0xffff0000, v24
    v_lshlrev_b32 v18, 16, v25
    v_and_b32 v19, 0xffff0000, v25
    v_lshlrev_b32 v20, 16, v26
    v_and_b32 v21, 0xffff0000, v26
    v_lshlrev_b32 v22, 16, v27
    v_and_b32 v23, 0xffff0000, v27
    v_pk_add_f32 v[104:105], v[104:105], v[16:17]
    v_pk_add_f32 v[106:107], v[106:107], v[18:19]
    v_pk_add_f32 v[108:109], v[108:109], v[20:21]
    v_pk_add_f32 v[110:111], v[110:111], v[22:23]
    v_pk_add_f32 v[104:105], v[104:105], v[106:107]
    v_pk_add_f32 v[108:109], v[108:109], v[110:111]
    v_pk_add_f32 v[104:105], v[104:105], v[108:109]
    v_add_f32 v104, v104, v105
    s_nop 1
    v_add_f32_dpp v104, v104, v104 row_shr:1 row_mask:0xf bank_mask:0xf bound_ctrl:0
    s_nop 1
    v_add_f32_dpp v104, v104, v104 row_shr:2 row_mask:0xf bank_mask:0xf bound_ctrl:0
    s_nop 1
    v_add_f32_dpp v104, v104, v104 row_shr:4 row_mask:0xf bank_mask:0xf bound_ctrl:0
    v_cvt_pk_bf16_f32 v104, v104, v104
    v_lshlrev_b32 v104, 16, v104
    v_mul_f32 v104, 0xbfb8aa3b, v104
    v_exp_f32 v104, v104
    s_nop 0
    v_add_f32 v104, 1.0, v104
    v_rcp_f32 v104, v104
    s_nop 0
    v_cvt_pk_bf16_f32 v104, v104, v104
    v_lshlrev_b32 v104, 16, v104
    s_cmp_lt_u32 s21, 4
    s_cbranch_scc0 q_ngs
    s_mov_b32 exec_lo, 0x80808080
    s_mov_b32 exec_hi, 0x80808080
    buffer_store_dword v104, v14, s[16:19], s32 offen sc1
    s_mov_b64 exec, -1
q_ngs:
    v_min_u32 v2, 0, v1
    v_lshlrev_b32 v2, 2, v2
    s_mov_b32 s24, 0
q_pf2:
    global_load_dword v5, v2, s[12:13] offset:132 sc1
    s_waitcnt vmcnt(0)
    v_cmp_eq_u32 vcc, 1, v5
    s_add_u32 s24, s24, 1
    s_nop 3
    s_cmp_eq_u64 vcc, -1
    s_cbranch_scc1 q_pf2_d
    s_cmp_lt_u32 s24, 20000
    s_cbranch_scc0 q_pf2_d
    s_sleep 4
    s_branch q_pf2
q_pf2_d:
    s_branch gated_mix__ssm_conv_s4__grouped_kv_mqa__prompt_kernel_ph2
q_comp:
    s_and_b32 s24, s6, 1
    s_lshl_b32 s24, s24, 13
    v_and_b32 v2, 31, v1
    v_bfe_u32 v3, v1, 1, 3
    v_lshrrev_b32 v4, 5, v1
    v_xor_b32 v3, v3, v4
    v_lshlrev_b32 v2, 7, v2
    v_add_u32 v2, s24, v2
    v_xor_b32 v4, 0, v3
    v_lshl_add_u32 v8, v4, 4, v2
    v_xor_b32 v4, 2, v3
    v_lshl_add_u32 v9, v4, 4, v2
    v_xor_b32 v4, 4, v3
    v_lshl_add_u32 v10, v4, 4, v2
    v_xor_b32 v4, 6, v3
    v_lshl_add_u32 v11, v4, 4, v2
    v_lshrrev_b32 v2, 5, v1
    v_bfe_u32 v3, v1, 2, 2
    v_lshl_add_u32 v2, v2, 3, v3
    v_lshlrev_b32 v2, 8, v2
    v_bfe_u32 v4, v1, 1, 1
    v_lshl_add_u32 v2, v4, 3, v2
    v_add_u32 v2, 16384, v2
    v_and_b32 v4, 1, v1
    v_lshlrev_b32 v4, 2, v4
    v_bfe_u32 v5, v1, 4, 1
    v_or_b32 v4, v4, v5
    s_lshr_b32 s25, s6, 1
    s_lshl_b32 s25, s25, 3
    v_or_b32 v4, s25, v4
    v_and_b32 v5, 1, v3
    v_lshlrev_b32 v5, 1, v5
    v_xor_b32 v4, v4, v5
    v_lshrrev_b32 v5, 1, v3
    v_lshlrev_b32 v5, 3, v5
    v_xor_b32 v4, v4, v5
    v_lshl_add_u32 v12, v4, 4, v2
    v_xor_b32 v4, 2, v4
    v_lshl_add_u32 v13, v4, 4, v2
    v_and_b32 v2, 31, v1
    v_mul_u32_u24 v14, 272, v2
    v_lshrrev_b32 v2, 5, v1
    v_lshl_add_u32 v14, v2, 6, v14
    s_and_b32 s24, s6, 1
    s_mul_i32 s24, s24, 36864
    s_lshl_b32 s25, s25, 4
    s_add_u32 s24, s24, s25
    v_add_u32 v14, s24, v14
    s_barrier
    ds_read_b128 v[16:19], v8 offset:0
    ds_read_b128 v[20:23], v8 offset:4096
    ds_read_b64_tr_b16 v[32:33], v12 offset:0
    ds_read_b64_tr_b16 v[34:35], v12 offset:1024
    ds_read_b64_tr_b16 v[36:37], v13 offset:0
    ds_read_b64_tr_b16 v[38:39], v13 offset:1024
    ds_read_b128 v[24:27], v9 offset:0
    ds_read_b128 v[28:31], v9 offset:4096
    ds_read_b64_tr_b16 v[40:41], v12 offset:4096
    ds_read_b64_tr_b16 v[42:43], v12 offset:5120
    ds_read_b64_tr_b16 v[44:45], v13 offset:4096
    ds_read_b64_tr_b16 v[46:47], v13 offset:5120
    s_waitcnt lgkmcnt(6)
    v_mfma_f32_32x32x16_bf16 v[64:79], v[32:35], v[16:19], 0
    v_mfma_f32_32x32x16_bf16 v[80:95], v[36:39], v[16:19], 0
    v_mfma_f32_32x32x16_bf16 v[96:111], v[32:35], v[20:23], 0
    v_mfma_f32_32x32x16_bf16 v[112:127], v[36:39], v[20:23], 0
    ds_read_b128 v[16:19], v10 offset:0
    ds_read_b128 v[20:23], v10 offset:4096
    ds_read_b64_tr_b16 v[32:33], v12 offset:8192
    ds_read_b64_tr_b16 v[34:35], v12 offset:9216
    ds_read_b64_tr_b16 v[36:37], v13 offset:8192
    ds_read_b64_tr_b16 v[38:39], v13 offset:9216
    s_waitcnt lgkmcnt(6)
    v_mfma_f32_32x32x16_bf16 v[64:79], v[40:43], v[24:27], v[64:79]
    v_mfma_f32_32x32x16_bf16 v[80:95], v[44:47], v[24:27], v[80:95]
    v_mfma_f32_32x32x16_bf16 v[96:111], v[40:43], v[28:31], v[96:111]
    v_mfma_f32_32x32x16_bf16 v[112:127], v[44:47], v[28:31], v[112:127]
    ds_read_b128 v[24:27], v11 offset:0
    ds_read_b128 v[28:31], v11 offset:4096
    ds_read_b64_tr_b16 v[40:41], v12 offset:12288
    ds_read_b64_tr_b16 v[42:43], v12 offset:13312
    ds_read_b64_tr_b16 v[44:45], v13 offset:12288
    ds_read_b64_tr_b16 v[46:47], v13 offset:13312
    s_waitcnt lgkmcnt(6)
    v_mfma_f32_32x32x16_bf16 v[64:79], v[32:35], v[16:19], v[64:79]
    s_barrier
    v_mfma_f32_32x32x16_bf16 v[80:95], v[36:39], v[16:19], v[80:95]
    v_mfma_f32_32x32x16_bf16 v[96:111], v[32:35], v[20:23], v[96:111]
    v_mfma_f32_32x32x16_bf16 v[112:127], v[36:39], v[20:23], v[112:127]
    ds_read_b128 v[16:19], v8 offset:32768
    ds_read_b128 v[20:23], v8 offset:36864
    ds_read_b64_tr_b16 v[32:33], v12 offset:32768
    ds_read_b64_tr_b16 v[34:35], v12 offset:33792
    ds_read_b64_tr_b16 v[36:37], v13 offset:32768
    ds_read_b64_tr_b16 v[38:39], v13 offset:33792
    s_waitcnt lgkmcnt(6)
    v_mfma_f32_32x32x16_bf16 v[64:79], v[40:43], v[24:27], v[64:79]
    v_mfma_f32_32x32x16_bf16 v[80:95], v[44:47], v[24:27], v[80:95]
    v_mfma_f32_32x32x16_bf16 v[96:111], v[40:43], v[28:31], v[96:111]
    v_mfma_f32_32x32x16_bf16 v[112:127], v[44:47], v[28:31], v[112:127]
    ds_read_b128 v[24:27], v9 offset:32768
    ds_read_b128 v[28:31], v9 offset:36864
    ds_read_b64_tr_b16 v[40:41], v12 offset:36864
    ds_read_b64_tr_b16 v[42:43], v12 offset:37888
    ds_read_b64_tr_b16 v[44:45], v13 offset:36864
    ds_read_b64_tr_b16 v[46:47], v13 offset:37888
    s_waitcnt lgkmcnt(6)
    v_mfma_f32_32x32x16_bf16 v[64:79], v[32:35], v[16:19], v[64:79]
    v_mfma_f32_32x32x16_bf16 v[80:95], v[36:39], v[16:19], v[80:95]
    v_mfma_f32_32x32x16_bf16 v[96:111], v[32:35], v[20:23], v[96:111]
    v_mfma_f32_32x32x16_bf16 v[112:127], v[36:39], v[20:23], v[112:127]
    ds_read_b128 v[16:19], v10 offset:32768
    ds_read_b128 v[20:23], v10 offset:36864
    ds_read_b64_tr_b16 v[32:33], v12 offset:40960
    ds_read_b64_tr_b16 v[34:35], v12 offset:41984
    ds_read_b64_tr_b16 v[36:37], v13 offset:40960
    ds_read_b64_tr_b16 v[38:39], v13 offset:41984
    s_waitcnt lgkmcnt(6)
    v_mfma_f32_32x32x16_bf16 v[64:79], v[40:43], v[24:27], v[64:79]
    v_mfma_f32_32x32x16_bf16 v[80:95], v[44:47], v[24:27], v[80:95]
    v_mfma_f32_32x32x16_bf16 v[96:111], v[40:43], v[28:31], v[96:111]
    v_mfma_f32_32x32x16_bf16 v[112:127], v[44:47], v[28:31], v[112:127]
    ds_read_b128 v[24:27], v11 offset:32768
    ds_read_b128 v[28:31], v11 offset:36864
    ds_read_b64_tr_b16 v[40:41], v12 offset:45056
    ds_read_b64_tr_b16 v[42:43], v12 offset:46080
    ds_read_b64_tr_b16 v[44:45], v13 offset:45056
    ds_read_b64_tr_b16 v[46:47], v13 offset:46080
    s_waitcnt lgkmcnt(6)
    v_mfma_f32_32x32x16_bf16 v[64:79], v[32:35], v[16:19], v[64:79]
    s_barrier
    v_mfma_f32_32x32x16_bf16 v[80:95], v[36:39], v[16:19], v[80:95]
    v_mfma_f32_32x32x16_bf16 v[96:111], v[32:35], v[20:23], v[96:111]
    v_mfma_f32_32x32x16_bf16 v[112:127], v[36:39], v[20:23], v[112:127]
    v_add_u32 v8, 65536, v8
    v_add_u32 v9, 65536, v9
    v_add_u32 v10, 65536, v10
    v_add_u32 v11, 65536, v11
    v_add_u32 v12, 65536, v12
    v_add_u32 v13, 65536, v13
    ds_read_b128 v[16:19], v8 offset:0
    ds_read_b128 v[20:23], v8 offset:4096
    ds_read_b64_tr_b16 v[32:33], v12 offset:0
    ds_read_b64_tr_b16 v[34:35], v12 offset:1024
    ds_read_b64_tr_b16 v[36:37], v13 offset:0
    ds_read_b64_tr_b16 v[38:39], v13 offset:1024
    s_waitcnt lgkmcnt(6)
    v_mfma_f32_32x32x16_bf16 v[64:79], v[40:43], v[24:27], v[64:79]
    v_mfma_f32_32x32x16_bf16 v[80:95], v[44:47], v[24:27], v[80:95]
    v_mfma_f32_32x32x16_bf16 v[96:111], v[40:43], v[28:31], v[96:111]
    v_mfma_f32_32x32x16_bf16 v[112:127], v[44:47], v[28:31], v[112:127]
    ds_read_b128 v[24:27], v9 offset:0
    ds_read_b128 v[28:31], v9 offset:4096
    ds_read_b64_tr_b16 v[40:41], v12 offset:4096
    ds_read_b64_tr_b16 v[42:43], v12 offset:5120
    ds_read_b64_tr_b16 v[44:45], v13 offset:4096
    ds_read_b64_tr_b16 v[46:47], v13 offset:5120
    s_waitcnt lgkmcnt(6)
    v_mfma_f32_32x32x16_bf16 v[64:79], v[32:35], v[16:19], v[64:79]
    v_mfma_f32_32x32x16_bf16 v[80:95], v[36:39], v[16:19], v[80:95]
    v_mfma_f32_32x32x16_bf16 v[96:111], v[32:35], v[20:23], v[96:111]
    v_mfma_f32_32x32x16_bf16 v[112:127], v[36:39], v[20:23], v[112:127]
    ds_read_b128 v[16:19], v10 offset:0
    ds_read_b128 v[20:23], v10 offset:4096
    ds_read_b64_tr_b16 v[32:33], v12 offset:8192
    ds_read_b64_tr_b16 v[34:35], v12 offset:9216
    ds_read_b64_tr_b16 v[36:37], v13 offset:8192
    ds_read_b64_tr_b16 v[38:39], v13 offset:9216
    s_waitcnt lgkmcnt(6)
    v_mfma_f32_32x32x16_bf16 v[64:79], v[40:43], v[24:27], v[64:79]
    v_mfma_f32_32x32x16_bf16 v[80:95], v[44:47], v[24:27], v[80:95]
    v_mfma_f32_32x32x16_bf16 v[96:111], v[40:43], v[28:31], v[96:111]
    v_mfma_f32_32x32x16_bf16 v[112:127], v[44:47], v[28:31], v[112:127]
    ds_read_b128 v[24:27], v11 offset:0
    ds_read_b128 v[28:31], v11 offset:4096
    ds_read_b64_tr_b16 v[40:41], v12 offset:12288
    ds_read_b64_tr_b16 v[42:43], v12 offset:13312
    ds_read_b64_tr_b16 v[44:45], v13 offset:12288
    ds_read_b64_tr_b16 v[46:47], v13 offset:13312
    s_waitcnt lgkmcnt(6)
    v_mfma_f32_32x32x16_bf16 v[64:79], v[32:35], v[16:19], v[64:79]
    s_barrier
    v_mfma_f32_32x32x16_bf16 v[80:95], v[36:39], v[16:19], v[80:95]
    v_mfma_f32_32x32x16_bf16 v[96:111], v[32:35], v[20:23], v[96:111]
    v_mfma_f32_32x32x16_bf16 v[112:127], v[36:39], v[20:23], v[112:127]
    ds_read_b128 v[16:19], v8 offset:32768
    ds_read_b128 v[20:23], v8 offset:36864
    ds_read_b64_tr_b16 v[32:33], v12 offset:32768
    ds_read_b64_tr_b16 v[34:35], v12 offset:33792
    ds_read_b64_tr_b16 v[36:37], v13 offset:32768
    ds_read_b64_tr_b16 v[38:39], v13 offset:33792
    s_waitcnt lgkmcnt(6)
    v_mfma_f32_32x32x16_bf16 v[64:79], v[40:43], v[24:27], v[64:79]
    v_mfma_f32_32x32x16_bf16 v[80:95], v[44:47], v[24:27], v[80:95]
    v_mfma_f32_32x32x16_bf16 v[96:111], v[40:43], v[28:31], v[96:111]
    v_mfma_f32_32x32x16_bf16 v[112:127], v[44:47], v[28:31], v[112:127]
    ds_read_b128 v[24:27], v9 offset:32768
    ds_read_b128 v[28:31], v9 offset:36864
    ds_read_b64_tr_b16 v[40:41], v12 offset:36864
    ds_read_b64_tr_b16 v[42:43], v12 offset:37888
    ds_read_b64_tr_b16 v[44:45], v13 offset:36864
    ds_read_b64_tr_b16 v[46:47], v13 offset:37888
    s_waitcnt lgkmcnt(6)
    v_mfma_f32_32x32x16_bf16 v[64:79], v[32:35], v[16:19], v[64:79]
    v_mfma_f32_32x32x16_bf16 v[80:95], v[36:39], v[16:19], v[80:95]
    v_mfma_f32_32x32x16_bf16 v[96:111], v[32:35], v[20:23], v[96:111]
    v_mfma_f32_32x32x16_bf16 v[112:127], v[36:39], v[20:23], v[112:127]
    ds_read_b128 v[16:19], v10 offset:32768
    ds_read_b128 v[20:23], v10 offset:36864
    ds_read_b64_tr_b16 v[32:33], v12 offset:40960
    ds_read_b64_tr_b16 v[34:35], v12 offset:41984
    ds_read_b64_tr_b16 v[36:37], v13 offset:40960
    ds_read_b64_tr_b16 v[38:39], v13 offset:41984
    s_waitcnt lgkmcnt(6)
    v_mfma_f32_32x32x16_bf16 v[64:79], v[40:43], v[24:27], v[64:79]
    v_mfma_f32_32x32x16_bf16 v[80:95], v[44:47], v[24:27], v[80:95]
    v_mfma_f32_32x32x16_bf16 v[96:111], v[40:43], v[28:31], v[96:111]
    v_mfma_f32_32x32x16_bf16 v[112:127], v[44:47], v[28:31], v[112:127]
    ds_read_b128 v[24:27], v11 offset:32768
    ds_read_b128 v[28:31], v11 offset:36864
    ds_read_b64_tr_b16 v[40:41], v12 offset:45056
    ds_read_b64_tr_b16 v[42:43], v12 offset:46080
    ds_read_b64_tr_b16 v[44:45], v13 offset:45056
    ds_read_b64_tr_b16 v[46:47], v13 offset:46080
    s_waitcnt lgkmcnt(6)
    v_mfma_f32_32x32x16_bf16 v[64:79], v[32:35], v[16:19], v[64:79]
    s_barrier
    v_mfma_f32_32x32x16_bf16 v[80:95], v[36:39], v[16:19], v[80:95]
    v_mfma_f32_32x32x16_bf16 v[96:111], v[32:35], v[20:23], v[96:111]
    v_mfma_f32_32x32x16_bf16 v[112:127], v[36:39], v[20:23], v[112:127]
    v_add_u32 v8, 65536, v8
    v_add_u32 v9, 65536, v9
    v_add_u32 v10, 65536, v10
    v_add_u32 v11, 65536, v11
    v_add_u32 v12, 65536, v12
    v_add_u32 v13, 65536, v13
    ds_read_b128 v[16:19], v8 offset:0
    ds_read_b128 v[20:23], v8 offset:4096
    ds_read_b64_tr_b16 v[32:33], v12 offset:0
    ds_read_b64_tr_b16 v[34:35], v12 offset:1024
    ds_read_b64_tr_b16 v[36:37], v13 offset:0
    ds_read_b64_tr_b16 v[38:39], v13 offset:1024
    s_waitcnt lgkmcnt(6)
    v_mfma_f32_32x32x16_bf16 v[64:79], v[40:43], v[24:27], v[64:79]
    v_mfma_f32_32x32x16_bf16 v[80:95], v[44:47], v[24:27], v[80:95]
    v_mfma_f32_32x32x16_bf16 v[96:111], v[40:43], v[28:31], v[96:111]
    v_mfma_f32_32x32x16_bf16 v[112:127], v[44:47], v[28:31], v[112:127]
    ds_read_b128 v[24:27], v9 offset:0
    ds_read_b128 v[28:31], v9 offset:4096
    ds_read_b64_tr_b16 v[40:41], v12 offset:4096
    ds_read_b64_tr_b16 v[42:43], v12 offset:5120
    ds_read_b64_tr_b16 v[44:45], v13 offset:4096
    ds_read_b64_tr_b16 v[46:47], v13 offset:5120
    s_waitcnt lgkmcnt(6)
    v_mfma_f32_32x32x16_bf16 v[64:79], v[32:35], v[16:19], v[64:79]
    v_mfma_f32_32x32x16_bf16 v[80:95], v[36:39], v[16:19], v[80:95]
    v_mfma_f32_32x32x16_bf16 v[96:111], v[32:35], v[20:23], v[96:111]
    v_mfma_f32_32x32x16_bf16 v[112:127], v[36:39], v[20:23], v[112:127]
    ds_read_b128 v[16:19], v10 offset:0
    ds_read_b128 v[20:23], v10 offset:4096
    ds_read_b64_tr_b16 v[32:33], v12 offset:8192
    ds_read_b64_tr_b16 v[34:35], v12 offset:9216
    ds_read_b64_tr_b16 v[36:37], v13 offset:8192
    ds_read_b64_tr_b16 v[38:39], v13 offset:9216
    s_waitcnt lgkmcnt(6)
    v_mfma_f32_32x32x16_bf16 v[64:79], v[40:43], v[24:27], v[64:79]
    v_mfma_f32_32x32x16_bf16 v[80:95], v[44:47], v[24:27], v[80:95]
    v_mfma_f32_32x32x16_bf16 v[96:111], v[40:43], v[28:31], v[96:111]
    v_mfma_f32_32x32x16_bf16 v[112:127], v[44:47], v[28:31], v[112:127]
    ds_read_b128 v[24:27], v11 offset:0
    ds_read_b128 v[28:31], v11 offset:4096
    ds_read_b64_tr_b16 v[40:41], v12 offset:12288
    ds_read_b64_tr_b16 v[42:43], v12 offset:13312
    ds_read_b64_tr_b16 v[44:45], v13 offset:12288
    ds_read_b64_tr_b16 v[46:47], v13 offset:13312
    s_waitcnt lgkmcnt(6)
    v_mfma_f32_32x32x16_bf16 v[64:79], v[32:35], v[16:19], v[64:79]
    s_barrier
    v_mfma_f32_32x32x16_bf16 v[80:95], v[36:39], v[16:19], v[80:95]
    v_mfma_f32_32x32x16_bf16 v[96:111], v[32:35], v[20:23], v[96:111]
    v_mfma_f32_32x32x16_bf16 v[112:127], v[36:39], v[20:23], v[112:127]
    v_add_u32 v8, 4294836224, v8
    v_add_u32 v9, 4294836224, v9
    v_add_u32 v10, 4294836224, v10
    v_add_u32 v11, 4294836224, v11
    v_add_u32 v12, 4294836224, v12
    v_add_u32 v13, 4294836224, v13
    ds_read_b128 v[16:19], v8 offset:0
    ds_read_b128 v[20:23], v8 offset:4096
    ds_read_b64_tr_b16 v[32:33], v12 offset:0
    ds_read_b64_tr_b16 v[34:35], v12 offset:1024
    ds_read_b64_tr_b16 v[36:37], v13 offset:0
    ds_read_b64_tr_b16 v[38:39], v13 offset:1024
    s_waitcnt lgkmcnt(6)
    v_mfma_f32_32x32x16_bf16 v[64:79], v[40:43], v[24:27], v[64:79]
    v_mfma_f32_32x32x16_bf16 v[80:95], v[44:47], v[24:27], v[80:95]
    v_mfma_f32_32x32x16_bf16 v[96:111], v[40:43], v[28:31], v[96:111]
    v_mfma_f32_32x32x16_bf16 v[112:127], v[44:47], v[28:31], v[112:127]
    ds_read_b128 v[24:27], v9 offset:0
    ds_read_b128 v[28:31], v9 offset:4096
    ds_read_b64_tr_b16 v[40:41], v12 offset:4096
    ds_read_b64_tr_b16 v[42:43], v12 offset:5120
    ds_read_b64_tr_b16 v[44:45], v13 offset:4096
    ds_read_b64_tr_b16 v[46:47], v13 offset:5120
    s_waitcnt lgkmcnt(6)
    v_mfma_f32_32x32x16_bf16 v[64:79], v[32:35], v[16:19], v[64:79]
    v_mfma_f32_32x32x16_bf16 v[80:95], v[36:39], v[16:19], v[80:95]
    v_mfma_f32_32x32x16_bf16 v[96:111], v[32:35], v[20:23], v[96:111]
    v_mfma_f32_32x32x16_bf16 v[112:127], v[36:39], v[20:23], v[112:127]
    ds_read_b128 v[16:19], v10 offset:0
    ds_read_b128 v[20:23], v10 offset:4096
    ds_read_b64_tr_b16 v[32:33], v12 offset:8192
    ds_read_b64_tr_b16 v[34:35], v12 offset:9216
    ds_read_b64_tr_b16 v[36:37], v13 offset:8192
    ds_read_b64_tr_b16 v[38:39], v13 offset:9216
    s_waitcnt lgkmcnt(6)
    v_mfma_f32_32x32x16_bf16 v[64:79], v[40:43], v[24:27], v[64:79]
    v_mfma_f32_32x32x16_bf16 v[80:95], v[44:47], v[24:27], v[80:95]
    v_mfma_f32_32x32x16_bf16 v[96:111], v[40:43], v[28:31], v[96:111]
    v_mfma_f32_32x32x16_bf16 v[112:127], v[44:47], v[28:31], v[112:127]
    ds_read_b128 v[24:27], v11 offset:0
    ds_read_b128 v[28:31], v11 offset:4096
    ds_read_b64_tr_b16 v[40:41], v12 offset:12288
    ds_read_b64_tr_b16 v[42:43], v12 offset:13312
    ds_read_b64_tr_b16 v[44:45], v13 offset:12288
    ds_read_b64_tr_b16 v[46:47], v13 offset:13312
    s_waitcnt lgkmcnt(6)
    v_mfma_f32_32x32x16_bf16 v[64:79], v[32:35], v[16:19], v[64:79]
    s_barrier
    v_mfma_f32_32x32x16_bf16 v[80:95], v[36:39], v[16:19], v[80:95]
    v_mfma_f32_32x32x16_bf16 v[96:111], v[32:35], v[20:23], v[96:111]
    v_mfma_f32_32x32x16_bf16 v[112:127], v[36:39], v[20:23], v[112:127]
    ds_read_b128 v[16:19], v8 offset:32768
    ds_read_b128 v[20:23], v8 offset:36864
    ds_read_b64_tr_b16 v[32:33], v12 offset:32768
    ds_read_b64_tr_b16 v[34:35], v12 offset:33792
    ds_read_b64_tr_b16 v[36:37], v13 offset:32768
    ds_read_b64_tr_b16 v[38:39], v13 offset:33792
    s_waitcnt lgkmcnt(6)
    v_mfma_f32_32x32x16_bf16 v[64:79], v[40:43], v[24:27], v[64:79]
    v_mfma_f32_32x32x16_bf16 v[80:95], v[44:47], v[24:27], v[80:95]
    v_mfma_f32_32x32x16_bf16 v[96:111], v[40:43], v[28:31], v[96:111]
    v_mfma_f32_32x32x16_bf16 v[112:127], v[44:47], v[28:31], v[112:127]
    ds_read_b128 v[24:27], v9 offset:32768
    ds_read_b128 v[28:31], v9 offset:36864
    ds_read_b64_tr_b16 v[40:41], v12 offset:36864
    ds_read_b64_tr_b16 v[42:43], v12 offset:37888
    ds_read_b64_tr_b16 v[44:45], v13 offset:36864
    ds_read_b64_tr_b16 v[46:47], v13 offset:37888
    s_waitcnt lgkmcnt(6)
    v_mfma_f32_32x32x16_bf16 v[64:79], v[32:35], v[16:19], v[64:79]
    v_mfma_f32_32x32x16_bf16 v[80:95], v[36:39], v[16:19], v[80:95]
    v_mfma_f32_32x32x16_bf16 v[96:111], v[32:35], v[20:23], v[96:111]
    v_mfma_f32_32x32x16_bf16 v[112:127], v[36:39], v[20:23], v[112:127]
    ds_read_b128 v[16:19], v10 offset:32768
    ds_read_b128 v[20:23], v10 offset:36864
    ds_read_b64_tr_b16 v[32:33], v12 offset:40960
    ds_read_b64_tr_b16 v[34:35], v12 offset:41984
    ds_read_b64_tr_b16 v[36:37], v13 offset:40960
    ds_read_b64_tr_b16 v[38:39], v13 offset:41984
    s_waitcnt lgkmcnt(6)
    v_mfma_f32_32x32x16_bf16 v[64:79], v[40:43], v[24:27], v[64:79]
    v_mfma_f32_32x32x16_bf16 v[80:95], v[44:47], v[24:27], v[80:95]
    v_mfma_f32_32x32x16_bf16 v[96:111], v[40:43], v[28:31], v[96:111]
    v_mfma_f32_32x32x16_bf16 v[112:127], v[44:47], v[28:31], v[112:127]
    ds_read_b128 v[24:27], v11 offset:32768
    ds_read_b128 v[28:31], v11 offset:36864
    ds_read_b64_tr_b16 v[40:41], v12 offset:45056
    ds_read_b64_tr_b16 v[42:43], v12 offset:46080
    ds_read_b64_tr_b16 v[44:45], v13 offset:45056
    ds_read_b64_tr_b16 v[46:47], v13 offset:46080
    s_waitcnt lgkmcnt(6)
    v_mfma_f32_32x32x16_bf16 v[64:79], v[32:35], v[16:19], v[64:79]
    s_barrier
    v_mfma_f32_32x32x16_bf16 v[80:95], v[36:39], v[16:19], v[80:95]
    v_mfma_f32_32x32x16_bf16 v[96:111], v[32:35], v[20:23], v[96:111]
    v_mfma_f32_32x32x16_bf16 v[112:127], v[36:39], v[20:23], v[112:127]
    v_add_u32 v8, 65536, v8
    v_add_u32 v9, 65536, v9
    v_add_u32 v10, 65536, v10
    v_add_u32 v11, 65536, v11
    v_add_u32 v12, 65536, v12
    v_add_u32 v13, 65536, v13
    ds_read_b128 v[16:19], v8 offset:0
    ds_read_b128 v[20:23], v8 offset:4096
    ds_read_b64_tr_b16 v[32:33], v12 offset:0
    ds_read_b64_tr_b16 v[34:35], v12 offset:1024
    ds_read_b64_tr_b16 v[36:37], v13 offset:0
    ds_read_b64_tr_b16 v[38:39], v13 offset:1024
    s_waitcnt lgkmcnt(6)
    v_mfma_f32_32x32x16_bf16 v[64:79], v[40:43], v[24:27], v[64:79]
    v_mfma_f32_32x32x16_bf16 v[80:95], v[44:47], v[24:27], v[80:95]
    v_mfma_f32_32x32x16_bf16 v[96:111], v[40:43], v[28:31], v[96:111]
    v_mfma_f32_32x32x16_bf16 v[112:127], v[44:47], v[28:31], v[112:127]
    ds_read_b128 v[24:27], v9 offset:0
    ds_read_b128 v[28:31], v9 offset:4096
    ds_read_b64_tr_b16 v[40:41], v12 offset:4096
    ds_read_b64_tr_b16 v[42:43], v12 offset:5120
    ds_read_b64_tr_b16 v[44:45], v13 offset:4096
    ds_read_b64_tr_b16 v[46:47], v13 offset:5120
    s_waitcnt lgkmcnt(6)
    v_mfma_f32_32x32x16_bf16 v[64:79], v[32:35], v[16:19], v[64:79]
    v_mfma_f32_32x32x16_bf16 v[80:95], v[36:39], v[16:19], v[80:95]
    v_mfma_f32_32x32x16_bf16 v[96:111], v[32:35], v[20:23], v[96:111]
    v_mfma_f32_32x32x16_bf16 v[112:127], v[36:39], v[20:23], v[112:127]
    ds_read_b128 v[16:19], v10 offset:0
    ds_read_b128 v[20:23], v10 offset:4096
    ds_read_b64_tr_b16 v[32:33], v12 offset:8192
    ds_read_b64_tr_b16 v[34:35], v12 offset:9216
    ds_read_b64_tr_b16 v[36:37], v13 offset:8192
    ds_read_b64_tr_b16 v[38:39], v13 offset:9216
    s_waitcnt lgkmcnt(6)
    v_mfma_f32_32x32x16_bf16 v[64:79], v[40:43], v[24:27], v[64:79]
    v_mfma_f32_32x32x16_bf16 v[80:95], v[44:47], v[24:27], v[80:95]
    v_mfma_f32_32x32x16_bf16 v[96:111], v[40:43], v[28:31], v[96:111]
    v_mfma_f32_32x32x16_bf16 v[112:127], v[44:47], v[28:31], v[112:127]
    ds_read_b128 v[24:27], v11 offset:0
    ds_read_b128 v[28:31], v11 offset:4096
    ds_read_b64_tr_b16 v[40:41], v12 offset:12288
    ds_read_b64_tr_b16 v[42:43], v12 offset:13312
    ds_read_b64_tr_b16 v[44:45], v13 offset:12288
    ds_read_b64_tr_b16 v[46:47], v13 offset:13312
    s_waitcnt lgkmcnt(6)
    v_mfma_f32_32x32x16_bf16 v[64:79], v[32:35], v[16:19], v[64:79]
    s_barrier
    v_mfma_f32_32x32x16_bf16 v[80:95], v[36:39], v[16:19], v[80:95]
    v_mfma_f32_32x32x16_bf16 v[96:111], v[32:35], v[20:23], v[96:111]
    v_mfma_f32_32x32x16_bf16 v[112:127], v[36:39], v[20:23], v[112:127]
    ds_read_b128 v[16:19], v8 offset:32768
    ds_read_b128 v[20:23], v8 offset:36864
    ds_read_b64_tr_b16 v[32:33], v12 offset:32768
    ds_read_b64_tr_b16 v[34:35], v12 offset:33792
    ds_read_b64_tr_b16 v[36:37], v13 offset:32768
    ds_read_b64_tr_b16 v[38:39], v13 offset:33792
    s_waitcnt lgkmcnt(6)
    v_mfma_f32_32x32x16_bf16 v[64:79], v[40:43], v[24:27], v[64:79]
    v_mfma_f32_32x32x16_bf16 v[80:95], v[44:47], v[24:27], v[80:95]
    v_mfma_f32_32x32x16_bf16 v[96:111], v[40:43], v[28:31], v[96:111]
    v_mfma_f32_32x32x16_bf16 v[112:127], v[44:47], v[28:31], v[112:127]
    ds_read_b128 v[24:27], v9 offset:32768
    ds_read_b128 v[28:31], v9 offset:36864
    ds_read_b64_tr_b16 v[40:41], v12 offset:36864
    ds_read_b64_tr_b16 v[42:43], v12 offset:37888
    ds_read_b64_tr_b16 v[44:45], v13 offset:36864
    ds_read_b64_tr_b16 v[46:47], v13 offset:37888
    s_waitcnt lgkmcnt(6)
    v_mfma_f32_32x32x16_bf16 v[64:79], v[32:35], v[16:19], v[64:79]
    v_mfma_f32_32x32x16_bf16 v[80:95], v[36:39], v[16:19], v[80:95]
    v_mfma_f32_32x32x16_bf16 v[96:111], v[32:35], v[20:23], v[96:111]
    v_mfma_f32_32x32x16_bf16 v[112:127], v[36:39], v[20:23], v[112:127]
    ds_read_b128 v[16:19], v10 offset:32768
    ds_read_b128 v[20:23], v10 offset:36864
    ds_read_b64_tr_b16 v[32:33], v12 offset:40960
    ds_read_b64_tr_b16 v[34:35], v12 offset:41984
    ds_read_b64_tr_b16 v[36:37], v13 offset:40960
    ds_read_b64_tr_b16 v[38:39], v13 offset:41984
    s_waitcnt lgkmcnt(6)
    v_mfma_f32_32x32x16_bf16 v[64:79], v[40:43], v[24:27], v[64:79]
    v_mfma_f32_32x32x16_bf16 v[80:95], v[44:47], v[24:27], v[80:95]
    v_mfma_f32_32x32x16_bf16 v[96:111], v[40:43], v[28:31], v[96:111]
    v_mfma_f32_32x32x16_bf16 v[112:127], v[44:47], v[28:31], v[112:127]
    ds_read_b128 v[24:27], v11 offset:32768
    ds_read_b128 v[28:31], v11 offset:36864
    ds_read_b64_tr_b16 v[40:41], v12 offset:45056
    ds_read_b64_tr_b16 v[42:43], v12 offset:46080
    ds_read_b64_tr_b16 v[44:45], v13 offset:45056
    ds_read_b64_tr_b16 v[46:47], v13 offset:46080
    s_waitcnt lgkmcnt(6)
    v_mfma_f32_32x32x16_bf16 v[64:79], v[32:35], v[16:19], v[64:79]
    s_barrier
    v_mfma_f32_32x32x16_bf16 v[80:95], v[36:39], v[16:19], v[80:95]
    v_mfma_f32_32x32x16_bf16 v[96:111], v[32:35], v[20:23], v[96:111]
    v_mfma_f32_32x32x16_bf16 v[112:127], v[36:39], v[20:23], v[112:127]
    v_add_u32 v8, 65536, v8
    v_add_u32 v9, 65536, v9
    v_add_u32 v10, 65536, v10
    v_add_u32 v11, 65536, v11
    v_add_u32 v12, 65536, v12
    v_add_u32 v13, 65536, v13
    ds_read_b128 v[16:19], v8 offset:0
    ds_read_b128 v[20:23], v8 offset:4096
    ds_read_b64_tr_b16 v[32:33], v12 offset:0
    ds_read_b64_tr_b16 v[34:35], v12 offset:1024
    ds_read_b64_tr_b16 v[36:37], v13 offset:0
    ds_read_b64_tr_b16 v[38:39], v13 offset:1024
    s_waitcnt lgkmcnt(6)
    v_mfma_f32_32x32x16_bf16 v[64:79], v[40:43], v[24:27], v[64:79]
    v_mfma_f32_32x32x16_bf16 v[80:95], v[44:47], v[24:27], v[80:95]
    v_mfma_f32_32x32x16_bf16 v[96:111], v[40:43], v[28:31], v[96:111]
    v_mfma_f32_32x32x16_bf16 v[112:127], v[44:47], v[28:31], v[112:127]
    ds_read_b128 v[24:27], v9 offset:0
    ds_read_b128 v[28:31], v9 offset:4096
    ds_read_b64_tr_b16 v[40:41], v12 offset:4096
    ds_read_b64_tr_b16 v[42:43], v12 offset:5120
    ds_read_b64_tr_b16 v[44:45], v13 offset:4096
    ds_read_b64_tr_b16 v[46:47], v13 offset:5120
    s_waitcnt lgkmcnt(6)
    v_mfma_f32_32x32x16_bf16 v[64:79], v[32:35], v[16:19], v[64:79]
    v_mfma_f32_32x32x16_bf16 v[80:95], v[36:39], v[16:19], v[80:95]
    v_mfma_f32_32x32x16_bf16 v[96:111], v[32:35], v[20:23], v[96:111]
    v_mfma_f32_32x32x16_bf16 v[112:127], v[36:39], v[20:23], v[112:127]
    ds_read_b128 v[16:19], v10 offset:0
    ds_read_b128 v[20:23], v10 offset:4096
    ds_read_b64_tr_b16 v[32:33], v12 offset:8192
    ds_read_b64_tr_b16 v[34:35], v12 offset:9216
    ds_read_b64_tr_b16 v[36:37], v13 offset:8192
    ds_read_b64_tr_b16 v[38:39], v13 offset:9216
    s_waitcnt lgkmcnt(6)
    v_mfma_f32_32x32x16_bf16 v[64:79], v[40:43], v[24:27], v[64:79]
    v_mfma_f32_32x32x16_bf16 v[80:95], v[44:47], v[24:27], v[80:95]
    v_mfma_f32_32x32x16_bf16 v[96:111], v[40:43], v[28:31], v[96:111]
    v_mfma_f32_32x32x16_bf16 v[112:127], v[44:47], v[28:31], v[112:127]
    ds_read_b128 v[24:27], v11 offset:0
    ds_read_b128 v[28:31], v11 offset:4096
    ds_read_b64_tr_b16 v[40:41], v12 offset:12288
    ds_read_b64_tr_b16 v[42:43], v12 offset:13312
    ds_read_b64_tr_b16 v[44:45], v13 offset:12288
    ds_read_b64_tr_b16 v[46:47], v13 offset:13312
    s_waitcnt lgkmcnt(6)
    v_mfma_f32_32x32x16_bf16 v[64:79], v[32:35], v[16:19], v[64:79]
    v_mfma_f32_32x32x16_bf16 v[80:95], v[36:39], v[16:19], v[80:95]
    v_mfma_f32_32x32x16_bf16 v[96:111], v[32:35], v[20:23], v[96:111]
    v_mfma_f32_32x32x16_bf16 v[112:127], v[36:39], v[20:23], v[112:127]
    s_waitcnt lgkmcnt(0)
    v_mfma_f32_32x32x16_bf16 v[64:79], v[40:43], v[24:27], v[64:79]
    v_mfma_f32_32x32x16_bf16 v[80:95], v[44:47], v[24:27], v[80:95]
    v_mfma_f32_32x32x16_bf16 v[96:111], v[40:43], v[28:31], v[96:111]
    v_mfma_f32_32x32x16_bf16 v[112:127], v[44:47], v[28:31], v[112:127]
    s_nop 7
    s_nop 3
    v_cvt_pk_bf16_f32 v64, v64, v65
    v_cvt_pk_bf16_f32 v65, v66, v67
    v_cvt_pk_bf16_f32 v66, v68, v69
    v_cvt_pk_bf16_f32 v67, v70, v71
    v_cvt_pk_bf16_f32 v68, v72, v73
    v_cvt_pk_bf16_f32 v69, v74, v75
    v_cvt_pk_bf16_f32 v70, v76, v77
    v_cvt_pk_bf16_f32 v71, v78, v79
    ds_write_b128 v14, v[64:67] offset:0
    ds_write_b128 v14, v[68:71] offset:16
    v_cvt_pk_bf16_f32 v80, v80, v81
    v_cvt_pk_bf16_f32 v81, v82, v83
    v_cvt_pk_bf16_f32 v82, v84, v85
    v_cvt_pk_bf16_f32 v83, v86, v87
    v_cvt_pk_bf16_f32 v84, v88, v89
    v_cvt_pk_bf16_f32 v85, v90, v91
    v_cvt_pk_bf16_f32 v86, v92, v93
    v_cvt_pk_bf16_f32 v87, v94, v95
    ds_write_b128 v14, v[80:83] offset:32
    ds_write_b128 v14, v[84:87] offset:48
    v_cvt_pk_bf16_f32 v96, v96, v97
    v_cvt_pk_bf16_f32 v97, v98, v99
    v_cvt_pk_bf16_f32 v98, v100, v101
    v_cvt_pk_bf16_f32 v99, v102, v103
    v_cvt_pk_bf16_f32 v100, v104, v105
    v_cvt_pk_bf16_f32 v101, v106, v107
    v_cvt_pk_bf16_f32 v102, v108, v109
    v_cvt_pk_bf16_f32 v103, v110, v111
    ds_write_b128 v14, v[96:99] offset:8704
    ds_write_b128 v14, v[100:103] offset:8720
    v_cvt_pk_bf16_f32 v112, v112, v113
    v_cvt_pk_bf16_f32 v113, v114, v115
    v_cvt_pk_bf16_f32 v114, v116, v117
    v_cvt_pk_bf16_f32 v115, v118, v119
    v_cvt_pk_bf16_f32 v116, v120, v121
    v_cvt_pk_bf16_f32 v117, v122, v123
    v_cvt_pk_bf16_f32 v118, v124, v125
    v_cvt_pk_bf16_f32 v119, v126, v127
    ds_write_b128 v14, v[112:115] offset:8736
    ds_write_b128 v14, v[116:119] offset:8752
    s_waitcnt lgkmcnt(0)
    s_barrier
    s_branch gated_mix__ssm_conv_s4__grouped_kv_mqa__prompt_kernel_ph2
k1_ssm:
    s_load_dwordx16 s[16:31], s[0:1], 0
    s_load_dwordx2 s[32:33], s[0:1], 64
    s_load_dwordx2 s[4:5], s[0:1], 136
    s_and_b32 s10, s2, 7
    s_mul_i32 s10, s10, 20
    s_lshr_b32 s11, s2, 3
    s_add_u32 s10, s10, s11
    s_lshl_b32 s7, s10, 2
    s_cmp_lt_u32 s6, 8
    s_cbranch_scc1 ssm_main
    s_cmp_lt_u32 s6, 12
    s_cbranch_scc0 ssm_lp2
    s_setprio 3
    s_branch ssm_lp3
ssm_lp2:
    s_setprio 2
ssm_lp3:
    s_load_dwordx2 s[82:83], s[0:1], 104
    s_load_dwordx2 s[76:77], s[0:1], 80
    s_sub_u32 s10, s6, 8
    s_lshr_b32 s50, s10, 2
    s_and_b32 s51, s10, 3
    s_lshr_b32 s53, s2, 3
    s_mul_i32 s53, s53, 5
    s_add_u32 s53, s53, s51
    s_add_u32 s52, s53, 0
    s_and_b32 s52, s52, 15
    s_lshl_b32 s52, s52, 6
    s_lshl_b32 s54, s50, 10
    s_add_u32 s84, s52, s54
    s_add_u32 s52, s53, 4
    s_and_b32 s52, s52, 15
    s_lshl_b32 s52, s52, 6
    s_lshl_b32 s54, s50, 10
    s_add_u32 s85, s52, s54
    s_add_u32 s52, s53, 8
    s_and_b32 s52, s52, 15
    s_lshl_b32 s52, s52, 6
    s_lshl_b32 s54, s50, 10
    s_add_u32 s86, s52, s54
    s_add_u32 s52, s53, 12
    s_and_b32 s52, s52, 15
    s_lshl_b32 s52, s52, 6
    s_lshl_b32 s54, s50, 10
    s_add_u32 s87, s52, s54
    v_mul_u32_u24 v2, 1280, v1
    s_lshl_b32 s11, s7, 1
    v_mov_b32 v16, 0
    v_mov_b32 v17, 0
    v_mov_b32 v18, 0
    v_mov_b32 v19, 0
    s_mul_i32 s34, s10, 4576
    s_add_u32 s34, s34, 139264
    v_lshlrev_b32 v3, 4, v1
    v_add_u32 v3, s34, v3
    s_cmp_lt_u32 s10, 4
    s_cbranch_scc0 ssm_nz
    s_mov_b32 exec_lo, 0x3fffffff
    s_mov_b32 exec_hi, 0
    ds_write_b128 v3, v[16:19]
    s_mov_b64 exec, -1
ssm_nz:
    s_cmp_eq_u32 s10, 4
    s_cbranch_scc0 ssm_nf
    v_lshlrev_b32 v3, 2, v1
    v_add_u32 v3, 157696, v3
    ds_write_b32 v3, v16
ssm_nf:
    v_lshlrev_b32 v3, 1, v1
    v_add_u32 v3, 139744, v3
    s_lshl_b32 s34, s84, 1
    v_add_u32 v4, s34, v3
    s_lshl_b32 s34, s85, 1
    v_add_u32 v5, s34, v3
    s_lshl_b32 s34, s86, 1
    v_add_u32 v6, s34, v3
    s_lshl_b32 s34, s87, 1
    v_add_u32 v7, s34, v3
    s_lshl_b32 s34, s50, 2
    s_add_u32 s34, s34, 157824
    v_mov_b32 v20, s34
    v_mov_b32 v21, 1
    s_waitcnt lgkmcnt(0)
    s_mov_b32 s12, s16
    s_mov_b32 s13, s17
    s_mov_b32 s14, 0x280000
    s_mov_b32 s15, 0x00020000
    s_barrier
    s_lshr_b32 s78, s2, 3
    s_lshl_b32 s78, s78, 3
    s_add_u32 s78, s78, s10
    v_lshlrev_b32 v77, 7, v1
    s_cmp_lt_u32 s78, 100
    s_cbranch_scc0 ssm_pf1
    s_mov_b32 s72, s76
    s_mov_b32 s73, s77
    s_mov_b32 s74, 0xc8000
    s_mov_b32 s75, 0x00020000
    s_lshl_b32 s79, s78, 13
    buffer_load_dword v76, v77, s[72:75], s79 offen
    s_branch ssm_pf2
ssm_pf1:
    s_sub_u32 s78, s78, 100
    s_cmp_ge_u32 s78, 20
    s_cselect_b32 s79, 8, 0
    s_cselect_b32 s80, 20, 0
    s_sub_u32 s78, s78, s80
    s_and_b32 s80, s2, 7
    s_add_u32 s79, s79, s80
    s_mul_i32 s79, s79, 163840
    s_lshl_b32 s80, s78, 13
    s_add_u32 s79, s79, s80
    s_cmp_ge_u32 s78, 20
    s_cselect_b32 s79, 0x400000, s79
    buffer_load_dword v76, v77, s[12:15], s79 offen
ssm_pf2:
    s_mul_i32 s34, s84, 1280
    s_add_u32 s34, s34, s11
    buffer_load_dwordx2 v[8:9], v2, s[12:15], s34 offen
    s_mul_i32 s34, s85, 1280
    s_add_u32 s34, s34, s11
    buffer_load_dwordx2 v[10:11], v2, s[12:15], s34 offen
    s_mul_i32 s34, s86, 1280
    s_add_u32 s34, s34, s11
    buffer_load_dwordx2 v[12:13], v2, s[12:15], s34 offen
    s_mul_i32 s34, s87, 1280
    s_add_u32 s34, s34, s11
    buffer_load_dwordx2 v[14:15], v2, s[12:15], s34 offen
    v_mov_b32 v25, 0
    s_waitcnt vmcnt(3)
    ds_write_b16 v4, v8 offset:0
    ds_write_b16_d16_hi v4, v8 offset:4576
    ds_write_b16 v4, v9 offset:9152
    ds_write_b16_d16_hi v4, v9 offset:13728
    s_waitcnt vmcnt(2)
    ds_write_b16 v5, v10 offset:0
    ds_write_b16_d16_hi v5, v10 offset:4576
    ds_write_b16 v5, v11 offset:9152
    ds_write_b16_d16_hi v5, v11 offset:13728
    s_waitcnt vmcnt(1)
    ds_write_b16 v6, v12 offset:0
    ds_write_b16_d16_hi v6, v12 offset:4576
    ds_write_b16 v6, v13 offset:9152
    ds_write_b16_d16_hi v6, v13 offset:13728
    s_waitcnt vmcnt(0)
    ds_write_b16 v7, v14 offset:0
    ds_write_b16_d16_hi v7, v14 offset:4576
    ds_write_b16 v7, v15 offset:9152
    ds_write_b16_d16_hi v7, v15 offset:13728
    s_waitcnt lgkmcnt(0)
    s_mov_b64 exec, 1
    ds_add_u32 v20, v21 offset:0
    s_mov_b64 exec, -1
    s_setprio 0
    s_cmp_eq_u32 s6, 8
    s_cbranch_scc0 ssm_nwo
    s_cmp_lt_u32 s2, 100
    s_cbranch_scc0 ssm_nwo
    v_lshrrev_b32 v28, 4, v1
    v_and_b32 v29, 15, v1
    v_lshrrev_b32 v27, 1, v29
    v_mul_u32_u24 v27, 20480, v27
    v_lshl_add_u32 v27, v28, 8, v27
    v_and_b32 v28, 1, v29
    v_lshl_add_u32 v27, v28, 7, v27
    v_lshlrev_b32 v28, 7, v1
    s_mov_b32 s50, 0x05040100
    s_mov_b32 s51, 0x07060302
    s_mul_i32 s52, s2, 205
    s_lshr_b32 s52, s52, 10
    s_mul_i32 s53, s52, 5
    s_sub_u32 s53, s2, s53
    s_mov_b32 s90, 0x14304200
    s_mov_b32 s91, 0x9108187
    s_lshl_b32 s54, s52, 5
    v_lshrrev_b32 v30, 4, v1
    v_lshlrev_b32 v30, 3, v30
    v_add_u32 v30, s54, v30
    v_add_u32 v31, 0, v30
    v_mul_u32_u24 v23, 1639, v31
    v_lshrrev_b32 v23, 16, v23
    v_mul_u32_u24 v26, 40, v23
    v_sub_u32 v31, v31, v26
    v_lshrrev_b32 v31, 2, v31
    v_mul_u32_u24 v31, 6, v31
    v_lshrrev_b64 v[16:17], v31, s[90:91]
    v_and_b32 v23, 63, v16
    v_add_u32 v26, v26, v23
    v_mul_u32_u24 v26, 1280, v26
    v_lshl_add_u32 v26, v29, 4, v26
    v_add_u32 v31, 4, v30
    v_mul_u32_u24 v23, 1639, v31
    v_lshrrev_b32 v23, 16, v23
    v_mul_u32_u24 v22, 40, v23
    v_sub_u32 v31, v31, v22
    v_lshrrev_b32 v31, 2, v31
    v_mul_u32_u24 v31, 6, v31
    v_lshrrev_b64 v[16:17], v31, s[90:91]
    v_and_b32 v23, 63, v16
    v_add_u32 v22, v22, v23
    v_mul_u32_u24 v22, 1280, v22
    v_lshl_add_u32 v22, v29, 4, v22
    s_lshl_b32 s96, s53, 8
    s_mul_i32 s54, s53, 163840
    s_lshl_b32 s57, s52, 10
    s_add_u32 s58, s54, s57
    s_mov_b32 s84, s82
    s_mov_b32 s85, s83
    s_mov_b32 s86, 0xc8000
    s_mov_b32 s87, 0x00020000
    s_add_u32 s88, s4, 0x300000
    s_addc_u32 s89, s5, 0
    s_mov_b32 s90, 0xc8000
    s_mov_b32 s91, 0x00020000
    s_add_u32 s92, s4, 0x2c0000
    s_addc_u32 s93, s5, 0
    s_mov_b32 s94, 0x1000
    s_mov_b32 s95, 0x00020000
    buffer_load_dwordx4 v[80:83], v26, s[84:87], s96 offen offset:0
    buffer_load_dwordx4 v[84:87], v26, s[84:87], s96 offen offset:1280
    buffer_load_dwordx4 v[88:91], v26, s[84:87], s96 offen offset:2560
    buffer_load_dwordx4 v[92:95], v26, s[84:87], s96 offen offset:3840
    buffer_load_dwordx4 v[96:99], v22, s[84:87], s96 offen offset:0
    buffer_load_dwordx4 v[100:103], v22, s[84:87], s96 offen offset:1280
    buffer_load_dwordx4 v[104:107], v22, s[84:87], s96 offen offset:2560
    buffer_load_dwordx4 v[108:111], v22, s[84:87], s96 offen offset:3840
    s_cmp_eq_u32 s2, 0
    s_cbranch_scc0 ssm_wnz
    buffer_store_dword v25, v28, s[92:95], 0 offen
    s_waitcnt vmcnt(9)
    s_branch ssm_wn2
ssm_wnz:
    s_waitcnt vmcnt(8)
ssm_wn2:
    s_waitcnt vmcnt(0)
    v_perm_b32 v112, v84, v80, s50
    v_perm_b32 v113, v92, v88, s50
    v_perm_b32 v114, v100, v96, s50
    v_perm_b32 v115, v108, v104, s50
    buffer_store_dwordx4 v[112:115], v27, s[88:91], s58 offen offset:0 sc1
    v_perm_b32 v116, v84, v80, s51
    v_perm_b32 v117, v92, v88, s51
    v_perm_b32 v118, v100, v96, s51
    v_perm_b32 v119, v108, v104, s51
    buffer_store_dwordx4 v[116:119], v27, s[88:91], s58 offen offset:16 sc1
    v_perm_b32 v120, v85, v81, s50
    v_perm_b32 v121, v93, v89, s50
    v_perm_b32 v122, v101, v97, s50
    v_perm_b32 v123, v109, v105, s50
    buffer_store_dwordx4 v[120:123], v27, s[88:91], s58 offen offset:32 sc1
    v_perm_b32 v124, v85, v81, s51
    v_perm_b32 v125, v93, v89, s51
    v_perm_b32 v126, v101, v97, s51
    v_perm_b32 v127, v109, v105, s51
    buffer_store_dwordx4 v[124:127], v27, s[88:91], s58 offen offset:48 sc1
    v_perm_b32 v112, v86, v82, s50
    v_perm_b32 v113, v94, v90, s50
    v_perm_b32 v114, v102, v98, s50
    v_perm_b32 v115, v110, v106, s50
    buffer_store_dwordx4 v[112:115], v27, s[88:91], s58 offen offset:64 sc1
    v_perm_b32 v116, v86, v82, s51
    v_perm_b32 v117, v94, v90, s51
    v_perm_b32 v118, v102, v98, s51
    v_perm_b32 v119, v110, v106, s51
    buffer_store_dwordx4 v[116:119], v27, s[88:91], s58 offen offset:80 sc1
    v_perm_b32 v120, v87, v83, s50
    v_perm_b32 v121, v95, v91, s50
    v_perm_b32 v122, v103, v99, s50
    v_perm_b32 v123, v111, v107, s50
    buffer_store_dwordx4 v[120:123], v27, s[88:91], s58 offen offset:96 sc1
    v_perm_b32 v124, v87, v83, s51
    v_perm_b32 v125, v95, v91, s51
    v_perm_b32 v126, v103, v99, s51
    v_perm_b32 v127, v111, v107, s51
    buffer_store_dwordx4 v[124:127], v27, s[88:91], s58 offen offset:112 sc1
    s_branch ssm_ldone
ssm_nwo:
    s_waitcnt vmcnt(0)
ssm_ldone:
    s_branch gated_mix__ssm_conv_s4__grouped_kv_mqa__prompt_kernel_ph2
ssm_main:
    s_lshr_b32 s8, s6, 1
    s_and_b32 s9, s6, 1
    v_mov_b32 v8, 0
    v_mov_b32 v9, 0
    v_mov_b32 v10, 0
    v_mov_b32 v11, 0
    v_mov_b32 v12, 0
    v_mov_b32 v13, 0
    s_add_u32 s10, s7, s8
    s_lshl_b32 s11, s10, 8
    s_lshl_b32 s34, s9, 7
    s_add_u32 s11, s11, s34
    v_lshlrev_b32 v2, 1, v1
    v_add_u32 v2, s11, v2
    s_lshl_b32 s11, s7, 1
    s_waitcnt lgkmcnt(0)
    global_load_short_d16_hi v8, v2, s[18:19]
    global_load_short_d16_hi v9, v2, s[20:21]
    global_load_short_d16_hi v10, v2, s[22:23]
    global_load_short_d16_hi v11, v2, s[24:25]
    global_load_short_d16_hi v12, v2, s[26:27]
    global_load_short_d16_hi v13, v2, s[28:29]
    s_load_dwordx2 s[34:35], s[30:31], s11
    s_load_dwordx2 s[40:41], s[32:33], s11
    s_barrier
    s_add_u32 s36, s4, 0xa80000
    s_addc_u32 s37, s5, 0
    s_mov_b32 s38, 0x280000
    s_mov_b32 s39, 0x00020000
    s_mul_i32 s42, s6, 17408
    v_lshlrev_b32 v50, 2, v1
    v_add_u32 v50, s42, v50
    s_waitcnt lgkmcnt(0)
    s_bitcmp1_b32 s8, 1
    s_cselect_b32 s43, s35, s34
    s_lshl_b32 s45, s43, 16
    s_and_b32 s43, s43, 0xffff0000
    s_bitcmp1_b32 s8, 0
    s_cselect_b32 s43, s43, s45
    s_bitcmp1_b32 s8, 1
    s_cselect_b32 s44, s41, s40
    s_lshl_b32 s45, s44, 16
    s_and_b32 s44, s44, 0xffff0000
    s_bitcmp1_b32 s8, 0
    s_cselect_b32 s44, s44, s45
    v_mov_b32 v6, s43
    v_mul_f32 v6, 0x3fb8aa3b, v6
    v_exp_f32 v6, v6
    s_nop 0
    v_cvt_pk_bf16_f32 v6, v6, v6
    v_and_b32 v6, 0xffff0000, v6
    s_waitcnt vmcnt(0)
    v_mul_f32 v14, v6, v8
    v_mul_f32 v15, v6, v9
    v_mul_f32 v10, v6, v10
    v_mul_f32 v11, v6, v11
    v_mul_f32 v14, 0x3fb8aa3b, v14
    v_mul_f32 v15, 0x3e22f983, v15
    v_mul_f32 v2, 0x41000000, v14
    v_mul_f32 v3, 0x41000000, v15
    v_exp_f32 v2, v2
    v_fract_f32 v3, v3
    v_cos_f32 v22, v3
    v_sin_f32 v23, v3
    s_nop 0
    v_mul_f32 v22, v22, v2
    v_mul_f32 v23, v23, v2
    v_exp_f32 v2, v14
    v_fract_f32 v3, v15
    v_cos_f32 v16, v3
    v_sin_f32 v17, v3
    s_nop 0
    v_mul_f32 v16, v16, v2
    v_mul_f32 v17, v17, v2
    v_pk_mul_f32 v[42:43], v[10:11], v[12:13] op_sel_hi:[0,1]
    v_pk_fma_f32 v[30:31], v[10:11], v[12:13], v[42:43] op_sel:[1,1,0] op_sel_hi:[1,0,1] neg_lo:[1,0,0]
    v_xor_b32 v31, 0x80000000, v31
    v_mul_f32 v2, 0x43800000, v14
    v_mul_f32 v3, 0x43800000, v15
    v_exp_f32 v2, v2
    v_fract_f32 v3, v3
    v_cos_f32 v24, v3
    v_sin_f32 v25, v3
    s_nop 0
    v_mul_f32 v24, v24, v2
    v_mul_f32 v25, v25, v2
    v_mul_f32 v2, 0x44000000, v14
    v_mul_f32 v3, 0x44000000, v15
    v_exp_f32 v2, v2
    v_fract_f32 v3, v3
    v_cos_f32 v26, v3
    v_sin_f32 v27, v3
    s_nop 0
    v_mul_f32 v26, v26, v2
    v_mul_f32 v27, v27, v2
    v_mul_f32 v2, 0x44800000, v14
    v_mul_f32 v3, 0x44800000, v15
    v_exp_f32 v2, v2
    v_fract_f32 v3, v3
    v_cos_f32 v28, v3
    v_sin_f32 v29, v3
    s_nop 0
    v_mul_f32 v28, v28, v2
    v_mul_f32 v29, v29, v2
    v_pk_mul_f32 v[42:43], v[16:17], v[16:17] op_sel_hi:[0,1]
    v_pk_fma_f32 v[18:19], v[16:17], v[16:17], v[42:43] op_sel:[1,1,0] op_sel_hi:[1,0,1] neg_lo:[1,0,0]
    v_pk_mul_f32 v[44:45], v[18:19], v[18:19] op_sel_hi:[0,1]
    v_pk_fma_f32 v[20:21], v[18:19], v[18:19], v[44:45] op_sel:[1,1,0] op_sel_hi:[1,0,1] neg_lo:[1,0,0]
    v_mov_b32 v49, 0x3f80
    ds_write_b32 v50, v49 offset:8704
    v_cvt_pk_bf16_f32 v46, v30, v31
    ds_write_b32 v50, v46 offset:2992
    v_cvt_pk_bf16_f32 v47, v22, v23
    ds_write_b32 v50, v47 offset:8976
    v_pk_mul_f32 v[44:45], v[16:17], v[30:31] op_sel_hi:[0,1]
    v_pk_fma_f32 v[34:35], v[16:17], v[30:31], v[44:45] op_sel:[1,1,0] op_sel_hi:[1,0,1] neg_hi:[1,0,0]
    v_cvt_pk_bf16_f32 v48, v34, v35
    ds_write_b32 v50, v48 offset:2720
    v_pk_mul_f32 v[42:43], v[22:23], v[22:23] op_sel_hi:[0,1]
    v_pk_fma_f32 v[38:39], v[22:23], v[22:23], v[42:43] op_sel:[1,1,0] op_sel_hi:[1,0,1] neg_lo:[1,0,0]
    v_cvt_pk_bf16_f32 v49, v38, v39
    ds_write_b32 v50, v49 offset:9248
    v_pk_mul_f32 v[44:45], v[16:17], v[34:35] op_sel_hi:[0,1]
    v_pk_fma_f32 v[32:33], v[16:17], v[34:35], v[44:45] op_sel:[1,1,0] op_sel_hi:[1,0,1] neg_hi:[1,0,0]
    v_cvt_pk_bf16_f32 v46, v32, v33
    ds_write_b32 v50, v46 offset:2448
    v_pk_mul_f32 v[42:43], v[22:23], v[38:39] op_sel_hi:[0,1]
    v_pk_fma_f32 v[40:41], v[22:23], v[38:39], v[42:43] op_sel:[1,1,0] op_sel_hi:[1,0,1] neg_lo:[1,0,0]
    v_cvt_pk_bf16_f32 v47, v40, v41
    ds_write_b32 v50, v47 offset:9520
    v_pk_mul_f32 v[44:45], v[16:17], v[32:33] op_sel_hi:[0,1]
    v_pk_fma_f32 v[34:35], v[16:17], v[32:33], v[44:45] op_sel:[1,1,0] op_sel_hi:[1,0,1] neg_hi:[1,0,0]
    v_cvt_pk_bf16_f32 v48, v34, v35
    ds_write_b32 v50, v48 offset:2176
    v_pk_mul_f32 v[42:43], v[22:23], v[40:41] op_sel_hi:[0,1]
    v_pk_fma_f32 v[38:39], v[22:23], v[40:41], v[42:43] op_sel:[1,1,0] op_sel_hi:[1,0,1] neg_lo:[1,0,0]
    v_cvt_pk_bf16_f32 v49, v38, v39
    ds_write_b32 v50, v49 offset:9792
    v_pk_mul_f32 v[44:45], v[16:17], v[34:35] op_sel_hi:[0,1]
    v_pk_fma_f32 v[32:33], v[16:17], v[34:35], v[44:45] op_sel:[1,1,0] op_sel_hi:[1,0,1] neg_hi:[1,0,0]
    v_cvt_pk_bf16_f32 v46, v32, v33
    ds_write_b32 v50, v46 offset:816
    v_pk_mul_f32 v[42:43], v[22:23], v[38:39] op_sel_hi:[0,1]
    v_pk_fma_f32 v[40:41], v[22:23], v[38:39], v[42:43] op_sel:[1,1,0] op_sel_hi:[1,0,1] neg_lo:[1,0,0]
    v_cvt_pk_bf16_f32 v47, v40, v41
    ds_write_b32 v50, v47 offset:10064
    v_pk_mul_f32 v[44:45], v[16:17], v[32:33] op_sel_hi:[0,1]
    v_pk_fma_f32 v[34:35], v[16:17], v[32:33], v[44:45] op_sel:[1,1,0] op_sel_hi:[1,0,1] neg_hi:[1,0,0]
    v_cvt_pk_bf16_f32 v48, v34, v35
    ds_write_b32 v50, v48 offset:544
    v_pk_mul_f32 v[42:43], v[22:23], v[40:41] op_sel_hi:[0,1]
    v_pk_fma_f32 v[38:39], v[22:23], v[40:41], v[42:43] op_sel:[1,1,0] op_sel_hi:[1,0,1] neg_lo:[1,0,0]
    v_cvt_pk_bf16_f32 v49, v38, v39
    ds_write_b32 v50, v49 offset:10336
    v_pk_mul_f32 v[44:45], v[16:17], v[34:35] op_sel_hi:[0,1]
    v_pk_fma_f32 v[32:33], v[16:17], v[34:35], v[44:45] op_sel:[1,1,0] op_sel_hi:[1,0,1] neg_hi:[1,0,0]
    v_cvt_pk_bf16_f32 v46, v32, v33
    ds_write_b32 v50, v46 offset:272
    v_pk_mul_f32 v[42:43], v[22:23], v[38:39] op_sel_hi:[0,1]
    v_pk_fma_f32 v[40:41], v[22:23], v[38:39], v[42:43] op_sel:[1,1,0] op_sel_hi:[1,0,1] neg_lo:[1,0,0]
    v_cvt_pk_bf16_f32 v47, v40, v41
    ds_write_b32 v50, v47 offset:10608
    v_pk_mul_f32 v[44:45], v[16:17], v[32:33] op_sel_hi:[0,1]
    v_pk_fma_f32 v[34:35], v[16:17], v[32:33], v[44:45] op_sel:[1,1,0] op_sel_hi:[1,0,1] neg_hi:[1,0,0]
    v_cvt_pk_bf16_f32 v48, v34, v35
    ds_write_b32 v50, v48 offset:0
    v_pk_mul_f32 v[42:43], v[22:23], v[40:41] op_sel_hi:[0,1]
    v_pk_fma_f32 v[38:39], v[22:23], v[40:41], v[42:43] op_sel:[1,1,0] op_sel_hi:[1,0,1] neg_lo:[1,0,0]
    v_cvt_pk_bf16_f32 v49, v38, v39
    ds_write_b32 v50, v49 offset:10880
    v_pk_mul_f32 v[44:45], v[24:25], v[30:31] op_sel_hi:[0,1]
    v_pk_fma_f32 v[36:37], v[24:25], v[30:31], v[44:45] op_sel:[1,1,0] op_sel_hi:[1,0,1] neg_hi:[1,0,0]
    v_cvt_pk_bf16_f32 v46, v36, v37
    ds_write_b32 v50, v46 offset:3808
    ds_write_b32 v50, v46 offset:4080
    v_pk_mul_f32 v[42:43], v[22:23], v[38:39] op_sel_hi:[0,1]
    v_pk_fma_f32 v[40:41], v[22:23], v[38:39], v[42:43] op_sel:[1,1,0] op_sel_hi:[1,0,1] neg_lo:[1,0,0]
    v_cvt_pk_bf16_f32 v47, v40, v41
    ds_write_b32 v50, v47 offset:11152
    v_pk_mul_f32 v[44:45], v[18:19], v[36:37] op_sel_hi:[0,1]
    v_pk_fma_f32 v[32:33], v[18:19], v[36:37], v[44:45] op_sel:[1,1,0] op_sel_hi:[1,0,1] neg_hi:[1,0,0]
    v_cvt_pk_bf16_f32 v48, v32, v33
    ds_write_b32 v50, v48 offset:3536
    v_pk_mul_f32 v[42:43], v[22:23], v[40:41] op_sel_hi:[0,1]
    v_pk_fma_f32 v[38:39], v[22:23], v[40:41], v[42:43] op_sel:[1,1,0] op_sel_hi:[1,0,1] neg_lo:[1,0,0]
    v_cvt_pk_bf16_f32 v49, v38, v39
    ds_write_b32 v50, v49 offset:11424
    v_pk_mul_f32 v[44:45], v[18:19], v[32:33] op_sel_hi:[0,1]
    v_pk_fma_f32 v[34:35], v[18:19], v[32:33], v[44:45] op_sel:[1,1,0] op_sel_hi:[1,0,1] neg_hi:[1,0,0]
    v_cvt_pk_bf16_f32 v46, v34, v35
    ds_write_b32 v50, v46 offset:3264
    ds_write_b32 v50, v46 offset:1904
    ds_write_b32 v50, v46 offset:1632
    v_pk_mul_f32 v[42:43], v[22:23], v[38:39] op_sel_hi:[0,1]
    v_pk_fma_f32 v[40:41], v[22:23], v[38:39], v[42:43] op_sel:[1,1,0] op_sel_hi:[1,0,1] neg_lo:[1,0,0]
    v_cvt_pk_bf16_f32 v47, v40, v41
    ds_write_b32 v50, v47 offset:11696
    v_pk_mul_f32 v[44:45], v[18:19], v[34:35] op_sel_hi:[0,1]
    v_pk_fma_f32 v[32:33], v[18:19], v[34:35], v[44:45] op_sel:[1,1,0] op_sel_hi:[1,0,1] neg_hi:[1,0,0]
    v_cvt_pk_bf16_f32 v48, v32, v33
    ds_write_b32 v50, v48 offset:1360
    v_pk_mul_f32 v[42:43], v[22:23], v[40:41] op_sel_hi:[0,1]
    v_pk_fma_f32 v[38:39], v[22:23], v[40:41], v[42:43] op_sel:[1,1,0] op_sel_hi:[1,0,1] neg_lo:[1,0,0]
    v_cvt_pk_bf16_f32 v49, v38, v39
    ds_write_b32 v50, v49 offset:11968
    v_pk_mul_f32 v[44:45], v[18:19], v[32:33] op_sel_hi:[0,1]
    v_pk_fma_f32 v[34:35], v[18:19], v[32:33], v[44:45] op_sel:[1,1,0] op_sel_hi:[1,0,1] neg_hi:[1,0,0]
    v_cvt_pk_bf16_f32 v46, v34, v35
    ds_write_b32 v50, v46 offset:1088
    v_pk_mul_f32 v[42:43], v[22:23], v[38:39] op_sel_hi:[0,1]
    v_pk_fma_f32 v[40:41], v[22:23], v[38:39], v[42:43] op_sel:[1,1,0] op_sel_hi:[1,0,1] neg_lo:[1,0,0]
    v_cvt_pk_bf16_f32 v47, v40, v41
    ds_write_b32 v50, v47 offset:12240
    v_pk_mul_f32 v[44:45], v[26:27], v[30:31] op_sel_hi:[0,1]
    v_pk_fma_f32 v[52:53], v[26:27], v[30:31], v[44:45] op_sel:[1,1,0] op_sel_hi:[1,0,1] neg_hi:[1,0,0]
    v_cvt_pk_bf16_f32 v48, v52, v53
    ds_write_b32 v50, v48 offset:4896
    v_pk_mul_f32 v[42:43], v[22:23], v[40:41] op_sel_hi:[0,1]
    v_pk_fma_f32 v[38:39], v[22:23], v[40:41], v[42:43] op_sel:[1,1,0] op_sel_hi:[1,0,1] neg_lo:[1,0,0]
    v_cvt_pk_bf16_f32 v49, v38, v39
    ds_write_b32 v50, v49 offset:12512
    v_pk_mul_f32 v[44:45], v[20:21], v[52:53] op_sel_hi:[0,1]
    v_pk_fma_f32 v[32:33], v[20:21], v[52:53], v[44:45] op_sel:[1,1,0] op_sel_hi:[1,0,1] neg_hi:[1,0,0]
    v_cvt_pk_bf16_f32 v46, v32, v33
    ds_write_b32 v50, v46 offset:4624
    v_pk_mul_f32 v[42:43], v[22:23], v[38:39] op_sel_hi:[0,1]
    v_pk_fma_f32 v[40:41], v[22:23], v[38:39], v[42:43] op_sel:[1,1,0] op_sel_hi:[1,0,1] neg_lo:[1,0,0]
    v_cvt_pk_bf16_f32 v47, v40, v41
    ds_write_b32 v50, v47 offset:12784
    v_pk_mul_f32 v[44:45], v[20:21], v[32:33] op_sel_hi:[0,1]
    v_pk_fma_f32 v[34:35], v[20:21], v[32:33], v[44:45] op_sel:[1,1,0] op_sel_hi:[1,0,1] neg_hi:[1,0,0]
    v_cvt_pk_bf16_f32 v48, v34, v35
    ds_write_b32 v50, v48 offset:4352
    v_pk_mul_f32 v[42:43], v[22:23], v[40:41] op_sel_hi:[0,1]
    v_pk_fma_f32 v[38:39], v[22:23], v[40:41], v[42:43] op_sel:[1,1,0] op_sel_hi:[1,0,1] neg_lo:[1,0,0]
    v_cvt_pk_bf16_f32 v49, v38, v39
    ds_write_b32 v50, v49 offset:13056
    v_pk_mul_f32 v[44:45], v[24:25], v[52:53] op_sel_hi:[0,1]
    v_pk_fma_f32 v[36:37], v[24:25], v[52:53], v[44:45] op_sel:[1,1,0] op_sel_hi:[1,0,1] neg_hi:[1,0,0]
    v_cvt_pk_bf16_f32 v46, v36, v37
    ds_write_b32 v50, v46 offset:5984
    v_pk_mul_f32 v[42:43], v[22:23], v[38:39] op_sel_hi:[0,1]
    v_pk_fma_f32 v[40:41], v[22:23], v[38:39], v[42:43] op_sel:[1,1,0] op_sel_hi:[1,0,1] neg_lo:[1,0,0]
    v_cvt_pk_bf16_f32 v47, v40, v41
    ds_write_b32 v50, v47 offset:13328
    v_pk_mul_f32 v[44:45], v[20:21], v[36:37] op_sel_hi:[0,1]
    v_pk_fma_f32 v[32:33], v[20:21], v[36:37], v[44:45] op_sel:[1,1,0] op_sel_hi:[1,0,1] neg_hi:[1,0,0]
    v_cvt_pk_bf16_f32 v48, v32, v33
    ds_write_b32 v50, v48 offset:5712
    v_pk_mul_f32 v[42:43], v[22:23], v[40:41] op_sel_hi:[0,1]
    v_pk_fma_f32 v[38:39], v[22:23], v[40:41], v[42:43] op_sel:[1,1,0] op_sel_hi:[1,0,1] neg_lo:[1,0,0]
    v_cvt_pk_bf16_f32 v49, v38, v39
    ds_write_b32 v50, v49 offset:13600
    v_pk_mul_f32 v[44:45], v[20:21], v[32:33] op_sel_hi:[0,1]
    v_pk_fma_f32 v[34:35], v[20:21], v[32:33], v[44:45] op_sel:[1,1,0] op_sel_hi:[1,0,1] neg_hi:[1,0,0]
    v_cvt_pk_bf16_f32 v46, v34, v35
    ds_write_b32 v50, v46 offset:5440
    v_pk_mul_f32 v[42:43], v[22:23], v[38:39] op_sel_hi:[0,1]
    v_pk_fma_f32 v[40:41], v[22:23], v[38:39], v[42:43] op_sel:[1,1,0] op_sel_hi:[1,0,1] neg_lo:[1,0,0]
    v_cvt_pk_bf16_f32 v47, v40, v41
    ds_write_b32 v50, v47 offset:13872
    v_pk_mul_f32 v[44:45], v[28:29], v[30:31] op_sel_hi:[0,1]
    v_pk_fma_f32 v[54:55], v[28:29], v[30:31], v[44:45] op_sel:[1,1,0] op_sel_hi:[1,0,1] neg_hi:[1,0,0]
    v_cvt_pk_bf16_f32 v48, v54, v55
    ds_write_b32 v50, v48 offset:6800
    v_pk_mul_f32 v[42:43], v[22:23], v[40:41] op_sel_hi:[0,1]
    v_pk_fma_f32 v[38:39], v[22:23], v[40:41], v[42:43] op_sel:[1,1,0] op_sel_hi:[1,0,1] neg_lo:[1,0,0]
    v_cvt_pk_bf16_f32 v49, v38, v39
    ds_write_b32 v50, v49 offset:14144
    v_pk_mul_f32 v[44:45], v[22:23], v[54:55] op_sel_hi:[0,1]
    v_pk_fma_f32 v[32:33], v[22:23], v[54:55], v[44:45] op_sel:[1,1,0] op_sel_hi:[1,0,1] neg_hi:[1,0,0]
    v_cvt_pk_bf16_f32 v46, v32, v33
    ds_write_b32 v50, v46 offset:6528
    v_pk_mul_f32 v[42:43], v[22:23], v[38:39] op_sel_hi:[0,1]
    v_pk_fma_f32 v[40:41], v[22:23], v[38:39], v[42:43] op_sel:[1,1,0] op_sel_hi:[1,0,1] neg_lo:[1,0,0]
    v_cvt_pk_bf16_f32 v47, v40, v41
    ds_write_b32 v50, v47 offset:14416
    v_pk_mul_f32 v[44:45], v[24:25], v[54:55] op_sel_hi:[0,1]
    v_pk_fma_f32 v[34:35], v[24:25], v[54:55], v[44:45] op_sel:[1,1,0] op_sel_hi:[1,0,1] neg_hi:[1,0,0]
    v_cvt_pk_bf16_f32 v48, v34, v35
    ds_write_b32 v50, v48 offset:7344
    v_pk_mul_f32 v[42:43], v[22:23], v[40:41] op_sel_hi:[0,1]
    v_pk_fma_f32 v[38:39], v[22:23], v[40:41], v[42:43] op_sel:[1,1,0] op_sel_hi:[1,0,1] neg_lo:[1,0,0]
    v_cvt_pk_bf16_f32 v49, v38, v39
    ds_write_b32 v50, v49 offset:14688
    v_pk_mul_f32 v[44:45], v[22:23], v[34:35] op_sel_hi:[0,1]
    v_pk_fma_f32 v[32:33], v[22:23], v[34:35], v[44:45] op_sel:[1,1,0] op_sel_hi:[1,0,1] neg_hi:[1,0,0]
    v_cvt_pk_bf16_f32 v46, v32, v33
    ds_write_b32 v50, v46 offset:7072
    v_pk_mul_f32 v[42:43], v[22:23], v[38:39] op_sel_hi:[0,1]
    v_pk_fma_f32 v[40:41], v[22:23], v[38:39], v[42:43] op_sel:[1,1,0] op_sel_hi:[1,0,1] neg_lo:[1,0,0]
    v_cvt_pk_bf16_f32 v47, v40, v41
    ds_write_b32 v50, v47 offset:14960
    v_pk_mul_f32 v[44:45], v[26:27], v[54:55] op_sel_hi:[0,1]
    v_pk_fma_f32 v[56:57], v[26:27], v[54:55], v[44:45] op_sel:[1,1,0] op_sel_hi:[1,0,1] neg_hi:[1,0,0]
    v_cvt_pk_bf16_f32 v48, v56, v57
    ds_write_b32 v50, v48 offset:7888
    v_pk_mul_f32 v[42:43], v[22:23], v[40:41] op_sel_hi:[0,1]
    v_pk_fma_f32 v[38:39], v[22:23], v[40:41], v[42:43] op_sel:[1,1,0] op_sel_hi:[1,0,1] neg_lo:[1,0,0]
    v_cvt_pk_bf16_f32 v49, v38, v39
    ds_write_b32 v50, v49 offset:15232
    v_pk_mul_f32 v[44:45], v[22:23], v[56:57] op_sel_hi:[0,1]
    v_pk_fma_f32 v[32:33], v[22:23], v[56:57], v[44:45] op_sel:[1,1,0] op_sel_hi:[1,0,1] neg_hi:[1,0,0]
    v_cvt_pk_bf16_f32 v46, v32, v33
    ds_write_b32 v50, v46 offset:7616
    v_pk_mul_f32 v[42:43], v[22:23], v[38:39] op_sel_hi:[0,1]
    v_pk_fma_f32 v[40:41], v[22:23], v[38:39], v[42:43] op_sel:[1,1,0] op_sel_hi:[1,0,1] neg_lo:[1,0,0]
    v_cvt_pk_bf16_f32 v47, v40, v41
    ds_write_b32 v50, v47 offset:15504
    v_pk_mul_f32 v[44:45], v[24:25], v[56:57] op_sel_hi:[0,1]
    v_pk_fma_f32 v[34:35], v[24:25], v[56:57], v[44:45] op_sel:[1,1,0] op_sel_hi:[1,0,1] neg_hi:[1,0,0]
    v_cvt_pk_bf16_f32 v48, v34, v35
    ds_write_b32 v50, v48 offset:8432
    v_pk_mul_f32 v[42:43], v[22:23], v[40:41] op_sel_hi:[0,1]
    v_pk_fma_f32 v[38:39], v[22:23], v[40:41], v[42:43] op_sel:[1,1,0] op_sel_hi:[1,0,1] neg_lo:[1,0,0]
    v_cvt_pk_bf16_f32 v49, v38, v39
    ds_write_b32 v50, v49 offset:15776
    v_pk_mul_f32 v[44:45], v[22:23], v[34:35] op_sel_hi:[0,1]
    v_pk_fma_f32 v[32:33], v[22:23], v[34:35], v[44:45] op_sel:[1,1,0] op_sel_hi:[1,0,1] neg_hi:[1,0,0]
    v_cvt_pk_bf16_f32 v46, v32, v33
    ds_write_b32 v50, v46 offset:8160
    v_pk_mul_f32 v[42:43], v[22:23], v[38:39] op_sel_hi:[0,1]
    v_pk_fma_f32 v[40:41], v[22:23], v[38:39], v[42:43] op_sel:[1,1,0] op_sel_hi:[1,0,1] neg_lo:[1,0,0]
    v_cvt_pk_bf16_f32 v47, v40, v41
    ds_write_b32 v50, v47 offset:16048
    v_pk_mul_f32 v[42:43], v[22:23], v[40:41] op_sel_hi:[0,1]
    v_pk_fma_f32 v[38:39], v[22:23], v[40:41], v[42:43] op_sel:[1,1,0] op_sel_hi:[1,0,1] neg_lo:[1,0,0]
    v_cvt_pk_bf16_f32 v48, v38, v39
    ds_write_b32 v50, v48 offset:16320
    v_pk_mul_f32 v[42:43], v[22:23], v[38:39] op_sel_hi:[0,1]
    v_pk_fma_f32 v[40:41], v[22:23], v[38:39], v[42:43] op_sel:[1,1,0] op_sel_hi:[1,0,1] neg_lo:[1,0,0]
    v_cvt_pk_bf16_f32 v49, v40, v41
    ds_write_b32 v50, v49 offset:16592
    v_pk_mul_f32 v[42:43], v[22:23], v[40:41] op_sel_hi:[0,1]
    v_pk_fma_f32 v[38:39], v[22:23], v[40:41], v[42:43] op_sel:[1,1,0] op_sel_hi:[1,0,1] neg_lo:[1,0,0]
    v_cvt_pk_bf16_f32 v46, v38, v39
    ds_write_b32 v50, v46 offset:16864
    v_pk_mul_f32 v[42:43], v[22:23], v[38:39] op_sel_hi:[0,1]
    v_pk_fma_f32 v[40:41], v[22:23], v[38:39], v[42:43] op_sel:[1,1,0] op_sel_hi:[1,0,1] neg_lo:[1,0,0]
    v_cvt_pk_bf16_f32 v47, v40, v41
    ds_write_b32 v50, v47 offset:17136
    s_lshl_b32 s45, s6, 2
    s_add_u32 s45, s45, 157696
    v_mov_b32 v58, s45
    s_xor_b32 s45, s45, 4
    v_mov_b32 v59, s45
    v_mov_b32 v51, 4
    v_and_b32 v2, 31, v1
    v_mul_u32_u24 v2, 272, v2
    v_lshrrev_b32 v3, 5, v1
    v_lshl_add_u32 v2, v3, 4, v2
    v_add_u32 v2, s42, v2
    ds_read_b128 v[64:67], v2 offset:0
    ds_read_b128 v[96:99], v2 offset:8704
    ds_read_b128 v[68:71], v2 offset:32
    ds_read_b128 v[100:103], v2 offset:8736
    ds_read_b128 v[72:75], v2 offset:64
    ds_read_b128 v[104:107], v2 offset:8768
    ds_read_b128 v[76:79], v2 offset:96
    ds_read_b128 v[108:111], v2 offset:8800
    ds_read_b128 v[80:83], v2 offset:128
    ds_read_b128 v[112:115], v2 offset:8832
    ds_read_b128 v[84:87], v2 offset:160
    ds_read_b128 v[116:119], v2 offset:8864
    ds_read_b128 v[88:91], v2 offset:192
    ds_read_b128 v[120:123], v2 offset:8896
    ds_read_b128 v[92:95], v2 offset:224
    ds_read_b128 v[124:127], v2 offset:8928
    s_waitcnt lgkmcnt(14)
    v_mfma_f32_32x32x16_bf16 v[16:31], v[64:67], v[96:99], 0
    s_waitcnt lgkmcnt(12)
    v_mfma_f32_32x32x16_bf16 v[16:31], v[68:71], v[100:103], v[16:31]
    s_waitcnt lgkmcnt(10)
    v_mfma_f32_32x32x16_bf16 v[16:31], v[72:75], v[104:107], v[16:31]
    s_waitcnt lgkmcnt(8)
    v_mfma_f32_32x32x16_bf16 v[16:31], v[76:79], v[108:111], v[16:31]
    s_waitcnt lgkmcnt(6)
    v_mfma_f32_32x32x16_bf16 v[16:31], v[80:83], v[112:115], v[16:31]
    s_waitcnt lgkmcnt(4)
    v_mfma_f32_32x32x16_bf16 v[16:31], v[84:87], v[116:119], v[16:31]
    s_waitcnt lgkmcnt(2)
    v_mfma_f32_32x32x16_bf16 v[16:31], v[88:91], v[120:123], v[16:31]
    s_waitcnt lgkmcnt(0)
    v_mfma_f32_32x32x16_bf16 v[16:31], v[92:95], v[124:127], v[16:31]
    v_lshlrev_b32 v7, 4, v1
    v_add_u32 v2, s42, v7
    s_xor_b32 s45, s6, 1
    s_mul_i32 s45, s45, 17408
    v_add_u32 v3, s45, v7
    s_mul_i32 s46, s8, 34816
    s_nop 7
    s_nop 1
    s_cmp_eq_u32 s9, 0
    s_cbranch_scc0 ssm_x1
    ds_write_b128 v2, v[24:27]
    ds_write_b128 v2, v[28:31] offset:1024
    s_branch ssm_x2
ssm_x1:
    ds_write_b128 v2, v[16:19]
    ds_write_b128 v2, v[20:23] offset:1024
ssm_x2:
    s_waitcnt lgkmcnt(0)
    s_mov_b64 exec, 1
    ds_write_b32 v58, v51 offset:0
    s_mov_b64 exec, -1
    s_mov_b32 s59, 0
ssm_fx:
    ds_read_b32 v2, v59 offset:0
    s_waitcnt lgkmcnt(0)
    v_cmp_le_u32 vcc, 4, v2
    s_nop 3
    s_cmp_eq_u64 vcc, -1
    s_cbranch_scc1 ssm_fx_d
    s_add_u32 s59, s59, 1
    s_cmp_lt_u32 s59, 100000
    s_cbranch_scc0 ssm_fx_d
    s_sleep 1
    s_branch ssm_fx
ssm_fx_d:
    ds_read_b128 v[32:35], v3
    ds_read_b128 v[36:39], v3 offset:1024
    v_and_b32 v4, 31, v1
    v_lshrrev_b32 v5, 5, v1
    v_lshlrev_b32 v4, 4, v4
    s_add_u32 s47, s46, 6128
    v_sub_u32 v4, s47, v4
    s_waitcnt lgkmcnt(0)
    s_cmp_eq_u32 s9, 0
    s_cbranch_scc0 ssm_y1
    v_add_f32 v16, v16, v32
    v_add_f32 v17, v17, v33
    v_add_f32 v18, v18, v34
    v_add_f32 v19, v19, v35
    v_add_f32 v20, v20, v36
    v_add_f32 v21, v21, v37
    v_add_f32 v22, v22, v38
    v_add_f32 v23, v23, v39
    v_lshlrev_b32 v5, 9, v5
    v_sub_u32 v4, v4, v5
    v_cvt_pk_bf16_f32 v32, v16, v17
    v_cvt_pk_bf16_f32 v33, v18, v19
    v_cvt_pk_bf16_f32 v34, v20, v21
    v_cvt_pk_bf16_f32 v35, v22, v23
    ds_write_b128 v4, v[32:35]
    v_mov_b32 v36, 0
    v_mov_b32 v37, 0
    v_mov_b32 v38, 0
    v_mov_b32 v39, 0
    s_add_u32 s47, s46, 6144
    v_add_u32 v5, s47, v7
    s_mov_b64 exec, 0xf
    ds_write_b128 v5, v[36:39]
    s_mov_b64 exec, -1
    s_branch ssm_y2
ssm_y1:
    v_add_f32 v16, v24, v32
    v_add_f32 v17, v25, v33
    v_add_f32 v18, v26, v34
    v_add_f32 v19, v27, v35
    v_add_f32 v20, v28, v36
    v_add_f32 v21, v29, v37
    v_add_f32 v22, v30, v38
    v_add_f32 v23, v31, v39
    v_lshlrev_b32 v44, 9, v5
    v_sub_u32 v44, v4, v44
    v_subrev_u32 v44, 1024, v44
    v_cvt_pk_bf16_f32 v32, v16, v16
    v_cvt_pk_bf16_f32 v33, v17, v17
    v_cvt_pk_bf16_f32 v34, v17, v18
    v_cvt_pk_bf16_f32 v35, v18, v18
    ds_write_b128 v44, v[32:35]
    v_lshlrev_b32 v45, 10, v5
    v_sub_u32 v45, v4, v45
    v_subrev_u32 v45, 2560, v45
    v_and_b32 v46, 1, v1
    v_cmp_eq_u32 vcc, 1, v46
    s_nop 1
    v_cndmask_b32 v47, v21, v20, vcc
    v_cvt_pk_bf16_f32 v36, v20, v20
    v_cvt_pk_bf16_f32 v37, v20, v47
    v_cvt_pk_bf16_f32 v38, v21, v21
    v_mov_b32 v39, v38
    v_cndmask_b32 v47, v23, v22, vcc
    v_cvt_pk_bf16_f32 v40, v22, v22
    v_cvt_pk_bf16_f32 v41, v22, v47
    v_cvt_pk_bf16_f32 v42, v23, v23
    v_mov_b32 v43, v42
    ds_write_b128 v45, v[36:39] offset:512
    ds_write_b128 v45, v[40:43]
ssm_y2:
    s_waitcnt lgkmcnt(0)
    s_mov_b64 exec, 1
    ds_write_b32 v58, v51 offset:32
    s_mov_b64 exec, -1
    s_mov_b32 s59, 0
ssm_fd:
    ds_read_b32 v2, v59 offset:32
    s_waitcnt lgkmcnt(0)
    v_cmp_le_u32 vcc, 4, v2
    s_nop 3
    s_cmp_eq_u64 vcc, -1
    s_cbranch_scc1 ssm_fd_d
    s_add_u32 s59, s59, 1
    s_cmp_lt_u32 s59, 100000
    s_cbranch_scc0 ssm_fd_d
    s_sleep 1
    s_branch ssm_fd
ssm_fd_d:
    s_lshl_b32 s47, s9, 11
    s_add_u32 s47, s47, s46
    s_add_u32 s47, s47, 2048
    v_add_u32 v2, s47, v7
    ds_read_b128 v[32:35], v2 offset:0
    ds_read_b64 v[36:37], v2 offset:16
    ds_read_b128 v[40:43], v2 offset:1024
    ds_read_b64 v[44:45], v2 offset:1040
    v_lshrrev_b32 v3, 2, v1
    v_mul_u32_u24 v3, 4160, v3
    v_and_b32 v4, 3, v1
    v_lshl_add_u32 v3, v4, 4, v3
    s_add_u32 s47, s46, 10304
    v_add_u32 v3, s47, v3
    v_mov_b32 v60, 0
    v_mov_b32 v61, 0
    v_mov_b32 v62, 0
    v_mov_b32 v63, 0
    s_cmp_eq_u32 s9, 0
    s_cbranch_scc0 ssm_z1
    s_mov_b64 exec, 0xfff
    ds_write_b128 v3, v[60:63]
    s_mov_b64 exec, -1
ssm_z1:
    v_add_u32 v64, 8320, v2
    v_add_u32 v65, 9344, v2
    s_waitcnt lgkmcnt(0)
    v_alignbit_b32 v48, v33, v32, 16
    v_alignbit_b32 v49, v34, v33, 16
    v_alignbit_b32 v50, v35, v34, 16
    v_alignbit_b32 v51, v36, v35, 16
    v_alignbit_b32 v52, v34, v33, 16
    v_alignbit_b32 v53, v35, v34, 16
    v_alignbit_b32 v54, v36, v35, 16
    v_alignbit_b32 v55, v37, v36, 16
    ds_write_b128 v2, v[48:51] offset:4160
    ds_write2_b32 v64, v33, v34 offset0:0 offset1:1
    ds_write2_b32 v64, v35, v36 offset0:2 offset1:3
    ds_write_b128 v2, v[52:55] offset:12480
    v_alignbit_b32 v56, v41, v40, 16
    v_alignbit_b32 v57, v42, v41, 16
    v_alignbit_b32 v58, v43, v42, 16
    v_alignbit_b32 v59, v44, v43, 16
    v_alignbit_b32 v60, v42, v41, 16
    v_alignbit_b32 v61, v43, v42, 16
    v_alignbit_b32 v62, v44, v43, 16
    v_alignbit_b32 v63, v45, v44, 16
    ds_write_b128 v2, v[56:59] offset:5184
    ds_write2_b32 v65, v41, v42 offset0:0 offset1:1
    ds_write2_b32 v65, v43, v44 offset0:2 offset1:3
    ds_write_b128 v2, v[60:63] offset:13504
    v_and_b32 v3, 3, v1
    v_sub_u32 v3, 3, v3
    v_mul_u32_u24 v8, 4160, v3
    v_bfe_u32 v3, v1, 2, 2
    v_lshrrev_b32 v4, 4, v1
    v_lshlrev_b32 v5, 1, v4
    v_sub_u32 v5, v5, v3
    v_lshl_add_u32 v8, v5, 3, v8
    s_lshl_b32 s47, s9, 8
    s_sub_u32 s48, s46, s47
    s_add_u32 s48, s48, 2520
    v_add_u32 v8, s48, v8
    v_add_u32 v9, 2048, v8
    v_and_b32 v3, 15, v1
    v_lshlrev_b32 v10, 5, v3
    v_lshl_add_u32 v10, v4, 4, v10
    s_mul_i32 s48, s8, 4576
    s_add_u32 s48, s48, 139712
    s_sub_u32 s49, s48, s47
    v_add_u32 v10, s49, v10
    v_lshlrev_b32 v12, 5, v3
    v_lshl_add_u32 v12, v4, 3, v12
    s_lshl_b32 s47, s9, 11
    s_add_u32 s49, s48, s47
    s_add_u32 s49, s49, 32
    v_add_u32 v11, s49, v12
    s_add_u32 s10, s7, s8
    s_lshl_b32 s10, s10, 12
    s_add_u32 s10, s10, s47
    s_add_u32 s47, s46, 20480
    s_lshl_b32 s48, s9, 12
    s_add_u32 s49, s47, s48
    v_add_u32 v13, s49, v7
    s_xor_b32 s48, s48, 4096
    s_add_u32 s49, s47, s48
    v_add_u32 v14, s49, v7
    s_lshl_b32 s45, s6, 2
    s_add_u32 s45, s45, 157696
    v_mov_b32 v16, s45
    s_xor_b32 s45, s45, 4
    v_mov_b32 v17, s45
    v_mov_b32 v20, 4
    v_mov_b32 v19, 157824
    v_add_u32 v18, 64, v17
    s_mov_b32 s45, 157824
    v_writelane_b32 v18, s45, 1
    v_subrev_u32 v8, 192, v8
    v_subrev_u32 v10, 192, v10
    s_waitcnt lgkmcnt(0)
    s_mov_b64 exec, 1
    ds_write_b32 v16, v20 offset:64
    s_mov_b64 exec, -1
    s_mov_b32 s59, 0
ssm_fp0:
    ds_read_b32 v2, v18 offset:0
    s_waitcnt lgkmcnt(0)
    v_cmp_le_u32 vcc, 4, v2
    s_nop 3
    s_cmp_eq_u64 vcc, -1
    s_cbranch_scc1 ssm_fp0_d
    s_add_u32 s59, s59, 1
    s_cmp_lt_u32 s59, 100000
    s_cbranch_scc0 ssm_fp0_d
    s_sleep 1
    s_branch ssm_fp0
ssm_fp0_d:
    ds_read_b64 v[60:61], v8 offset:192
    ds_read_b64 v[62:63], v8 offset:200
    ds_read_b128 v[64:67], v10 offset:192
    ds_read_b64 v[56:57], v8 offset:704
    ds_read_b64 v[58:59], v8 offset:712
    ds_read_b128 v[68:71], v10 offset:704
    ds_read_b64 v[52:53], v8 offset:1216
    ds_read_b64 v[54:55], v8 offset:1224
    ds_read_b128 v[72:75], v10 offset:1216
    ds_read_b64 v[48:49], v8 offset:1728
    ds_read_b64 v[50:51], v8 offset:1736
    ds_read_b128 v[76:79], v10 offset:1728
    ds_read_b64 v[44:45], v8 offset:2240
    ds_read_b64 v[46:47], v8 offset:2248
    ds_read_b64 v[40:41], v8 offset:2752
    ds_read_b64 v[42:43], v8 offset:2760
    ds_read_b64 v[36:37], v8 offset:3264
    ds_read_b64 v[38:39], v8 offset:3272
    ds_read_b64 v[32:33], v8 offset:3776
    ds_read_b64 v[34:35], v8 offset:3784
    ds_read_b128 v[80:83], v10 offset:128
    ds_read_b128 v[84:87], v10 offset:640
    ds_read_b128 v[88:91], v10 offset:1152
    ds_read_b128 v[92:95], v10 offset:1664
    s_waitcnt lgkmcnt(15)
    v_mfma_f32_16x16x32_bf16 v[124:127], v[60:63], v[64:67], 0
    ds_read_b64 v[60:61], v8 offset:128
    ds_read_b64 v[62:63], v8 offset:136
    v_mfma_f32_16x16x32_bf16 v[120:123], v[56:59], v[64:67], 0
    v_mfma_f32_16x16x32_bf16 v[124:127], v[56:59], v[68:71], v[124:127]
    ds_read_b64 v[56:57], v8 offset:640
    ds_read_b64 v[58:59], v8 offset:648
    v_mfma_f32_16x16x32_bf16 v[116:119], v[52:55], v[64:67], 0
    v_mfma_f32_16x16x32_bf16 v[120:123], v[52:55], v[68:71], v[120:123]
    v_mfma_f32_16x16x32_bf16 v[124:127], v[52:55], v[72:75], v[124:127]
    ds_read_b64 v[52:53], v8 offset:1152
    ds_read_b64 v[54:55], v8 offset:1160
    s_waitcnt lgkmcnt(15)
    v_mfma_f32_16x16x32_bf16 v[112:115], v[48:51], v[64:67], 0
    v_mfma_f32_16x16x32_bf16 v[116:119], v[48:51], v[68:71], v[116:119]
    v_mfma_f32_16x16x32_bf16 v[120:123], v[48:51], v[72:75], v[120:123]
    v_mfma_f32_16x16x32_bf16 v[124:127], v[48:51], v[76:79], v[124:127]
    ds_read_b64 v[48:49], v8 offset:1664
    ds_read_b64 v[50:51], v8 offset:1672
    v_mfma_f32_16x16x32_bf16 v[108:111], v[44:47], v[64:67], 0
    v_mfma_f32_16x16x32_bf16 v[112:115], v[44:47], v[68:71], v[112:115]
    v_mfma_f32_16x16x32_bf16 v[116:119], v[44:47], v[72:75], v[116:119]
    v_mfma_f32_16x16x32_bf16 v[120:123], v[44:47], v[76:79], v[120:123]
    ds_read_b64 v[44:45], v8 offset:2176
    ds_read_b64 v[46:47], v8 offset:2184
    s_waitcnt lgkmcnt(15)
    v_mfma_f32_16x16x32_bf16 v[104:107], v[40:43], v[64:67], 0
    v_mfma_f32_16x16x32_bf16 v[108:111], v[40:43], v[68:71], v[108:111]
    v_mfma_f32_16x16x32_bf16 v[112:115], v[40:43], v[72:75], v[112:115]
    v_mfma_f32_16x16x32_bf16 v[116:119], v[40:43], v[76:79], v[116:119]
    ds_read_b64 v[40:41], v8 offset:2688
    ds_read_b64 v[42:43], v8 offset:2696
    v_mfma_f32_16x16x32_bf16 v[100:103], v[36:39], v[64:67], 0
    v_mfma_f32_16x16x32_bf16 v[104:107], v[36:39], v[68:71], v[104:107]
    v_mfma_f32_16x16x32_bf16 v[108:111], v[36:39], v[72:75], v[108:111]
    v_mfma_f32_16x16x32_bf16 v[112:115], v[36:39], v[76:79], v[112:115]
    ds_read_b64 v[36:37], v8 offset:3200
    ds_read_b64 v[38:39], v8 offset:3208
    s_waitcnt lgkmcnt(15)
    v_mfma_f32_16x16x32_bf16 v[96:99], v[32:35], v[64:67], 0
    ds_read_b128 v[64:67], v10 offset:64
    v_mfma_f32_16x16x32_bf16 v[100:103], v[32:35], v[68:71], v[100:103]
    ds_read_b128 v[68:71], v10 offset:576
    v_mfma_f32_16x16x32_bf16 v[104:107], v[32:35], v[72:75], v[104:107]
    ds_read_b128 v[72:75], v10 offset:1088
    v_mfma_f32_16x16x32_bf16 v[108:111], v[32:35], v[76:79], v[108:111]
    ds_read_b64 v[32:33], v8 offset:3712
    ds_read_b64 v[34:35], v8 offset:3720
    ds_read_b128 v[76:79], v10 offset:1600
    s_waitcnt lgkmcnt(15)
    v_mfma_f32_16x16x32_bf16 v[124:127], v[60:63], v[80:83], v[124:127]
    ds_read_b64 v[60:61], v8 offset:64
    ds_read_b64 v[62:63], v8 offset:72
    v_mfma_f32_16x16x32_bf16 v[120:123], v[56:59], v[80:83], v[120:123]
    v_mfma_f32_16x16x32_bf16 v[124:127], v[56:59], v[84:87], v[124:127]
    ds_read_b64 v[56:57], v8 offset:576
    ds_read_b64 v[58:59], v8 offset:584
    s_waitcnt lgkmcnt(15)
    v_mfma_f32_16x16x32_bf16 v[116:119], v[52:55], v[80:83], v[116:119]
    v_mfma_f32_16x16x32_bf16 v[120:123], v[52:55], v[84:87], v[120:123]
    v_mfma_f32_16x16x32_bf16 v[124:127], v[52:55], v[88:91], v[124:127]
    ds_read_b64 v[52:53], v8 offset:1088
    ds_read_b64 v[54:55], v8 offset:1096
    v_mfma_f32_16x16x32_bf16 v[112:115], v[48:51], v[80:83], v[112:115]
    v_mfma_f32_16x16x32_bf16 v[116:119], v[48:51], v[84:87], v[116:119]
    v_mfma_f32_16x16x32_bf16 v[120:123], v[48:51], v[88:91], v[120:123]
    v_mfma_f32_16x16x32_bf16 v[124:127], v[48:51], v[92:95], v[124:127]
    ds_read_b64 v[48:49], v8 offset:1600
    ds_read_b64 v[50:51], v8 offset:1608
    s_waitcnt lgkmcnt(15)
    v_mfma_f32_16x16x32_bf16 v[108:111], v[44:47], v[80:83], v[108:111]
    v_mfma_f32_16x16x32_bf16 v[112:115], v[44:47], v[84:87], v[112:115]
    v_mfma_f32_16x16x32_bf16 v[116:119], v[44:47], v[88:91], v[116:119]
    v_mfma_f32_16x16x32_bf16 v[120:123], v[44:47], v[92:95], v[120:123]
    ds_read_b64 v[44:45], v8 offset:2112
    ds_read_b64 v[46:47], v8 offset:2120
    v_mfma_f32_16x16x32_bf16 v[104:107], v[40:43], v[80:83], v[104:107]
    v_mfma_f32_16x16x32_bf16 v[108:111], v[40:43], v[84:87], v[108:111]
    v_mfma_f32_16x16x32_bf16 v[112:115], v[40:43], v[88:91], v[112:115]
    v_mfma_f32_16x16x32_bf16 v[116:119], v[40:43], v[92:95], v[116:119]
    ds_read_b64 v[40:41], v8 offset:2624
    ds_read_b64 v[42:43], v8 offset:2632
    s_waitcnt lgkmcnt(15)
    v_mfma_f32_16x16x32_bf16 v[100:103], v[36:39], v[80:83], v[100:103]
    v_mfma_f32_16x16x32_bf16 v[104:107], v[36:39], v[84:87], v[104:107]
    v_mfma_f32_16x16x32_bf16 v[108:111], v[36:39], v[88:91], v[108:111]
    v_mfma_f32_16x16x32_bf16 v[112:115], v[36:39], v[92:95], v[112:115]
    ds_read_b64 v[36:37], v8 offset:3136
    ds_read_b64 v[38:39], v8 offset:3144
    s_waitcnt lgkmcnt(15)
    v_mfma_f32_16x16x32_bf16 v[96:99], v[32:35], v[80:83], v[96:99]
    ds_read_b128 v[80:83], v10 offset:0
    v_mfma_f32_16x16x32_bf16 v[100:103], v[32:35], v[84:87], v[100:103]
    ds_read_b128 v[84:87], v10 offset:512
    v_mfma_f32_16x16x32_bf16 v[104:107], v[32:35], v[88:91], v[104:107]
    ds_read_b128 v[88:91], v10 offset:1024
    v_mfma_f32_16x16x32_bf16 v[108:111], v[32:35], v[92:95], v[108:111]
    ds_read_b64 v[32:33], v8 offset:3648
    ds_read_b64 v[34:35], v8 offset:3656
    ds_read_b128 v[92:95], v10 offset:1536
    s_waitcnt lgkmcnt(15)
    v_mfma_f32_16x16x32_bf16 v[124:127], v[60:63], v[64:67], v[124:127]
    ds_read_b64 v[60:61], v8 offset:0
    ds_read_b64 v[62:63], v8 offset:8
    v_mfma_f32_16x16x32_bf16 v[120:123], v[56:59], v[64:67], v[120:123]
    v_mfma_f32_16x16x32_bf16 v[124:127], v[56:59], v[68:71], v[124:127]
    ds_read_b64 v[56:57], v8 offset:512
    ds_read_b64 v[58:59], v8 offset:520
    s_waitcnt lgkmcnt(15)
    v_mfma_f32_16x16x32_bf16 v[116:119], v[52:55], v[64:67], v[116:119]
    v_mfma_f32_16x16x32_bf16 v[120:123], v[52:55], v[68:71], v[120:123]
    v_mfma_f32_16x16x32_bf16 v[124:127], v[52:55], v[72:75], v[124:127]
    ds_read_b64 v[52:53], v8 offset:1024
    ds_read_b64 v[54:55], v8 offset:1032
    v_mfma_f32_16x16x32_bf16 v[112:115], v[48:51], v[64:67], v[112:115]
    v_mfma_f32_16x16x32_bf16 v[116:119], v[48:51], v[68:71], v[116:119]
    v_mfma_f32_16x16x32_bf16 v[120:123], v[48:51], v[72:75], v[120:123]
    v_mfma_f32_16x16x32_bf16 v[124:127], v[48:51], v[76:79], v[124:127]
    ds_read_b64 v[48:49], v8 offset:1536
    ds_read_b64 v[50:51], v8 offset:1544
    s_waitcnt lgkmcnt(15)
    v_mfma_f32_16x16x32_bf16 v[108:111], v[44:47], v[64:67], v[108:111]
    v_mfma_f32_16x16x32_bf16 v[112:115], v[44:47], v[68:71], v[112:115]
    v_mfma_f32_16x16x32_bf16 v[116:119], v[44:47], v[72:75], v[116:119]
    v_mfma_f32_16x16x32_bf16 v[120:123], v[44:47], v[76:79], v[120:123]
    ds_read_b64 v[44:45], v8 offset:2048
    ds_read_b64 v[46:47], v8 offset:2056
    v_mfma_f32_16x16x32_bf16 v[104:107], v[40:43], v[64:67], v[104:107]
    v_mfma_f32_16x16x32_bf16 v[108:111], v[40:43], v[68:71], v[108:111]
    v_mfma_f32_16x16x32_bf16 v[112:115], v[40:43], v[72:75], v[112:115]
    v_mfma_f32_16x16x32_bf16 v[116:119], v[40:43], v[76:79], v[116:119]
    ds_read_b64 v[40:41], v8 offset:2560
    ds_read_b64 v[42:43], v8 offset:2568
    s_waitcnt lgkmcnt(15)
    v_mfma_f32_16x16x32_bf16 v[100:103], v[36:39], v[64:67], v[100:103]
    v_mfma_f32_16x16x32_bf16 v[104:107], v[36:39], v[68:71], v[104:107]
    v_mfma_f32_16x16x32_bf16 v[108:111], v[36:39], v[72:75], v[108:111]
    v_mfma_f32_16x16x32_bf16 v[112:115], v[36:39], v[76:79], v[112:115]
    ds_read_b64 v[36:37], v8 offset:3072
    ds_read_b64 v[38:39], v8 offset:3080
    s_waitcnt lgkmcnt(15)
    v_mfma_f32_16x16x32_bf16 v[96:99], v[32:35], v[64:67], v[96:99]
    v_mfma_f32_16x16x32_bf16 v[100:103], v[32:35], v[68:71], v[100:103]
    v_mfma_f32_16x16x32_bf16 v[104:107], v[32:35], v[72:75], v[104:107]
    v_mfma_f32_16x16x32_bf16 v[108:111], v[32:35], v[76:79], v[108:111]
    ds_read_b64 v[32:33], v8 offset:3584
    ds_read_b64 v[34:35], v8 offset:3592
    s_waitcnt lgkmcnt(14)
    v_mfma_f32_16x16x32_bf16 v[124:127], v[60:63], v[80:83], v[124:127]
    ds_read_b64 v[60:61], v8 offset:2176
    ds_read_b64 v[62:63], v8 offset:2184
    s_waitcnt lgkmcnt(14)
    v_mfma_f32_16x16x32_bf16 v[120:123], v[56:59], v[80:83], v[120:123]
    v_mfma_f32_16x16x32_bf16 v[124:127], v[56:59], v[84:87], v[124:127]
    ds_read_b64 v[56:57], v8 offset:2688
    ds_read_b64 v[58:59], v8 offset:2696
    s_waitcnt lgkmcnt(14)
    v_mfma_f32_16x16x32_bf16 v[116:119], v[52:55], v[80:83], v[116:119]
    v_mfma_f32_16x16x32_bf16 v[120:123], v[52:55], v[84:87], v[120:123]
    v_mfma_f32_16x16x32_bf16 v[124:127], v[52:55], v[88:91], v[124:127]
    ds_read_b64 v[52:53], v8 offset:3200
    ds_read_b64 v[54:55], v8 offset:3208
    s_waitcnt lgkmcnt(14)
    v_mfma_f32_16x16x32_bf16 v[112:115], v[48:51], v[80:83], v[112:115]
    v_mfma_f32_16x16x32_bf16 v[116:119], v[48:51], v[84:87], v[116:119]
    v_mfma_f32_16x16x32_bf16 v[120:123], v[48:51], v[88:91], v[120:123]
    v_mfma_f32_16x16x32_bf16 v[124:127], v[48:51], v[92:95], v[124:127]
    ds_read_b64 v[48:49], v8 offset:3712
    ds_read_b64 v[50:51], v8 offset:3720
    s_waitcnt lgkmcnt(14)
    v_mfma_f32_16x16x32_bf16 v[108:111], v[44:47], v[80:83], v[108:111]
    v_mfma_f32_16x16x32_bf16 v[112:115], v[44:47], v[84:87], v[112:115]
    v_mfma_f32_16x16x32_bf16 v[116:119], v[44:47], v[88:91], v[116:119]
    v_mfma_f32_16x16x32_bf16 v[120:123], v[44:47], v[92:95], v[120:123]
    ds_read_b64 v[44:45], v8 offset:2240
    ds_read_b64 v[46:47], v8 offset:2248
    s_waitcnt lgkmcnt(14)
    v_mfma_f32_16x16x32_bf16 v[104:107], v[40:43], v[80:83], v[104:107]
    v_mfma_f32_16x16x32_bf16 v[108:111], v[40:43], v[84:87], v[108:111]
    v_mfma_f32_16x16x32_bf16 v[112:115], v[40:43], v[88:91], v[112:115]
    v_mfma_f32_16x16x32_bf16 v[116:119], v[40:43], v[92:95], v[116:119]
    ds_read_b64 v[40:41], v8 offset:2752
    ds_read_b64 v[42:43], v8 offset:2760
    s_waitcnt lgkmcnt(14)
    v_mfma_f32_16x16x32_bf16 v[100:103], v[36:39], v[80:83], v[100:103]
    v_mfma_f32_16x16x32_bf16 v[104:107], v[36:39], v[84:87], v[104:107]
    v_mfma_f32_16x16x32_bf16 v[108:111], v[36:39], v[88:91], v[108:111]
    v_mfma_f32_16x16x32_bf16 v[112:115], v[36:39], v[92:95], v[112:115]
    ds_read_b64 v[36:37], v8 offset:3264
    ds_read_b64 v[38:39], v8 offset:3272
    s_waitcnt lgkmcnt(14)
    v_mfma_f32_16x16x32_bf16 v[96:99], v[32:35], v[80:83], v[96:99]
    v_mfma_f32_16x16x32_bf16 v[100:103], v[32:35], v[84:87], v[100:103]
    v_mfma_f32_16x16x32_bf16 v[104:107], v[32:35], v[88:91], v[104:107]
    v_mfma_f32_16x16x32_bf16 v[108:111], v[32:35], v[92:95], v[108:111]
    ds_read_b64 v[32:33], v8 offset:3776
    ds_read_b64 v[34:35], v8 offset:3784
    s_mov_b32 s59, 0
ssm_fp1:
    ds_read_b32 v2, v19 offset:4
    s_waitcnt lgkmcnt(0)
    v_cmp_le_u32 vcc, 4, v2
    s_nop 3
    s_cmp_eq_u64 vcc, -1
    s_cbranch_scc1 ssm_fp1_d
    s_add_u32 s59, s59, 1
    s_cmp_lt_u32 s59, 100000
    s_cbranch_scc0 ssm_fp1_d
    s_sleep 1
    s_branch ssm_fp1
ssm_fp1_d:
    ds_read_b128 v[64:67], v10 offset:2240
    ds_read_b128 v[68:71], v10 offset:2752
    ds_read_b128 v[72:75], v10 offset:3264
    ds_read_b128 v[76:79], v10 offset:3776
    ds_read_b128 v[80:83], v10 offset:2176
    ds_read_b128 v[84:87], v10 offset:2688
    ds_read_b128 v[88:91], v10 offset:3200
    ds_read_b128 v[92:95], v10 offset:3712
    s_waitcnt lgkmcnt(7)
    v_mfma_f32_16x16x32_bf16 v[124:127], v[44:47], v[64:67], v[124:127]
    ds_read_b64 v[44:45], v8 offset:2112
    ds_read_b64 v[46:47], v8 offset:2120
    v_mfma_f32_16x16x32_bf16 v[120:123], v[40:43], v[64:67], v[120:123]
    s_waitcnt lgkmcnt(8)
    v_mfma_f32_16x16x32_bf16 v[124:127], v[40:43], v[68:71], v[124:127]
    ds_read_b64 v[40:41], v8 offset:2624
    ds_read_b64 v[42:43], v8 offset:2632
    v_mfma_f32_16x16x32_bf16 v[116:119], v[36:39], v[64:67], v[116:119]
    v_mfma_f32_16x16x32_bf16 v[120:123], v[36:39], v[68:71], v[120:123]
    s_waitcnt lgkmcnt(9)
    v_mfma_f32_16x16x32_bf16 v[124:127], v[36:39], v[72:75], v[124:127]
    ds_read_b64 v[36:37], v8 offset:3136
    ds_read_b64 v[38:39], v8 offset:3144
    v_mfma_f32_16x16x32_bf16 v[112:115], v[32:35], v[64:67], v[112:115]
    ds_read_b128 v[64:67], v10 offset:2112
    v_mfma_f32_16x16x32_bf16 v[116:119], v[32:35], v[68:71], v[116:119]
    ds_read_b128 v[68:71], v10 offset:2624
    v_mfma_f32_16x16x32_bf16 v[120:123], v[32:35], v[72:75], v[120:123]
    ds_read_b128 v[72:75], v10 offset:3136
    s_waitcnt lgkmcnt(13)
    v_mfma_f32_16x16x32_bf16 v[124:127], v[32:35], v[76:79], v[124:127]
    ds_read_b64 v[32:33], v8 offset:3648
    ds_read_b64 v[34:35], v8 offset:3656
    ds_read_b128 v[76:79], v10 offset:3648
    s_waitcnt lgkmcnt(15)
    v_mfma_f32_16x16x32_bf16 v[124:127], v[60:63], v[80:83], v[124:127]
    ds_read_b64 v[60:61], v8 offset:2048
    ds_read_b64 v[62:63], v8 offset:2056
    v_mfma_f32_16x16x32_bf16 v[120:123], v[56:59], v[80:83], v[120:123]
    s_waitcnt lgkmcnt(15)
    v_mfma_f32_16x16x32_bf16 v[124:127], v[56:59], v[84:87], v[124:127]
    ds_read_b64 v[56:57], v8 offset:2560
    ds_read_b64 v[58:59], v8 offset:2568
    v_mfma_f32_16x16x32_bf16 v[116:119], v[52:55], v[80:83], v[116:119]
    v_mfma_f32_16x16x32_bf16 v[120:123], v[52:55], v[84:87], v[120:123]
    v_mfma_f32_16x16x32_bf16 v[124:127], v[52:55], v[88:91], v[124:127]
    ds_read_b64 v[52:53], v8 offset:3072
    ds_read_b64 v[54:55], v8 offset:3080
    v_mfma_f32_16x16x32_bf16 v[112:115], v[48:51], v[80:83], v[112:115]
    ds_read_b128 v[80:83], v10 offset:2048
    v_mfma_f32_16x16x32_bf16 v[116:119], v[48:51], v[84:87], v[116:119]
    ds_read_b128 v[84:87], v10 offset:2560
    v_mfma_f32_16x16x32_bf16 v[120:123], v[48:51], v[88:91], v[120:123]
    ds_read_b128 v[88:91], v10 offset:3072
    s_waitcnt lgkmcnt(15)
    v_mfma_f32_16x16x32_bf16 v[124:127], v[48:51], v[92:95], v[124:127]
    ds_read_b64 v[48:49], v8 offset:3584
    ds_read_b64 v[50:51], v8 offset:3592
    ds_read_b128 v[92:95], v10 offset:3584
    s_waitcnt lgkmcnt(15)
    v_mfma_f32_16x16x32_bf16 v[124:127], v[44:47], v[64:67], v[124:127]
    v_mfma_f32_16x16x32_bf16 v[120:123], v[40:43], v[64:67], v[120:123]
    v_mfma_f32_16x16x32_bf16 v[124:127], v[40:43], v[68:71], v[124:127]
    v_mfma_f32_16x16x32_bf16 v[116:119], v[36:39], v[64:67], v[116:119]
    v_mfma_f32_16x16x32_bf16 v[120:123], v[36:39], v[68:71], v[120:123]
    v_mfma_f32_16x16x32_bf16 v[124:127], v[36:39], v[72:75], v[124:127]
    s_waitcnt lgkmcnt(13)
    v_mfma_f32_16x16x32_bf16 v[112:115], v[32:35], v[64:67], v[112:115]
    v_mfma_f32_16x16x32_bf16 v[116:119], v[32:35], v[68:71], v[116:119]
    v_mfma_f32_16x16x32_bf16 v[120:123], v[32:35], v[72:75], v[120:123]
    s_waitcnt lgkmcnt(12)
    v_mfma_f32_16x16x32_bf16 v[124:127], v[32:35], v[76:79], v[124:127]
    s_waitcnt lgkmcnt(5)
    v_mfma_f32_16x16x32_bf16 v[124:127], v[60:63], v[80:83], v[124:127]
    v_mfma_f32_16x16x32_bf16 v[120:123], v[56:59], v[80:83], v[120:123]
    s_waitcnt lgkmcnt(4)
    v_mfma_f32_16x16x32_bf16 v[124:127], v[56:59], v[84:87], v[124:127]
    v_mfma_f32_16x16x32_bf16 v[116:119], v[52:55], v[80:83], v[116:119]
    v_mfma_f32_16x16x32_bf16 v[120:123], v[52:55], v[84:87], v[120:123]
    s_waitcnt lgkmcnt(3)
    v_mfma_f32_16x16x32_bf16 v[124:127], v[52:55], v[88:91], v[124:127]
    s_waitcnt lgkmcnt(1)
    v_mfma_f32_16x16x32_bf16 v[112:115], v[48:51], v[80:83], v[112:115]
    v_mfma_f32_16x16x32_bf16 v[116:119], v[48:51], v[84:87], v[116:119]
    v_mfma_f32_16x16x32_bf16 v[120:123], v[48:51], v[88:91], v[120:123]
    s_waitcnt lgkmcnt(0)
    v_mfma_f32_16x16x32_bf16 v[124:127], v[48:51], v[92:95], v[124:127]
    s_nop 7
    s_cmp_eq_u32 s9, 0
    s_cbranch_scc0 ssm_w1
    ds_write_b128 v13, v[112:115] offset:0
    ds_write_b128 v13, v[116:119] offset:1024
    ds_write_b128 v13, v[120:123] offset:2048
    ds_write_b128 v13, v[124:127] offset:3072
    s_branch ssm_w2
ssm_w1:
    ds_write_b128 v13, v[96:99] offset:0
    ds_write_b128 v13, v[100:103] offset:1024
    ds_write_b128 v13, v[104:107] offset:2048
    ds_write_b128 v13, v[108:111] offset:3072
ssm_w2:
    ds_read_b64 v[32:33], v11 offset:0
    ds_read_b64 v[34:35], v11 offset:512
    ds_read_b64 v[36:37], v11 offset:1024
    ds_read_b64 v[38:39], v11 offset:1536
    s_waitcnt lgkmcnt(0)
    s_mov_b64 exec, 1
    ds_write_b32 v16, v20 offset:96
    s_mov_b64 exec, -1
    s_mov_b32 s59, 0
ssm_fe:
    ds_read_b32 v2, v17 offset:96
    s_waitcnt lgkmcnt(0)
    v_cmp_le_u32 vcc, 4, v2
    s_nop 3
    s_cmp_eq_u64 vcc, -1
    s_cbranch_scc1 ssm_fe_d
    s_add_u32 s59, s59, 1
    s_cmp_lt_u32 s59, 100000
    s_cbranch_scc0 ssm_fe_d
    s_sleep 1
    s_branch ssm_fe
ssm_fe_d:
    ds_read_b128 v[64:67], v14 offset:0
    ds_read_b128 v[68:71], v14 offset:1024
    ds_read_b128 v[72:75], v14 offset:2048
    ds_read_b128 v[76:79], v14 offset:3072
    v_lshlrev_b32 v40, 16, v32
    v_and_b32 v41, 0xffff0000, v32
    v_lshlrev_b32 v42, 16, v33
    v_and_b32 v43, 0xffff0000, v33
    v_lshlrev_b32 v44, 16, v34
    v_and_b32 v45, 0xffff0000, v34
    v_lshlrev_b32 v46, 16, v35
    v_and_b32 v47, 0xffff0000, v35
    v_lshlrev_b32 v48, 16, v36
    v_and_b32 v49, 0xffff0000, v36
    v_lshlrev_b32 v50, 16, v37
    v_and_b32 v51, 0xffff0000, v37
    v_lshlrev_b32 v52, 16, v38
    v_and_b32 v53, 0xffff0000, v38
    v_lshlrev_b32 v54, 16, v39
    v_and_b32 v55, 0xffff0000, v39
    v_mul_f32 v40, s44, v40
    v_mul_f32 v41, s44, v41
    v_mul_f32 v42, s44, v42
    v_mul_f32 v43, s44, v43
    v_mul_f32 v44, s44, v44
    v_mul_f32 v45, s44, v45
    v_mul_f32 v46, s44, v46
    v_mul_f32 v47, s44, v47
    v_mul_f32 v48, s44, v48
    v_mul_f32 v49, s44, v49
    v_mul_f32 v50, s44, v50
    v_mul_f32 v51, s44, v51
    v_mul_f32 v52, s44, v52
    v_mul_f32 v53, s44, v53
    v_mul_f32 v54, s44, v54
    v_mul_f32 v55, s44, v55
    v_cvt_pk_bf16_f32 v32, v40, v41
    v_cvt_pk_bf16_f32 v33, v42, v43
    v_cvt_pk_bf16_f32 v34, v44, v45
    v_cvt_pk_bf16_f32 v35, v46, v47
    v_cvt_pk_bf16_f32 v36, v48, v49
    v_cvt_pk_bf16_f32 v37, v50, v51
    v_cvt_pk_bf16_f32 v38, v52, v53
    v_cvt_pk_bf16_f32 v39, v54, v55
    v_lshlrev_b32 v40, 16, v32
    v_and_b32 v41, 0xffff0000, v32
    v_lshlrev_b32 v42, 16, v33
    v_and_b32 v43, 0xffff0000, v33
    v_lshlrev_b32 v44, 16, v34
    v_and_b32 v45, 0xffff0000, v34
    v_lshlrev_b32 v46, 16, v35
    v_and_b32 v47, 0xffff0000, v35
    v_lshlrev_b32 v48, 16, v36
    v_and_b32 v49, 0xffff0000, v36
    v_lshlrev_b32 v50, 16, v37
    v_and_b32 v51, 0xffff0000, v37
    v_lshlrev_b32 v52, 16, v38
    v_and_b32 v53, 0xffff0000, v38
    v_lshlrev_b32 v54, 16, v39
    v_and_b32 v55, 0xffff0000, v39
    s_waitcnt lgkmcnt(0)
    s_cmp_eq_u32 s9, 0
    s_cbranch_scc0 ssm_v1
    v_add_f32 v96, v96, v64
    v_add_f32 v97, v97, v65
    v_add_f32 v98, v98, v66
    v_add_f32 v99, v99, v67
    v_add_f32 v100, v100, v68
    v_add_f32 v101, v101, v69
    v_add_f32 v102, v102, v70
    v_add_f32 v103, v103, v71
    v_add_f32 v104, v104, v72
    v_add_f32 v105, v105, v73
    v_add_f32 v106, v106, v74
    v_add_f32 v107, v107, v75
    v_add_f32 v108, v108, v76
    v_add_f32 v109, v109, v77
    v_add_f32 v110, v110, v78
    v_add_f32 v111, v111, v79
    s_branch ssm_v2
ssm_v1:
    v_add_f32 v96, v112, v64
    v_add_f32 v97, v113, v65
    v_add_f32 v98, v114, v66
    v_add_f32 v99, v115, v67
    v_add_f32 v100, v116, v68
    v_add_f32 v101, v117, v69
    v_add_f32 v102, v118, v70
    v_add_f32 v103, v119, v71
    v_add_f32 v104, v120, v72
    v_add_f32 v105, v121, v73
    v_add_f32 v106, v122, v74
    v_add_f32 v107, v123, v75
    v_add_f32 v108, v124, v76
    v_add_f32 v109, v125, v77
    v_add_f32 v110, v126, v78
    v_add_f32 v111, v127, v79
ssm_v2:
    v_cvt_pk_bf16_f32 v32, v96, v97
    v_cvt_pk_bf16_f32 v33, v98, v99
    v_cvt_pk_bf16_f32 v34, v100, v101
    v_cvt_pk_bf16_f32 v35, v102, v103
    v_cvt_pk_bf16_f32 v36, v104, v105
    v_cvt_pk_bf16_f32 v37, v106, v107
    v_cvt_pk_bf16_f32 v38, v108, v109
    v_cvt_pk_bf16_f32 v39, v110, v111
    v_lshlrev_b32 v96, 16, v32
    v_and_b32 v97, 0xffff0000, v32
    v_lshlrev_b32 v98, 16, v33
    v_and_b32 v99, 0xffff0000, v33
    v_lshlrev_b32 v100, 16, v34
    v_and_b32 v101, 0xffff0000, v34
    v_lshlrev_b32 v102, 16, v35
    v_and_b32 v103, 0xffff0000, v35
    v_lshlrev_b32 v104, 16, v36
    v_and_b32 v105, 0xffff0000, v36
    v_lshlrev_b32 v106, 16, v37
    v_and_b32 v107, 0xffff0000, v37
    v_lshlrev_b32 v108, 16, v38
    v_and_b32 v109, 0xffff0000, v38
    v_lshlrev_b32 v110, 16, v39
    v_and_b32 v111, 0xffff0000, v39
    v_add_f32 v96, v96, v40
    v_add_f32 v97, v97, v41
    v_add_f32 v98, v98, v42
    v_add_f32 v99, v99, v43
    v_add_f32 v100, v100, v44
    v_add_f32 v101, v101, v45
    v_add_f32 v102, v102, v46
    v_add_f32 v103, v103, v47
    v_add_f32 v104, v104, v48
    v_add_f32 v105, v105, v49
    v_add_f32 v106, v106, v50
    v_add_f32 v107, v107, v51
    v_add_f32 v108, v108, v52
    v_add_f32 v109, v109, v53
    v_add_f32 v110, v110, v54
    v_add_f32 v111, v111, v55
    v_cvt_pk_bf16_f32 v32, v96, v97
    v_cvt_pk_bf16_f32 v33, v98, v99
    v_cvt_pk_bf16_f32 v34, v100, v101
    v_cvt_pk_bf16_f32 v35, v102, v103
    v_cvt_pk_bf16_f32 v36, v104, v105
    v_cvt_pk_bf16_f32 v37, v106, v107
    v_cvt_pk_bf16_f32 v38, v108, v109
    v_cvt_pk_bf16_f32 v39, v110, v111
    buffer_store_dwordx2 v[32:33], v12, s[36:39], s10 offen offset:0 sc1
    buffer_store_dwordx2 v[34:35], v12, s[36:39], s10 offen offset:512 sc1
    buffer_store_dwordx2 v[36:37], v12, s[36:39], s10 offen offset:1024 sc1
    buffer_store_dwordx2 v[38:39], v12, s[36:39], s10 offen offset:1536 sc1
    s_branch gated_mix__ssm_conv_s4__grouped_kv_mqa__prompt_kernel_ph2
gated_mix__ssm_conv_s4__grouped_kv_mqa__prompt_kernel_ph2:
    s_load_dwordx2 s[4:5], s[0:1], 136
    s_load_dwordx2 s[92:93], s[0:1], 120
    s_load_dwordx2 s[94:95], s[0:1], 128
    s_mov_b32 s3, s2
    s_and_b32 s26, s2, 7
    s_lshl_b32 s26, s26, 5
    s_lshr_b32 s27, s2, 6
    s_lshl_b32 s27, s27, 3
    s_or_b32 s26, s26, s27
    s_bfe_u32 s27, s2, 0x30003
    s_or_b32 s2, s26, s27
    s_lshr_b32 s79, s2, 3
    s_and_b32 s78, s2, 7
    s_cmp_ge_u32 s6, 8
    s_cbranch_scc1 gated_mix__ssm_conv_s4__grouped_kv_mqa__prompt_kernel_proj
    v_and_b32 v110, 31, v1
    v_lshrrev_b32 v111, 5, v1
    v_lshlrev_b32 v2, 4, v1
    v_lshlrev_b32 v3, 3, v110
    v_mul_u32_u24 v10, 320, v111
    v_lshl_add_u32 v10, v110, 4, v10
    s_lshl_b32 s26, s6, 10
    s_add_u32 s26, s26, 98304
    v_add_u32 v16, s26, v2
    s_lshl_b32 s26, s6, 8
    s_add_u32 s26, s26, 63488
    v_add_u32 v17, s26, v3
    s_mov_b32 s24, 0x000fffff
    s_mov_b32 s25, 0x000fffff
    v_cmp_eq_u32 vcc, 20, v110
    v_mov_b32 v19, 0x3f803f80
    v_mov_b32 v108, 0
    v_cndmask_b32 v108, v108, v19, vcc
    v_mov_b32 v92, v108
    v_mov_b32 v93, v108
    v_mov_b32 v94, v108
    v_mov_b32 v95, v108
    v_mov_b32 v96, v108
    v_mov_b32 v97, v108
    v_mov_b32 v98, v108
    v_mov_b32 v99, v108
    v_mov_b32 v100, v108
    v_mov_b32 v101, v108
    v_mov_b32 v102, v108
    v_mov_b32 v103, v108
    v_mov_b32 v104, v108
    v_mov_b32 v105, v108
    v_mov_b32 v106, v108
    v_mov_b32 v107, v108
    v_mov_b32 v48, 0
    v_mov_b32 v49, 0
    v_mov_b32 v50, 0
    v_mov_b32 v51, 0
    v_mov_b32 v52, 0
    v_mov_b32 v53, 0
    v_mov_b32 v54, 0
    v_mov_b32 v55, 0
    v_mov_b32 v56, 0
    v_mov_b32 v57, 0
    v_mov_b32 v58, 0
    v_mov_b32 v59, 0
    v_mov_b32 v60, 0
    v_mov_b32 v61, 0
    v_mov_b32 v62, 0
    v_mov_b32 v63, 0
    v_mov_b32 v8, 0
    v_mov_b32 v9, 0
    s_cmp_ge_u32 s6, 4
    s_cselect_b64 vcc, -1, 0
    s_waitcnt lgkmcnt(0)
    s_barrier
    ds_read_b128 v[4:7], v16
    s_mov_b32 exec_hi, 0
    ds_read_b64 v[8:9], v17
    s_mov_b64 exec, -1
    ds_read_b128 v[80:83], v2 offset:30720
    ds_read_b64 v[88:89], v3 offset:31744
    ds_read_b128 v[84:87], v2 offset:33280
    ds_read_b64 v[90:91], v3 offset:34304
    s_add_u32 s8, s4, 0x280000
    s_addc_u32 s9, s5, 0
    s_mov_b32 s10, 0x28000
    s_mov_b32 s11, 0x00020000
    s_add_u32 s16, s4, 0x800000
    s_addc_u32 s17, s5, 0
    s_mov_b32 s18, 0x280000
    s_mov_b32 s19, 0x00020000
    s_add_u32 s64, s4, 0xa80000
    s_addc_u32 s65, s5, 0
    s_mov_b32 s66, 0x280000
    s_mov_b32 s67, 0x00020000
    s_add_u32 s68, s4, 0x2b0000
    s_addc_u32 s69, s5, 0
    s_mov_b32 s70, 0x2000
    s_mov_b32 s71, 0x00020000
    s_mov_b32 s72, s92
    s_mov_b32 s73, s93
    s_mov_b32 s74, 0x280000
    s_mov_b32 s75, 0x00020000
    s_waitcnt lgkmcnt(2)
    v_mfma_f32_32x32x16_bf16 v[16:31], v[80:83], v[4:7], 0
    v_mfma_f32_32x32x8_bf16 v[16:31], v[88:89], v[8:9], v[16:31]
    s_nop 7
    s_nop 3
    s_setprio 0
    v_add_u32 v2, 65536, v2
    v_add_u32 v3, 65536, v3
    ds_read_b128 v[80:83], v2 offset:1024
    ds_read_b64 v[88:89], v3 offset:2048
    s_mov_b64 exec, s[24:25]
    ds_read_b128 v[92:95], v10 offset:32000
    ds_read_b128 v[96:99], v10 offset:32640
    s_mov_b64 exec, -1
    s_waitcnt lgkmcnt(4)
    v_mfma_f32_32x32x16_bf16 v[32:47], v[84:87], v[4:7], 0
    v_exp_f32 v16, v16
    v_exp_f32 v17, v17
    v_exp_f32 v18, v18
    v_exp_f32 v19, v19
    v_mfma_f32_32x32x8_bf16 v[32:47], v[90:91], v[8:9], v[32:47]
    v_exp_f32 v20, v20
    v_exp_f32 v21, v21
    v_exp_f32 v22, v22
    v_exp_f32 v23, v23
    v_cvt_pk_bf16_f32 v64, v16, v17
    v_cvt_pk_bf16_f32 v65, v18, v19
    v_exp_f32 v24, v24
    v_exp_f32 v25, v25
    v_exp_f32 v26, v26
    v_exp_f32 v27, v27
    v_cvt_pk_bf16_f32 v66, v20, v21
    v_cvt_pk_bf16_f32 v67, v22, v23
    v_exp_f32 v28, v28
    v_exp_f32 v29, v29
    v_exp_f32 v30, v30
    v_exp_f32 v31, v31
    v_cvt_pk_bf16_f32 v68, v24, v25
    v_cvt_pk_bf16_f32 v69, v26, v27
    v_cvt_pk_bf16_f32 v70, v28, v29
    v_cvt_pk_bf16_f32 v71, v30, v31
    s_cbranch_vccz gated_mix__ssm_conv_s4__grouped_kv_mqa__prompt_kernel_p_1
    s_setprio 1
gated_mix__ssm_conv_s4__grouped_kv_mqa__prompt_kernel_p_1:
    ds_read_b128 v[84:87], v2 offset:3584
    ds_read_b64 v[90:91], v3 offset:4608
    s_mov_b64 exec, s[24:25]
    ds_read_b128 v[100:103], v10 offset:34560
    ds_read_b128 v[104:107], v10 offset:35200
    s_mov_b64 exec, -1
    s_waitcnt lgkmcnt(4)
    v_mfma_f32_32x32x16_bf16 v[16:31], v[80:83], v[4:7], 0
    v_exp_f32 v32, v32
    v_exp_f32 v33, v33
    v_exp_f32 v34, v34
    v_exp_f32 v35, v35
    v_mfma_f32_32x32x8_bf16 v[16:31], v[88:89], v[8:9], v[16:31]
    v_exp_f32 v36, v36
    v_exp_f32 v37, v37
    v_exp_f32 v38, v38
    v_exp_f32 v39, v39
    v_cvt_pk_bf16_f32 v72, v32, v33
    v_cvt_pk_bf16_f32 v73, v34, v35
    v_mfma_f32_32x32x16_bf16 v[48:63], v[92:95], v[64:67], v[48:63]
    v_exp_f32 v40, v40
    v_exp_f32 v41, v41
    v_exp_f32 v42, v42
    v_exp_f32 v43, v43
    v_cvt_pk_bf16_f32 v74, v36, v37
    v_cvt_pk_bf16_f32 v75, v38, v39
    v_mfma_f32_32x32x16_bf16 v[48:63], v[96:99], v[68:71], v[48:63]
    v_exp_f32 v44, v44
    v_exp_f32 v45, v45
    v_exp_f32 v46, v46
    v_exp_f32 v47, v47
    v_cvt_pk_bf16_f32 v76, v40, v41
    v_cvt_pk_bf16_f32 v77, v42, v43
    v_cvt_pk_bf16_f32 v78, v44, v45
    v_cvt_pk_bf16_f32 v79, v46, v47
    v_add_u32 v2, 65536, v2
    v_add_u32 v3, 65536, v3
    ds_read_b128 v[80:83], v2 offset:2048
    ds_read_b64 v[88:89], v3 offset:3072
    v_add_u32 v10, 65536, v10
    s_mov_b64 exec, s[24:25]
    ds_read_b128 v[92:95], v10 offset:2304
    ds_read_b128 v[96:99], v10 offset:2944
    s_mov_b64 exec, -1
    s_waitcnt lgkmcnt(4)
    v_mfma_f32_32x32x16_bf16 v[32:47], v[84:87], v[4:7], 0
    v_exp_f32 v16, v16
    v_exp_f32 v17, v17
    v_exp_f32 v18, v18
    v_exp_f32 v19, v19
    v_mfma_f32_32x32x8_bf16 v[32:47], v[90:91], v[8:9], v[32:47]
    v_exp_f32 v20, v20
    v_exp_f32 v21, v21
    v_exp_f32 v22, v22
    v_exp_f32 v23, v23
    v_cvt_pk_bf16_f32 v64, v16, v17
    v_cvt_pk_bf16_f32 v65, v18, v19
    v_mfma_f32_32x32x16_bf16 v[48:63], v[100:103], v[72:75], v[48:63]
    v_exp_f32 v24, v24
    v_exp_f32 v25, v25
    v_exp_f32 v26, v26
    v_exp_f32 v27, v27
    v_cvt_pk_bf16_f32 v66, v20, v21
    v_cvt_pk_bf16_f32 v67, v22, v23
    v_mfma_f32_32x32x16_bf16 v[48:63], v[104:107], v[76:79], v[48:63]
    v_exp_f32 v28, v28
    v_exp_f32 v29, v29
    v_exp_f32 v30, v30
    v_exp_f32 v31, v31
    v_cvt_pk_bf16_f32 v68, v24, v25
    v_cvt_pk_bf16_f32 v69, v26, v27
    v_cvt_pk_bf16_f32 v70, v28, v29
    v_cvt_pk_bf16_f32 v71, v30, v31
    ds_read_b128 v[84:87], v2 offset:4608
    ds_read_b64 v[90:91], v3 offset:5632
    s_mov_b64 exec, s[24:25]
    ds_read_b128 v[100:103], v10 offset:4864
    ds_read_b128 v[104:107], v10 offset:5504
    s_mov_b64 exec, -1
    s_waitcnt lgkmcnt(4)
    v_mfma_f32_32x32x16_bf16 v[16:31], v[80:83], v[4:7], 0
    v_exp_f32 v32, v32
    v_exp_f32 v33, v33
    v_exp_f32 v34, v34
    v_exp_f32 v35, v35
    v_mfma_f32_32x32x8_bf16 v[16:31], v[88:89], v[8:9], v[16:31]
    v_exp_f32 v36, v36
    v_exp_f32 v37, v37
    v_exp_f32 v38, v38
    v_exp_f32 v39, v39
    v_cvt_pk_bf16_f32 v72, v32, v33
    v_cvt_pk_bf16_f32 v73, v34, v35
    v_mfma_f32_32x32x16_bf16 v[48:63], v[92:95], v[64:67], v[48:63]
    v_exp_f32 v40, v40
    v_exp_f32 v41, v41
    v_exp_f32 v42, v42
    v_exp_f32 v43, v43
    v_cvt_pk_bf16_f32 v74, v36, v37
    v_cvt_pk_bf16_f32 v75, v38, v39
    v_mfma_f32_32x32x16_bf16 v[48:63], v[96:99], v[68:71], v[48:63]
    v_exp_f32 v44, v44
    v_exp_f32 v45, v45
    v_exp_f32 v46, v46
    v_exp_f32 v47, v47
    v_cvt_pk_bf16_f32 v76, v40, v41
    v_cvt_pk_bf16_f32 v77, v42, v43
    v_cvt_pk_bf16_f32 v78, v44, v45
    v_cvt_pk_bf16_f32 v79, v46, v47
    s_setprio 0
    ds_read_b128 v[80:83], v2 offset:27648
    ds_read_b64 v[88:89], v3 offset:28672
    v_add_u32 v10, 65536, v10
    s_mov_b64 exec, s[24:25]
    ds_read_b128 v[92:95], v10 offset:3328
    ds_read_b128 v[96:99], v10 offset:3968
    s_mov_b64 exec, -1
    s_waitcnt lgkmcnt(4)
    v_mfma_f32_32x32x16_bf16 v[32:47], v[84:87], v[4:7], 0
    v_exp_f32 v16, v16
    v_exp_f32 v17, v17
    v_exp_f32 v18, v18
    v_exp_f32 v19, v19
    v_mfma_f32_32x32x8_bf16 v[32:47], v[90:91], v[8:9], v[32:47]
    v_exp_f32 v20, v20
    v_exp_f32 v21, v21
    v_exp_f32 v22, v22
    v_exp_f32 v23, v23
    v_cvt_pk_bf16_f32 v64, v16, v17
    v_cvt_pk_bf16_f32 v65, v18, v19
    v_mfma_f32_32x32x16_bf16 v[48:63], v[100:103], v[72:75], v[48:63]
    v_exp_f32 v24, v24
    v_exp_f32 v25, v25
    v_exp_f32 v26, v26
    v_exp_f32 v27, v27
    v_cvt_pk_bf16_f32 v66, v20, v21
    v_cvt_pk_bf16_f32 v67, v22, v23
    v_mfma_f32_32x32x16_bf16 v[48:63], v[104:107], v[76:79], v[48:63]
    v_exp_f32 v28, v28
    v_exp_f32 v29, v29
    v_exp_f32 v30, v30
    v_exp_f32 v31, v31
    v_cvt_pk_bf16_f32 v68, v24, v25
    v_cvt_pk_bf16_f32 v69, v26, v27
    v_cvt_pk_bf16_f32 v70, v28, v29
    v_cvt_pk_bf16_f32 v71, v30, v31
    s_cbranch_vccz gated_mix__ssm_conv_s4__grouped_kv_mqa__prompt_kernel_p_2
    s_setprio 1
gated_mix__ssm_conv_s4__grouped_kv_mqa__prompt_kernel_p_2:
    ds_read_b128 v[84:87], v2 offset:30208
    ds_read_b64 v[90:91], v3 offset:31232
    s_mov_b64 exec, s[24:25]
    ds_read_b128 v[100:103], v10 offset:5888
    ds_read_b128 v[104:107], v10 offset:6528
    s_mov_b64 exec, -1
    s_waitcnt lgkmcnt(4)
    v_mfma_f32_32x32x16_bf16 v[16:31], v[80:83], v[4:7], 0
    v_exp_f32 v32, v32
    v_exp_f32 v33, v33
    v_exp_f32 v34, v34
    v_exp_f32 v35, v35
    v_mfma_f32_32x32x8_bf16 v[16:31], v[88:89], v[8:9], v[16:31]
    v_exp_f32 v36, v36
    v_exp_f32 v37, v37
    v_exp_f32 v38, v38
    v_exp_f32 v39, v39
    v_cvt_pk_bf16_f32 v72, v32, v33
    v_cvt_pk_bf16_f32 v73, v34, v35
    v_mfma_f32_32x32x16_bf16 v[48:63], v[92:95], v[64:67], v[48:63]
    v_exp_f32 v40, v40
    v_exp_f32 v41, v41
    v_exp_f32 v42, v42
    v_exp_f32 v43, v43
    v_cvt_pk_bf16_f32 v74, v36, v37
    v_cvt_pk_bf16_f32 v75, v38, v39
    v_mfma_f32_32x32x16_bf16 v[48:63], v[96:99], v[68:71], v[48:63]
    v_exp_f32 v44, v44
    v_exp_f32 v45, v45
    v_exp_f32 v46, v46
    v_exp_f32 v47, v47
    v_cvt_pk_bf16_f32 v76, v40, v41
    v_cvt_pk_bf16_f32 v77, v42, v43
    v_cvt_pk_bf16_f32 v78, v44, v45
    v_cvt_pk_bf16_f32 v79, v46, v47
    s_waitcnt vmcnt(0)
    s_barrier
    v_subrev_u32 v2, 131072, v2
    v_subrev_u32 v3, 131072, v3
    ds_read_b128 v[80:83], v2 offset:0
    ds_read_b64 v[88:89], v3 offset:1024
    s_mov_b64 exec, s[24:25]
    ds_read_b128 v[92:95], v10 offset:28928
    ds_read_b128 v[96:99], v10 offset:29568
    s_mov_b64 exec, -1
    s_waitcnt lgkmcnt(4)
    v_mfma_f32_32x32x16_bf16 v[32:47], v[84:87], v[4:7], 0
    v_exp_f32 v16, v16
    v_exp_f32 v17, v17
    v_exp_f32 v18, v18
    v_exp_f32 v19, v19
    v_mfma_f32_32x32x8_bf16 v[32:47], v[90:91], v[8:9], v[32:47]
    v_exp_f32 v20, v20
    v_exp_f32 v21, v21
    v_exp_f32 v22, v22
    v_exp_f32 v23, v23
    v_cvt_pk_bf16_f32 v64, v16, v17
    v_cvt_pk_bf16_f32 v65, v18, v19
    v_mfma_f32_32x32x16_bf16 v[48:63], v[100:103], v[72:75], v[48:63]
    v_exp_f32 v24, v24
    v_exp_f32 v25, v25
    v_exp_f32 v26, v26
    v_exp_f32 v27, v27
    v_cvt_pk_bf16_f32 v66, v20, v21
    v_cvt_pk_bf16_f32 v67, v22, v23
    v_mfma_f32_32x32x16_bf16 v[48:63], v[104:107], v[76:79], v[48:63]
    v_exp_f32 v28, v28
    v_exp_f32 v29, v29
    v_exp_f32 v30, v30
    v_exp_f32 v31, v31
    v_cvt_pk_bf16_f32 v68, v24, v25
    v_cvt_pk_bf16_f32 v69, v26, v27
    v_cvt_pk_bf16_f32 v70, v28, v29
    v_cvt_pk_bf16_f32 v71, v30, v31
    ds_read_b128 v[84:87], v2 offset:2560
    ds_read_b64 v[90:91], v3 offset:3584
    s_mov_b64 exec, s[24:25]
    ds_read_b128 v[100:103], v10 offset:31488
    ds_read_b128 v[104:107], v10 offset:32128
    s_mov_b64 exec, -1
    s_waitcnt lgkmcnt(4)
    v_mfma_f32_32x32x16_bf16 v[16:31], v[80:83], v[4:7], 0
    v_exp_f32 v32, v32
    v_exp_f32 v33, v33
    v_exp_f32 v34, v34
    v_exp_f32 v35, v35
    v_mfma_f32_32x32x8_bf16 v[16:31], v[88:89], v[8:9], v[16:31]
    v_exp_f32 v36, v36
    v_exp_f32 v37, v37
    v_exp_f32 v38, v38
    v_exp_f32 v39, v39
    v_cvt_pk_bf16_f32 v72, v32, v33
    v_cvt_pk_bf16_f32 v73, v34, v35
    v_mfma_f32_32x32x16_bf16 v[48:63], v[92:95], v[64:67], v[48:63]
    v_exp_f32 v40, v40
    v_exp_f32 v41, v41
    v_exp_f32 v42, v42
    v_exp_f32 v43, v43
    v_cvt_pk_bf16_f32 v74, v36, v37
    v_cvt_pk_bf16_f32 v75, v38, v39
    v_mfma_f32_32x32x16_bf16 v[48:63], v[96:99], v[68:71], v[48:63]
    v_exp_f32 v44, v44
    v_exp_f32 v45, v45
    v_exp_f32 v46, v46
    v_exp_f32 v47, v47
    v_cvt_pk_bf16_f32 v76, v40, v41
    v_cvt_pk_bf16_f32 v77, v42, v43
    v_cvt_pk_bf16_f32 v78, v44, v45
    v_cvt_pk_bf16_f32 v79, v46, v47
    s_setprio 0
    ds_read_b128 v[80:83], v2 offset:5120
    ds_read_b64 v[88:89], v3 offset:6144
    v_subrev_u32 v10, 131072, v10
    s_mov_b64 exec, s[24:25]
    ds_read_b128 v[92:95], v10 offset:1280
    ds_read_b128 v[96:99], v10 offset:1920
    s_mov_b64 exec, -1
    s_waitcnt lgkmcnt(4)
    v_mfma_f32_32x32x16_bf16 v[32:47], v[84:87], v[4:7], 0
    v_exp_f32 v16, v16
    v_exp_f32 v17, v17
    v_exp_f32 v18, v18
    v_exp_f32 v19, v19
    v_mfma_f32_32x32x8_bf16 v[32:47], v[90:91], v[8:9], v[32:47]
    v_exp_f32 v20, v20
    v_exp_f32 v21, v21
    v_exp_f32 v22, v22
    v_exp_f32 v23, v23
    v_cvt_pk_bf16_f32 v64, v16, v17
    v_cvt_pk_bf16_f32 v65, v18, v19
    v_mfma_f32_32x32x16_bf16 v[48:63], v[100:103], v[72:75], v[48:63]
    v_exp_f32 v24, v24
    v_exp_f32 v25, v25
    v_exp_f32 v26, v26
    v_exp_f32 v27, v27
    v_cvt_pk_bf16_f32 v66, v20, v21
    v_cvt_pk_bf16_f32 v67, v22, v23
    v_mfma_f32_32x32x16_bf16 v[48:63], v[104:107], v[76:79], v[48:63]
    v_exp_f32 v28, v28
    v_exp_f32 v29, v29
    v_exp_f32 v30, v30
    v_exp_f32 v31, v31
    v_cvt_pk_bf16_f32 v68, v24, v25
    v_cvt_pk_bf16_f32 v69, v26, v27
    v_cvt_pk_bf16_f32 v70, v28, v29
    v_cvt_pk_bf16_f32 v71, v30, v31
    s_cbranch_vccz gated_mix__ssm_conv_s4__grouped_kv_mqa__prompt_kernel_p_3
    s_setprio 1
gated_mix__ssm_conv_s4__grouped_kv_mqa__prompt_kernel_p_3:
    ds_read_b128 v[84:87], v2 offset:7680
    ds_read_b64 v[90:91], v3 offset:8704
    s_mov_b64 exec, s[24:25]
    ds_read_b128 v[100:103], v10 offset:3840
    ds_read_b128 v[104:107], v10 offset:4480
    s_mov_b64 exec, -1
    s_waitcnt lgkmcnt(4)
    v_mfma_f32_32x32x16_bf16 v[16:31], v[80:83], v[4:7], 0
    v_exp_f32 v32, v32
    v_exp_f32 v33, v33
    v_exp_f32 v34, v34
    v_exp_f32 v35, v35
    v_mfma_f32_32x32x8_bf16 v[16:31], v[88:89], v[8:9], v[16:31]
    v_exp_f32 v36, v36
    v_exp_f32 v37, v37
    v_exp_f32 v38, v38
    v_exp_f32 v39, v39
    v_cvt_pk_bf16_f32 v72, v32, v33
    v_cvt_pk_bf16_f32 v73, v34, v35
    v_mfma_f32_32x32x16_bf16 v[48:63], v[92:95], v[64:67], v[48:63]
    v_exp_f32 v40, v40
    v_exp_f32 v41, v41
    v_exp_f32 v42, v42
    v_exp_f32 v43, v43
    v_cvt_pk_bf16_f32 v74, v36, v37
    v_cvt_pk_bf16_f32 v75, v38, v39
    v_mfma_f32_32x32x16_bf16 v[48:63], v[96:99], v[68:71], v[48:63]
    v_exp_f32 v44, v44
    v_exp_f32 v45, v45
    v_exp_f32 v46, v46
    v_exp_f32 v47, v47
    v_cvt_pk_bf16_f32 v76, v40, v41
    v_cvt_pk_bf16_f32 v77, v42, v43
    v_cvt_pk_bf16_f32 v78, v44, v45
    v_cvt_pk_bf16_f32 v79, v46, v47
    ds_read_b128 v[80:83], v2 offset:10240
    ds_read_b64 v[88:89], v3 offset:11264
    s_mov_b64 exec, s[24:25]
    ds_read_b128 v[92:95], v10 offset:6400
    ds_read_b128 v[96:99], v10 offset:7040
    s_mov_b64 exec, -1
    s_waitcnt lgkmcnt(4)
    v_mfma_f32_32x32x16_bf16 v[32:47], v[84:87], v[4:7], 0
    v_exp_f32 v16, v16
    v_exp_f32 v17, v17
    v_exp_f32 v18, v18
    v_exp_f32 v19, v19
    v_mfma_f32_32x32x8_bf16 v[32:47], v[90:91], v[8:9], v[32:47]
    v_exp_f32 v20, v20
    v_exp_f32 v21, v21
    v_exp_f32 v22, v22
    v_exp_f32 v23, v23
    v_cvt_pk_bf16_f32 v64, v16, v17
    v_cvt_pk_bf16_f32 v65, v18, v19
    v_mfma_f32_32x32x16_bf16 v[48:63], v[100:103], v[72:75], v[48:63]
    v_exp_f32 v24, v24
    v_exp_f32 v25, v25
    v_exp_f32 v26, v26
    v_exp_f32 v27, v27
    v_cvt_pk_bf16_f32 v66, v20, v21
    v_cvt_pk_bf16_f32 v67, v22, v23
    v_mfma_f32_32x32x16_bf16 v[48:63], v[104:107], v[76:79], v[48:63]
    v_exp_f32 v28, v28
    v_exp_f32 v29, v29
    v_exp_f32 v30, v30
    v_exp_f32 v31, v31
    v_cvt_pk_bf16_f32 v68, v24, v25
    v_cvt_pk_bf16_f32 v69, v26, v27
    v_cvt_pk_bf16_f32 v70, v28, v29
    v_cvt_pk_bf16_f32 v71, v30, v31
    ds_read_b128 v[84:87], v2 offset:12800
    ds_read_b64 v[90:91], v3 offset:13824
    s_mov_b64 exec, s[24:25]
    ds_read_b128 v[100:103], v10 offset:8960
    ds_read_b128 v[104:107], v10 offset:9600
    s_mov_b64 exec, -1
    s_waitcnt lgkmcnt(4)
    v_mfma_f32_32x32x16_bf16 v[16:31], v[80:83], v[4:7], 0
    v_exp_f32 v32, v32
    v_exp_f32 v33, v33
    v_exp_f32 v34, v34
    v_exp_f32 v35, v35
    v_mfma_f32_32x32x8_bf16 v[16:31], v[88:89], v[8:9], v[16:31]
    v_exp_f32 v36, v36
    v_exp_f32 v37, v37
    v_exp_f32 v38, v38
    v_exp_f32 v39, v39
    v_cvt_pk_bf16_f32 v72, v32, v33
    v_cvt_pk_bf16_f32 v73, v34, v35
    v_mfma_f32_32x32x16_bf16 v[48:63], v[92:95], v[64:67], v[48:63]
    v_exp_f32 v40, v40
    v_exp_f32 v41, v41
    v_exp_f32 v42, v42
    v_exp_f32 v43, v43
    v_cvt_pk_bf16_f32 v74, v36, v37
    v_cvt_pk_bf16_f32 v75, v38, v39
    v_mfma_f32_32x32x16_bf16 v[48:63], v[96:99], v[68:71], v[48:63]
    v_exp_f32 v44, v44
    v_exp_f32 v45, v45
    v_exp_f32 v46, v46
    v_exp_f32 v47, v47
    v_cvt_pk_bf16_f32 v76, v40, v41
    v_cvt_pk_bf16_f32 v77, v42, v43
    v_cvt_pk_bf16_f32 v78, v44, v45
    v_cvt_pk_bf16_f32 v79, v46, v47
    s_setprio 0
    ds_read_b128 v[80:83], v2 offset:15360
    ds_read_b64 v[88:89], v3 offset:16384
    s_mov_b64 exec, s[24:25]
    ds_read_b128 v[92:95], v10 offset:11520
    ds_read_b128 v[96:99], v10 offset:12160
    s_mov_b64 exec, -1
    s_waitcnt lgkmcnt(4)
    v_mfma_f32_32x32x16_bf16 v[32:47], v[84:87], v[4:7], 0
    v_exp_f32 v16, v16
    v_exp_f32 v17, v17
    v_exp_f32 v18, v18
    v_exp_f32 v19, v19
    v_mfma_f32_32x32x8_bf16 v[32:47], v[90:91], v[8:9], v[32:47]
    v_exp_f32 v20, v20
    v_exp_f32 v21, v21
    v_exp_f32 v22, v22
    v_exp_f32 v23, v23
    v_cvt_pk_bf16_f32 v64, v16, v17
    v_cvt_pk_bf16_f32 v65, v18, v19
    v_mfma_f32_32x32x16_bf16 v[48:63], v[100:103], v[72:75], v[48:63]
    v_exp_f32 v24, v24
    v_exp_f32 v25, v25
    v_exp_f32 v26, v26
    v_exp_f32 v27, v27
    v_cvt_pk_bf16_f32 v66, v20, v21
    v_cvt_pk_bf16_f32 v67, v22, v23
    v_mfma_f32_32x32x16_bf16 v[48:63], v[104:107], v[76:79], v[48:63]
    v_exp_f32 v28, v28
    v_exp_f32 v29, v29
    v_exp_f32 v30, v30
    v_exp_f32 v31, v31
    v_cvt_pk_bf16_f32 v68, v24, v25
    v_cvt_pk_bf16_f32 v69, v26, v27
    v_cvt_pk_bf16_f32 v70, v28, v29
    v_cvt_pk_bf16_f32 v71, v30, v31
    s_cbranch_vccz gated_mix__ssm_conv_s4__grouped_kv_mqa__prompt_kernel_p_4
    s_setprio 1
gated_mix__ssm_conv_s4__grouped_kv_mqa__prompt_kernel_p_4:
    ds_read_b128 v[84:87], v2 offset:17920
    ds_read_b64 v[90:91], v3 offset:18944
    s_mov_b64 exec, s[24:25]
    ds_read_b128 v[100:103], v10 offset:14080
    ds_read_b128 v[104:107], v10 offset:14720
    s_mov_b64 exec, -1
    s_waitcnt lgkmcnt(4)
    v_mfma_f32_32x32x16_bf16 v[16:31], v[80:83], v[4:7], 0
    v_exp_f32 v32, v32
    v_exp_f32 v33, v33
    v_exp_f32 v34, v34
    v_exp_f32 v35, v35
    v_mfma_f32_32x32x8_bf16 v[16:31], v[88:89], v[8:9], v[16:31]
    v_exp_f32 v36, v36
    v_exp_f32 v37, v37
    v_exp_f32 v38, v38
    v_exp_f32 v39, v39
    v_cvt_pk_bf16_f32 v72, v32, v33
    v_cvt_pk_bf16_f32 v73, v34, v35
    v_mfma_f32_32x32x16_bf16 v[48:63], v[92:95], v[64:67], v[48:63]
    v_exp_f32 v40, v40
    v_exp_f32 v41, v41
    v_exp_f32 v42, v42
    v_exp_f32 v43, v43
    v_cvt_pk_bf16_f32 v74, v36, v37
    v_cvt_pk_bf16_f32 v75, v38, v39
    v_mfma_f32_32x32x16_bf16 v[48:63], v[96:99], v[68:71], v[48:63]
    v_exp_f32 v44, v44
    v_exp_f32 v45, v45
    v_exp_f32 v46, v46
    v_exp_f32 v47, v47
    v_cvt_pk_bf16_f32 v76, v40, v41
    v_cvt_pk_bf16_f32 v77, v42, v43
    v_cvt_pk_bf16_f32 v78, v44, v45
    v_cvt_pk_bf16_f32 v79, v46, v47
    ds_read_b128 v[80:83], v2 offset:20480
    ds_read_b64 v[88:89], v3 offset:21504
    s_mov_b64 exec, s[24:25]
    ds_read_b128 v[92:95], v10 offset:16640
    ds_read_b128 v[96:99], v10 offset:17280
    s_mov_b64 exec, -1
    s_waitcnt lgkmcnt(4)
    v_mfma_f32_32x32x16_bf16 v[32:47], v[84:87], v[4:7], 0
    v_exp_f32 v16, v16
    v_exp_f32 v17, v17
    v_exp_f32 v18, v18
    v_exp_f32 v19, v19
    v_mfma_f32_32x32x8_bf16 v[32:47], v[90:91], v[8:9], v[32:47]
    v_exp_f32 v20, v20
    v_exp_f32 v21, v21
    v_exp_f32 v22, v22
    v_exp_f32 v23, v23
    v_cvt_pk_bf16_f32 v64, v16, v17
    v_cvt_pk_bf16_f32 v65, v18, v19
    v_mfma_f32_32x32x16_bf16 v[48:63], v[100:103], v[72:75], v[48:63]
    v_exp_f32 v24, v24
    v_exp_f32 v25, v25
    v_exp_f32 v26, v26
    v_exp_f32 v27, v27
    v_cvt_pk_bf16_f32 v66, v20, v21
    v_cvt_pk_bf16_f32 v67, v22, v23
    v_mfma_f32_32x32x16_bf16 v[48:63], v[104:107], v[76:79], v[48:63]
    v_exp_f32 v28, v28
    v_exp_f32 v29, v29
    v_exp_f32 v30, v30
    v_exp_f32 v31, v31
    v_cvt_pk_bf16_f32 v68, v24, v25
    v_cvt_pk_bf16_f32 v69, v26, v27
    v_cvt_pk_bf16_f32 v70, v28, v29
    v_cvt_pk_bf16_f32 v71, v30, v31
    ds_read_b128 v[84:87], v2 offset:23040
    ds_read_b64 v[90:91], v3 offset:24064
    s_mov_b64 exec, s[24:25]
    ds_read_b128 v[100:103], v10 offset:19200
    ds_read_b128 v[104:107], v10 offset:19840
    s_mov_b64 exec, -1
    s_waitcnt lgkmcnt(4)
    v_mfma_f32_32x32x16_bf16 v[16:31], v[80:83], v[4:7], 0
    v_exp_f32 v32, v32
    v_exp_f32 v33, v33
    v_exp_f32 v34, v34
    v_exp_f32 v35, v35
    v_mfma_f32_32x32x8_bf16 v[16:31], v[88:89], v[8:9], v[16:31]
    v_exp_f32 v36, v36
    v_exp_f32 v37, v37
    v_exp_f32 v38, v38
    v_exp_f32 v39, v39
    v_cvt_pk_bf16_f32 v72, v32, v33
    v_cvt_pk_bf16_f32 v73, v34, v35
    v_mfma_f32_32x32x16_bf16 v[48:63], v[92:95], v[64:67], v[48:63]
    v_exp_f32 v40, v40
    v_exp_f32 v41, v41
    v_exp_f32 v42, v42
    v_exp_f32 v43, v43
    v_cvt_pk_bf16_f32 v74, v36, v37
    v_cvt_pk_bf16_f32 v75, v38, v39
    v_mfma_f32_32x32x16_bf16 v[48:63], v[96:99], v[68:71], v[48:63]
    v_exp_f32 v44, v44
    v_exp_f32 v45, v45
    v_exp_f32 v46, v46
    v_exp_f32 v47, v47
    v_cvt_pk_bf16_f32 v76, v40, v41
    v_cvt_pk_bf16_f32 v77, v42, v43
    v_cvt_pk_bf16_f32 v78, v44, v45
    v_cvt_pk_bf16_f32 v79, v46, v47
    s_setprio 0
    ds_read_b128 v[80:83], v2 offset:25600
    ds_read_b64 v[88:89], v3 offset:26624
    s_mov_b64 exec, s[24:25]
    ds_read_b128 v[92:95], v10 offset:21760
    ds_read_b128 v[96:99], v10 offset:22400
    s_mov_b64 exec, -1
    s_waitcnt lgkmcnt(4)
    v_mfma_f32_32x32x16_bf16 v[32:47], v[84:87], v[4:7], 0
    v_exp_f32 v16, v16
    v_exp_f32 v17, v17
    v_exp_f32 v18, v18
    v_exp_f32 v19, v19
    v_mfma_f32_32x32x8_bf16 v[32:47], v[90:91], v[8:9], v[32:47]
    v_exp_f32 v20, v20
    v_exp_f32 v21, v21
    v_exp_f32 v22, v22
    v_exp_f32 v23, v23
    v_cvt_pk_bf16_f32 v64, v16, v17
    v_cvt_pk_bf16_f32 v65, v18, v19
    v_mfma_f32_32x32x16_bf16 v[48:63], v[100:103], v[72:75], v[48:63]
    v_exp_f32 v24, v24
    v_exp_f32 v25, v25
    v_exp_f32 v26, v26
    v_exp_f32 v27, v27
    v_cvt_pk_bf16_f32 v66, v20, v21
    v_cvt_pk_bf16_f32 v67, v22, v23
    v_mfma_f32_32x32x16_bf16 v[48:63], v[104:107], v[76:79], v[48:63]
    v_exp_f32 v28, v28
    v_exp_f32 v29, v29
    v_exp_f32 v30, v30
    v_exp_f32 v31, v31
    v_cvt_pk_bf16_f32 v68, v24, v25
    v_cvt_pk_bf16_f32 v69, v26, v27
    v_cvt_pk_bf16_f32 v70, v28, v29
    v_cvt_pk_bf16_f32 v71, v30, v31
    s_cbranch_vccz gated_mix__ssm_conv_s4__grouped_kv_mqa__prompt_kernel_p_5
    s_setprio 1
gated_mix__ssm_conv_s4__grouped_kv_mqa__prompt_kernel_p_5:
    ds_read_b128 v[84:87], v2 offset:28160
    ds_read_b64 v[90:91], v3 offset:29184
    s_mov_b64 exec, s[24:25]
    ds_read_b128 v[100:103], v10 offset:24320
    ds_read_b128 v[104:107], v10 offset:24960
    s_mov_b64 exec, -1
    s_waitcnt lgkmcnt(4)
    v_mfma_f32_32x32x16_bf16 v[16:31], v[80:83], v[4:7], 0
    v_exp_f32 v32, v32
    v_exp_f32 v33, v33
    v_exp_f32 v34, v34
    v_exp_f32 v35, v35
    v_mfma_f32_32x32x8_bf16 v[16:31], v[88:89], v[8:9], v[16:31]
    v_exp_f32 v36, v36
    v_exp_f32 v37, v37
    v_exp_f32 v38, v38
    v_exp_f32 v39, v39
    v_cvt_pk_bf16_f32 v72, v32, v33
    v_cvt_pk_bf16_f32 v73, v34, v35
    v_mfma_f32_32x32x16_bf16 v[48:63], v[92:95], v[64:67], v[48:63]
    v_exp_f32 v40, v40
    v_exp_f32 v41, v41
    v_exp_f32 v42, v42
    v_exp_f32 v43, v43
    v_cvt_pk_bf16_f32 v74, v36, v37
    v_cvt_pk_bf16_f32 v75, v38, v39
    v_mfma_f32_32x32x16_bf16 v[48:63], v[96:99], v[68:71], v[48:63]
    v_exp_f32 v44, v44
    v_exp_f32 v45, v45
    v_exp_f32 v46, v46
    v_exp_f32 v47, v47
    v_cvt_pk_bf16_f32 v76, v40, v41
    v_cvt_pk_bf16_f32 v77, v42, v43
    v_cvt_pk_bf16_f32 v78, v44, v45
    v_cvt_pk_bf16_f32 v79, v46, v47
    ds_read_b128 v[80:83], v2 offset:35840
    ds_read_b64 v[88:89], v3 offset:36864
    s_mov_b64 exec, s[24:25]
    ds_read_b128 v[92:95], v10 offset:26880
    ds_read_b128 v[96:99], v10 offset:27520
    s_mov_b64 exec, -1
    s_waitcnt lgkmcnt(4)
    v_mfma_f32_32x32x16_bf16 v[32:47], v[84:87], v[4:7], 0
    v_exp_f32 v16, v16
    v_exp_f32 v17, v17
    v_exp_f32 v18, v18
    v_exp_f32 v19, v19
    v_mfma_f32_32x32x8_bf16 v[32:47], v[90:91], v[8:9], v[32:47]
    v_exp_f32 v20, v20
    v_exp_f32 v21, v21
    v_exp_f32 v22, v22
    v_exp_f32 v23, v23
    v_cvt_pk_bf16_f32 v64, v16, v17
    v_cvt_pk_bf16_f32 v65, v18, v19
    v_mfma_f32_32x32x16_bf16 v[48:63], v[100:103], v[72:75], v[48:63]
    v_exp_f32 v24, v24
    v_exp_f32 v25, v25
    v_exp_f32 v26, v26
    v_exp_f32 v27, v27
    v_cvt_pk_bf16_f32 v66, v20, v21
    v_cvt_pk_bf16_f32 v67, v22, v23
    v_mfma_f32_32x32x16_bf16 v[48:63], v[104:107], v[76:79], v[48:63]
    v_exp_f32 v28, v28
    v_exp_f32 v29, v29
    v_exp_f32 v30, v30
    v_exp_f32 v31, v31
    v_cvt_pk_bf16_f32 v68, v24, v25
    v_cvt_pk_bf16_f32 v69, v26, v27
    v_cvt_pk_bf16_f32 v70, v28, v29
    v_cvt_pk_bf16_f32 v71, v30, v31
    ds_read_b128 v[84:87], v2 offset:38400
    ds_read_b64 v[90:91], v3 offset:39424
    s_mov_b64 exec, s[24:25]
    ds_read_b128 v[100:103], v10 offset:29440
    ds_read_b128 v[104:107], v10 offset:30080
    s_mov_b64 exec, -1
    s_waitcnt lgkmcnt(4)
    v_mfma_f32_32x32x16_bf16 v[16:31], v[80:83], v[4:7], 0
    v_exp_f32 v32, v32
    v_exp_f32 v33, v33
    v_exp_f32 v34, v34
    v_exp_f32 v35, v35
    v_mfma_f32_32x32x8_bf16 v[16:31], v[88:89], v[8:9], v[16:31]
    v_exp_f32 v36, v36
    v_exp_f32 v37, v37
    v_exp_f32 v38, v38
    v_exp_f32 v39, v39
    v_cvt_pk_bf16_f32 v72, v32, v33
    v_cvt_pk_bf16_f32 v73, v34, v35
    v_mfma_f32_32x32x16_bf16 v[48:63], v[92:95], v[64:67], v[48:63]
    v_exp_f32 v40, v40
    v_exp_f32 v41, v41
    v_exp_f32 v42, v42
    v_exp_f32 v43, v43
    v_cvt_pk_bf16_f32 v74, v36, v37
    v_cvt_pk_bf16_f32 v75, v38, v39
    v_mfma_f32_32x32x16_bf16 v[48:63], v[96:99], v[68:71], v[48:63]
    v_exp_f32 v44, v44
    v_exp_f32 v45, v45
    v_exp_f32 v46, v46
    v_exp_f32 v47, v47
    v_cvt_pk_bf16_f32 v76, v40, v41
    v_cvt_pk_bf16_f32 v77, v42, v43
    v_cvt_pk_bf16_f32 v78, v44, v45
    v_cvt_pk_bf16_f32 v79, v46, v47
    s_setprio 0
    ds_read_b128 v[80:83], v2 offset:40960
    ds_read_b64 v[88:89], v3 offset:41984
    s_mov_b64 exec, s[24:25]
    ds_read_b128 v[92:95], v10 offset:37120
    ds_read_b128 v[96:99], v10 offset:37760
    s_mov_b64 exec, -1
    s_waitcnt lgkmcnt(4)
    v_mfma_f32_32x32x16_bf16 v[32:47], v[84:87], v[4:7], 0
    v_exp_f32 v16, v16
    v_exp_f32 v17, v17
    v_exp_f32 v18, v18
    v_exp_f32 v19, v19
    v_mfma_f32_32x32x8_bf16 v[32:47], v[90:91], v[8:9], v[32:47]
    v_exp_f32 v20, v20
    v_exp_f32 v21, v21
    v_exp_f32 v22, v22
    v_exp_f32 v23, v23
    v_cvt_pk_bf16_f32 v64, v16, v17
    v_cvt_pk_bf16_f32 v65, v18, v19
    v_mfma_f32_32x32x16_bf16 v[48:63], v[100:103], v[72:75], v[48:63]
    v_exp_f32 v24, v24
    v_exp_f32 v25, v25
    v_exp_f32 v26, v26
    v_exp_f32 v27, v27
    v_cvt_pk_bf16_f32 v66, v20, v21
    v_cvt_pk_bf16_f32 v67, v22, v23
    v_mfma_f32_32x32x16_bf16 v[48:63], v[104:107], v[76:79], v[48:63]
    v_exp_f32 v28, v28
    v_exp_f32 v29, v29
    v_exp_f32 v30, v30
    v_exp_f32 v31, v31
    v_cvt_pk_bf16_f32 v68, v24, v25
    v_cvt_pk_bf16_f32 v69, v26, v27
    v_cvt_pk_bf16_f32 v70, v28, v29
    v_cvt_pk_bf16_f32 v71, v30, v31
    s_cbranch_vccz gated_mix__ssm_conv_s4__grouped_kv_mqa__prompt_kernel_p_6
    s_setprio 1
gated_mix__ssm_conv_s4__grouped_kv_mqa__prompt_kernel_p_6:
    ds_read_b128 v[84:87], v2 offset:43520
    ds_read_b64 v[90:91], v3 offset:44544
    s_mov_b64 exec, s[24:25]
    ds_read_b128 v[100:103], v10 offset:39680
    ds_read_b128 v[104:107], v10 offset:40320
    s_mov_b64 exec, -1
    s_waitcnt lgkmcnt(4)
    v_mfma_f32_32x32x16_bf16 v[16:31], v[80:83], v[4:7], 0
    v_exp_f32 v32, v32
    v_exp_f32 v33, v33
    v_exp_f32 v34, v34
    v_exp_f32 v35, v35
    v_mfma_f32_32x32x8_bf16 v[16:31], v[88:89], v[8:9], v[16:31]
    v_exp_f32 v36, v36
    v_exp_f32 v37, v37
    v_exp_f32 v38, v38
    v_exp_f32 v39, v39
    v_cvt_pk_bf16_f32 v72, v32, v33
    v_cvt_pk_bf16_f32 v73, v34, v35
    v_mfma_f32_32x32x16_bf16 v[48:63], v[92:95], v[64:67], v[48:63]
    v_exp_f32 v40, v40
    v_exp_f32 v41, v41
    v_exp_f32 v42, v42
    v_exp_f32 v43, v43
    v_cvt_pk_bf16_f32 v74, v36, v37
    v_cvt_pk_bf16_f32 v75, v38, v39
    v_mfma_f32_32x32x16_bf16 v[48:63], v[96:99], v[68:71], v[48:63]
    v_exp_f32 v44, v44
    v_exp_f32 v45, v45
    v_exp_f32 v46, v46
    v_exp_f32 v47, v47
    v_cvt_pk_bf16_f32 v76, v40, v41
    v_cvt_pk_bf16_f32 v77, v42, v43
    v_cvt_pk_bf16_f32 v78, v44, v45
    v_cvt_pk_bf16_f32 v79, v46, v47
    s_barrier
    ds_read_b128 v[80:83], v2 offset:46080
    ds_read_b64 v[88:89], v3 offset:47104
    s_mov_b64 exec, s[24:25]
    ds_read_b128 v[92:95], v10 offset:42240
    ds_read_b128 v[96:99], v10 offset:42880
    s_mov_b64 exec, -1
    s_waitcnt lgkmcnt(4)
    v_mfma_f32_32x32x16_bf16 v[32:47], v[84:87], v[4:7], 0
    v_exp_f32 v16, v16
    v_exp_f32 v17, v17
    v_exp_f32 v18, v18
    v_exp_f32 v19, v19
    v_mfma_f32_32x32x8_bf16 v[32:47], v[90:91], v[8:9], v[32:47]
    v_exp_f32 v20, v20
    v_exp_f32 v21, v21
    v_exp_f32 v22, v22
    v_exp_f32 v23, v23
    v_cvt_pk_bf16_f32 v64, v16, v17
    v_cvt_pk_bf16_f32 v65, v18, v19
    v_mfma_f32_32x32x16_bf16 v[48:63], v[100:103], v[72:75], v[48:63]
    v_exp_f32 v24, v24
    v_exp_f32 v25, v25
    v_exp_f32 v26, v26
    v_exp_f32 v27, v27
    v_cvt_pk_bf16_f32 v66, v20, v21
    v_cvt_pk_bf16_f32 v67, v22, v23
    v_mfma_f32_32x32x16_bf16 v[48:63], v[104:107], v[76:79], v[48:63]
    v_exp_f32 v28, v28
    v_exp_f32 v29, v29
    v_exp_f32 v30, v30
    v_exp_f32 v31, v31
    v_cvt_pk_bf16_f32 v68, v24, v25
    v_cvt_pk_bf16_f32 v69, v26, v27
    v_cvt_pk_bf16_f32 v70, v28, v29
    v_cvt_pk_bf16_f32 v71, v30, v31
    ds_read_b128 v[84:87], v2 offset:48640
    ds_read_b64 v[90:91], v3 offset:49664
    s_mov_b64 exec, s[24:25]
    ds_read_b128 v[100:103], v10 offset:44800
    ds_read_b128 v[104:107], v10 offset:45440
    s_mov_b64 exec, -1
    s_waitcnt lgkmcnt(4)
    v_mfma_f32_32x32x16_bf16 v[16:31], v[80:83], v[4:7], 0
    v_exp_f32 v32, v32
    v_exp_f32 v33, v33
    v_exp_f32 v34, v34
    v_exp_f32 v35, v35
    v_mfma_f32_32x32x8_bf16 v[16:31], v[88:89], v[8:9], v[16:31]
    v_exp_f32 v36, v36
    v_exp_f32 v37, v37
    v_exp_f32 v38, v38
    v_exp_f32 v39, v39
    v_cvt_pk_bf16_f32 v72, v32, v33
    v_cvt_pk_bf16_f32 v73, v34, v35
    v_mfma_f32_32x32x16_bf16 v[48:63], v[92:95], v[64:67], v[48:63]
    v_exp_f32 v40, v40
    v_exp_f32 v41, v41
    v_exp_f32 v42, v42
    v_exp_f32 v43, v43
    v_cvt_pk_bf16_f32 v74, v36, v37
    v_cvt_pk_bf16_f32 v75, v38, v39
    v_mfma_f32_32x32x16_bf16 v[48:63], v[96:99], v[68:71], v[48:63]
    v_exp_f32 v44, v44
    v_exp_f32 v45, v45
    v_exp_f32 v46, v46
    v_exp_f32 v47, v47
    v_cvt_pk_bf16_f32 v76, v40, v41
    v_cvt_pk_bf16_f32 v77, v42, v43
    v_cvt_pk_bf16_f32 v78, v44, v45
    v_cvt_pk_bf16_f32 v79, v46, v47
    s_setprio 0
    ds_read_b128 v[80:83], v2 offset:51200
    ds_read_b64 v[88:89], v3 offset:52224
    s_mov_b64 exec, s[24:25]
    ds_read_b128 v[92:95], v10 offset:47360
    ds_read_b128 v[96:99], v10 offset:48000
    s_mov_b64 exec, -1
    s_waitcnt lgkmcnt(4)
    v_mfma_f32_32x32x16_bf16 v[32:47], v[84:87], v[4:7], 0
    v_exp_f32 v16, v16
    v_exp_f32 v17, v17
    v_exp_f32 v18, v18
    v_exp_f32 v19, v19
    v_mfma_f32_32x32x8_bf16 v[32:47], v[90:91], v[8:9], v[32:47]
    v_exp_f32 v20, v20
    v_exp_f32 v21, v21
    v_exp_f32 v22, v22
    v_exp_f32 v23, v23
    v_cvt_pk_bf16_f32 v64, v16, v17
    v_cvt_pk_bf16_f32 v65, v18, v19
    v_mfma_f32_32x32x16_bf16 v[48:63], v[100:103], v[72:75], v[48:63]
    v_exp_f32 v24, v24
    v_exp_f32 v25, v25
    v_exp_f32 v26, v26
    v_exp_f32 v27, v27
    v_cvt_pk_bf16_f32 v66, v20, v21
    v_cvt_pk_bf16_f32 v67, v22, v23
    v_mfma_f32_32x32x16_bf16 v[48:63], v[104:107], v[76:79], v[48:63]
    v_exp_f32 v28, v28
    v_exp_f32 v29, v29
    v_exp_f32 v30, v30
    v_exp_f32 v31, v31
    v_cvt_pk_bf16_f32 v68, v24, v25
    v_cvt_pk_bf16_f32 v69, v26, v27
    v_cvt_pk_bf16_f32 v70, v28, v29
    v_cvt_pk_bf16_f32 v71, v30, v31
    s_cbranch_vccz gated_mix__ssm_conv_s4__grouped_kv_mqa__prompt_kernel_p_7
    s_setprio 1
gated_mix__ssm_conv_s4__grouped_kv_mqa__prompt_kernel_p_7:
    ds_read_b128 v[84:87], v2 offset:53760
    ds_read_b64 v[90:91], v3 offset:54784
    s_mov_b64 exec, s[24:25]
    ds_read_b128 v[100:103], v10 offset:49920
    ds_read_b128 v[104:107], v10 offset:50560
    s_mov_b64 exec, -1
    s_waitcnt lgkmcnt(4)
    v_mfma_f32_32x32x16_bf16 v[16:31], v[80:83], v[4:7], 0
    v_exp_f32 v32, v32
    v_exp_f32 v33, v33
    v_exp_f32 v34, v34
    v_exp_f32 v35, v35
    v_mfma_f32_32x32x8_bf16 v[16:31], v[88:89], v[8:9], v[16:31]
    v_exp_f32 v36, v36
    v_exp_f32 v37, v37
    v_exp_f32 v38, v38
    v_exp_f32 v39, v39
    v_cvt_pk_bf16_f32 v72, v32, v33
    v_cvt_pk_bf16_f32 v73, v34, v35
    v_mfma_f32_32x32x16_bf16 v[48:63], v[92:95], v[64:67], v[48:63]
    v_exp_f32 v40, v40
    v_exp_f32 v41, v41
    v_exp_f32 v42, v42
    v_exp_f32 v43, v43
    v_cvt_pk_bf16_f32 v74, v36, v37
    v_cvt_pk_bf16_f32 v75, v38, v39
    v_mfma_f32_32x32x16_bf16 v[48:63], v[96:99], v[68:71], v[48:63]
    v_exp_f32 v44, v44
    v_exp_f32 v45, v45
    v_exp_f32 v46, v46
    v_exp_f32 v47, v47
    v_cvt_pk_bf16_f32 v76, v40, v41
    v_cvt_pk_bf16_f32 v77, v42, v43
    v_cvt_pk_bf16_f32 v78, v44, v45
    v_cvt_pk_bf16_f32 v79, v46, v47
    ds_read_b128 v[80:83], v2 offset:56320
    ds_read_b64 v[88:89], v3 offset:57344
    s_mov_b64 exec, s[24:25]
    ds_read_b128 v[92:95], v10 offset:52480
    ds_read_b128 v[96:99], v10 offset:53120
    s_mov_b64 exec, -1
    s_waitcnt lgkmcnt(4)
    v_mfma_f32_32x32x16_bf16 v[32:47], v[84:87], v[4:7], 0
    v_exp_f32 v16, v16
    v_exp_f32 v17, v17
    v_exp_f32 v18, v18
    v_exp_f32 v19, v19
    v_mfma_f32_32x32x8_bf16 v[32:47], v[90:91], v[8:9], v[32:47]
    v_exp_f32 v20, v20
    v_exp_f32 v21, v21
    v_exp_f32 v22, v22
    v_exp_f32 v23, v23
    v_cvt_pk_bf16_f32 v64, v16, v17
    v_cvt_pk_bf16_f32 v65, v18, v19
    v_mfma_f32_32x32x16_bf16 v[48:63], v[100:103], v[72:75], v[48:63]
    v_exp_f32 v24, v24
    v_exp_f32 v25, v25
    v_exp_f32 v26, v26
    v_exp_f32 v27, v27
    v_cvt_pk_bf16_f32 v66, v20, v21
    v_cvt_pk_bf16_f32 v67, v22, v23
    v_mfma_f32_32x32x16_bf16 v[48:63], v[104:107], v[76:79], v[48:63]
    v_exp_f32 v28, v28
    v_exp_f32 v29, v29
    v_exp_f32 v30, v30
    v_exp_f32 v31, v31
    v_cvt_pk_bf16_f32 v68, v24, v25
    v_cvt_pk_bf16_f32 v69, v26, v27
    v_cvt_pk_bf16_f32 v70, v28, v29
    v_cvt_pk_bf16_f32 v71, v30, v31
    ds_read_b128 v[84:87], v2 offset:58880
    ds_read_b64 v[90:91], v3 offset:59904
    s_mov_b64 exec, s[24:25]
    ds_read_b128 v[100:103], v10 offset:55040
    ds_read_b128 v[104:107], v10 offset:55680
    s_mov_b64 exec, -1
    s_waitcnt lgkmcnt(4)
    v_mfma_f32_32x32x16_bf16 v[16:31], v[80:83], v[4:7], 0
    v_exp_f32 v32, v32
    v_exp_f32 v33, v33
    v_exp_f32 v34, v34
    v_exp_f32 v35, v35
    v_mfma_f32_32x32x8_bf16 v[16:31], v[88:89], v[8:9], v[16:31]
    v_exp_f32 v36, v36
    v_exp_f32 v37, v37
    v_exp_f32 v38, v38
    v_exp_f32 v39, v39
    v_cvt_pk_bf16_f32 v72, v32, v33
    v_cvt_pk_bf16_f32 v73, v34, v35
    v_mfma_f32_32x32x16_bf16 v[48:63], v[92:95], v[64:67], v[48:63]
    v_exp_f32 v40, v40
    v_exp_f32 v41, v41
    v_exp_f32 v42, v42
    v_exp_f32 v43, v43
    v_cvt_pk_bf16_f32 v74, v36, v37
    v_cvt_pk_bf16_f32 v75, v38, v39
    v_mfma_f32_32x32x16_bf16 v[48:63], v[96:99], v[68:71], v[48:63]
    v_exp_f32 v44, v44
    v_exp_f32 v45, v45
    v_exp_f32 v46, v46
    v_exp_f32 v47, v47
    v_cvt_pk_bf16_f32 v76, v40, v41
    v_cvt_pk_bf16_f32 v77, v42, v43
    v_cvt_pk_bf16_f32 v78, v44, v45
    v_cvt_pk_bf16_f32 v79, v46, v47
    s_setprio 0
    ds_read_b128 v[80:83], v2 offset:61440
    ds_read_b64 v[88:89], v3 offset:62464
    s_mov_b64 exec, s[24:25]
    ds_read_b128 v[92:95], v10 offset:57600
    ds_read_b128 v[96:99], v10 offset:58240
    s_mov_b64 exec, -1
    s_waitcnt lgkmcnt(4)
    v_mfma_f32_32x32x16_bf16 v[32:47], v[84:87], v[4:7], 0
    v_exp_f32 v16, v16
    v_exp_f32 v17, v17
    v_exp_f32 v18, v18
    v_exp_f32 v19, v19
    v_mfma_f32_32x32x8_bf16 v[32:47], v[90:91], v[8:9], v[32:47]
    v_exp_f32 v20, v20
    v_exp_f32 v21, v21
    v_exp_f32 v22, v22
    v_exp_f32 v23, v23
    v_cvt_pk_bf16_f32 v64, v16, v17
    v_cvt_pk_bf16_f32 v65, v18, v19
    v_mfma_f32_32x32x16_bf16 v[48:63], v[100:103], v[72:75], v[48:63]
    v_exp_f32 v24, v24
    v_exp_f32 v25, v25
    v_exp_f32 v26, v26
    v_exp_f32 v27, v27
    v_cvt_pk_bf16_f32 v66, v20, v21
    v_cvt_pk_bf16_f32 v67, v22, v23
    v_mfma_f32_32x32x16_bf16 v[48:63], v[104:107], v[76:79], v[48:63]
    v_exp_f32 v28, v28
    v_exp_f32 v29, v29
    v_exp_f32 v30, v30
    v_exp_f32 v31, v31
    v_cvt_pk_bf16_f32 v68, v24, v25
    v_cvt_pk_bf16_f32 v69, v26, v27
    v_cvt_pk_bf16_f32 v70, v28, v29
    v_cvt_pk_bf16_f32 v71, v30, v31
    s_cbranch_vccz gated_mix__ssm_conv_s4__grouped_kv_mqa__prompt_kernel_p_8
    s_setprio 1
gated_mix__ssm_conv_s4__grouped_kv_mqa__prompt_kernel_p_8:
    v_add_u32 v2, 32768, v2
    v_add_u32 v3, 32768, v3
    ds_read_b128 v[84:87], v2 offset:31232
    ds_read_b64 v[90:91], v3 offset:32256
    s_mov_b64 exec, s[24:25]
    ds_read_b128 v[100:103], v10 offset:60160
    ds_read_b128 v[104:107], v10 offset:60800
    s_mov_b64 exec, -1
    s_waitcnt lgkmcnt(4)
    v_mfma_f32_32x32x16_bf16 v[16:31], v[80:83], v[4:7], 0
    v_exp_f32 v32, v32
    v_exp_f32 v33, v33
    v_exp_f32 v34, v34
    v_exp_f32 v35, v35
    v_mfma_f32_32x32x8_bf16 v[16:31], v[88:89], v[8:9], v[16:31]
    v_exp_f32 v36, v36
    v_exp_f32 v37, v37
    v_exp_f32 v38, v38
    v_exp_f32 v39, v39
    v_cvt_pk_bf16_f32 v72, v32, v33
    v_cvt_pk_bf16_f32 v73, v34, v35
    v_mfma_f32_32x32x16_bf16 v[48:63], v[92:95], v[64:67], v[48:63]
    v_exp_f32 v40, v40
    v_exp_f32 v41, v41
    v_exp_f32 v42, v42
    v_exp_f32 v43, v43
    v_cvt_pk_bf16_f32 v74, v36, v37
    v_cvt_pk_bf16_f32 v75, v38, v39
    v_mfma_f32_32x32x16_bf16 v[48:63], v[96:99], v[68:71], v[48:63]
    v_exp_f32 v44, v44
    v_exp_f32 v45, v45
    v_exp_f32 v46, v46
    v_exp_f32 v47, v47
    v_cvt_pk_bf16_f32 v76, v40, v41
    v_cvt_pk_bf16_f32 v77, v42, v43
    v_cvt_pk_bf16_f32 v78, v44, v45
    v_cvt_pk_bf16_f32 v79, v46, v47
    ds_read_b128 v[80:83], v2 offset:38912
    ds_read_b64 v[88:89], v3 offset:39936
    s_mov_b64 exec, s[24:25]
    ds_read_b128 v[92:95], v10 offset:62720
    ds_read_b128 v[96:99], v10 offset:63360
    s_mov_b64 exec, -1
    s_waitcnt lgkmcnt(4)
    v_mfma_f32_32x32x16_bf16 v[32:47], v[84:87], v[4:7], 0
    v_exp_f32 v16, v16
    v_exp_f32 v17, v17
    v_exp_f32 v18, v18
    v_exp_f32 v19, v19
    v_mfma_f32_32x32x8_bf16 v[32:47], v[90:91], v[8:9], v[32:47]
    v_exp_f32 v20, v20
    v_exp_f32 v21, v21
    v_exp_f32 v22, v22
    v_exp_f32 v23, v23
    v_cvt_pk_bf16_f32 v64, v16, v17
    v_cvt_pk_bf16_f32 v65, v18, v19
    v_mfma_f32_32x32x16_bf16 v[48:63], v[100:103], v[72:75], v[48:63]
    v_exp_f32 v24, v24
    v_exp_f32 v25, v25
    v_exp_f32 v26, v26
    v_exp_f32 v27, v27
    v_cvt_pk_bf16_f32 v66, v20, v21
    v_cvt_pk_bf16_f32 v67, v22, v23
    v_mfma_f32_32x32x16_bf16 v[48:63], v[104:107], v[76:79], v[48:63]
    v_exp_f32 v28, v28
    v_exp_f32 v29, v29
    v_exp_f32 v30, v30
    v_exp_f32 v31, v31
    v_cvt_pk_bf16_f32 v68, v24, v25
    v_cvt_pk_bf16_f32 v69, v26, v27
    v_cvt_pk_bf16_f32 v70, v28, v29
    v_cvt_pk_bf16_f32 v71, v30, v31
    ds_read_b128 v[84:87], v2 offset:41472
    ds_read_b64 v[90:91], v3 offset:42496
    v_add_u32 v10, 32768, v10
    s_mov_b64 exec, s[24:25]
    ds_read_b128 v[100:103], v10 offset:32512
    ds_read_b128 v[104:107], v10 offset:33152
    s_mov_b64 exec, -1
    s_waitcnt lgkmcnt(4)
    v_mfma_f32_32x32x16_bf16 v[16:31], v[80:83], v[4:7], 0
    v_exp_f32 v32, v32
    v_exp_f32 v33, v33
    v_exp_f32 v34, v34
    v_exp_f32 v35, v35
    v_mfma_f32_32x32x8_bf16 v[16:31], v[88:89], v[8:9], v[16:31]
    v_exp_f32 v36, v36
    v_exp_f32 v37, v37
    v_exp_f32 v38, v38
    v_exp_f32 v39, v39
    v_cvt_pk_bf16_f32 v72, v32, v33
    v_cvt_pk_bf16_f32 v73, v34, v35
    v_mfma_f32_32x32x16_bf16 v[48:63], v[92:95], v[64:67], v[48:63]
    v_exp_f32 v40, v40
    v_exp_f32 v41, v41
    v_exp_f32 v42, v42
    v_exp_f32 v43, v43
    v_cvt_pk_bf16_f32 v74, v36, v37
    v_cvt_pk_bf16_f32 v75, v38, v39
    v_mfma_f32_32x32x16_bf16 v[48:63], v[96:99], v[68:71], v[48:63]
    v_exp_f32 v44, v44
    v_exp_f32 v45, v45
    v_exp_f32 v46, v46
    v_exp_f32 v47, v47
    v_cvt_pk_bf16_f32 v76, v40, v41
    v_cvt_pk_bf16_f32 v77, v42, v43
    v_cvt_pk_bf16_f32 v78, v44, v45
    v_cvt_pk_bf16_f32 v79, v46, v47
    s_setprio 0
    ds_read_b128 v[80:83], v2 offset:44032
    ds_read_b64 v[88:89], v3 offset:45056
    s_mov_b64 exec, s[24:25]
    ds_read_b128 v[92:95], v10 offset:40192
    ds_read_b128 v[96:99], v10 offset:40832
    s_mov_b64 exec, -1
    s_waitcnt lgkmcnt(4)
    v_mfma_f32_32x32x16_bf16 v[32:47], v[84:87], v[4:7], 0
    v_exp_f32 v16, v16
    v_exp_f32 v17, v17
    v_exp_f32 v18, v18
    v_exp_f32 v19, v19
    v_mfma_f32_32x32x8_bf16 v[32:47], v[90:91], v[8:9], v[32:47]
    v_exp_f32 v20, v20
    v_exp_f32 v21, v21
    v_exp_f32 v22, v22
    v_exp_f32 v23, v23
    v_cvt_pk_bf16_f32 v64, v16, v17
    v_cvt_pk_bf16_f32 v65, v18, v19
    v_mfma_f32_32x32x16_bf16 v[48:63], v[100:103], v[72:75], v[48:63]
    v_exp_f32 v24, v24
    v_exp_f32 v25, v25
    v_exp_f32 v26, v26
    v_exp_f32 v27, v27
    v_cvt_pk_bf16_f32 v66, v20, v21
    v_cvt_pk_bf16_f32 v67, v22, v23
    v_mfma_f32_32x32x16_bf16 v[48:63], v[104:107], v[76:79], v[48:63]
    v_exp_f32 v28, v28
    v_exp_f32 v29, v29
    v_exp_f32 v30, v30
    v_exp_f32 v31, v31
    v_cvt_pk_bf16_f32 v68, v24, v25
    v_cvt_pk_bf16_f32 v69, v26, v27
    v_cvt_pk_bf16_f32 v70, v28, v29
    v_cvt_pk_bf16_f32 v71, v30, v31
    s_cbranch_vccz gated_mix__ssm_conv_s4__grouped_kv_mqa__prompt_kernel_p_9
    s_setprio 1
gated_mix__ssm_conv_s4__grouped_kv_mqa__prompt_kernel_p_9:
    ds_read_b128 v[84:87], v2 offset:46592
    ds_read_b64 v[90:91], v3 offset:47616
    s_mov_b64 exec, s[24:25]
    ds_read_b128 v[100:103], v10 offset:42752
    ds_read_b128 v[104:107], v10 offset:43392
    s_mov_b64 exec, -1
    s_waitcnt lgkmcnt(4)
    v_mfma_f32_32x32x16_bf16 v[16:31], v[80:83], v[4:7], 0
    v_exp_f32 v32, v32
    v_exp_f32 v33, v33
    v_exp_f32 v34, v34
    v_exp_f32 v35, v35
    v_mfma_f32_32x32x8_bf16 v[16:31], v[88:89], v[8:9], v[16:31]
    v_exp_f32 v36, v36
    v_exp_f32 v37, v37
    v_exp_f32 v38, v38
    v_exp_f32 v39, v39
    v_cvt_pk_bf16_f32 v72, v32, v33
    v_cvt_pk_bf16_f32 v73, v34, v35
    v_mfma_f32_32x32x16_bf16 v[48:63], v[92:95], v[64:67], v[48:63]
    v_exp_f32 v40, v40
    v_exp_f32 v41, v41
    v_exp_f32 v42, v42
    v_exp_f32 v43, v43
    v_cvt_pk_bf16_f32 v74, v36, v37
    v_cvt_pk_bf16_f32 v75, v38, v39
    v_mfma_f32_32x32x16_bf16 v[48:63], v[96:99], v[68:71], v[48:63]
    v_exp_f32 v44, v44
    v_exp_f32 v45, v45
    v_exp_f32 v46, v46
    v_exp_f32 v47, v47
    v_cvt_pk_bf16_f32 v76, v40, v41
    v_cvt_pk_bf16_f32 v77, v42, v43
    v_cvt_pk_bf16_f32 v78, v44, v45
    v_cvt_pk_bf16_f32 v79, v46, v47
    ds_read_b128 v[80:83], v2 offset:49152
    ds_read_b64 v[88:89], v3 offset:50176
    s_mov_b64 exec, s[24:25]
    ds_read_b128 v[92:95], v10 offset:45312
    ds_read_b128 v[96:99], v10 offset:45952
    s_mov_b64 exec, -1
    s_waitcnt lgkmcnt(4)
    v_mfma_f32_32x32x16_bf16 v[32:47], v[84:87], v[4:7], 0
    v_exp_f32 v16, v16
    v_exp_f32 v17, v17
    v_exp_f32 v18, v18
    v_exp_f32 v19, v19
    v_mfma_f32_32x32x8_bf16 v[32:47], v[90:91], v[8:9], v[32:47]
    v_exp_f32 v20, v20
    v_exp_f32 v21, v21
    v_exp_f32 v22, v22
    v_exp_f32 v23, v23
    v_cvt_pk_bf16_f32 v64, v16, v17
    v_cvt_pk_bf16_f32 v65, v18, v19
    v_mfma_f32_32x32x16_bf16 v[48:63], v[100:103], v[72:75], v[48:63]
    v_exp_f32 v24, v24
    v_exp_f32 v25, v25
    v_exp_f32 v26, v26
    v_exp_f32 v27, v27
    v_cvt_pk_bf16_f32 v66, v20, v21
    v_cvt_pk_bf16_f32 v67, v22, v23
    v_mfma_f32_32x32x16_bf16 v[48:63], v[104:107], v[76:79], v[48:63]
    v_exp_f32 v28, v28
    v_exp_f32 v29, v29
    v_exp_f32 v30, v30
    v_exp_f32 v31, v31
    v_cvt_pk_bf16_f32 v68, v24, v25
    v_cvt_pk_bf16_f32 v69, v26, v27
    v_cvt_pk_bf16_f32 v70, v28, v29
    v_cvt_pk_bf16_f32 v71, v30, v31
    ds_read_b128 v[84:87], v2 offset:51712
    ds_read_b64 v[90:91], v3 offset:52736
    s_mov_b64 exec, s[24:25]
    ds_read_b128 v[100:103], v10 offset:47872
    ds_read_b128 v[104:107], v10 offset:48512
    s_mov_b64 exec, -1
    s_waitcnt lgkmcnt(4)
    v_mfma_f32_32x32x16_bf16 v[16:31], v[80:83], v[4:7], 0
    v_exp_f32 v32, v32
    v_exp_f32 v33, v33
    v_exp_f32 v34, v34
    v_exp_f32 v35, v35
    v_mfma_f32_32x32x8_bf16 v[16:31], v[88:89], v[8:9], v[16:31]
    v_exp_f32 v36, v36
    v_exp_f32 v37, v37
    v_exp_f32 v38, v38
    v_exp_f32 v39, v39
    v_cvt_pk_bf16_f32 v72, v32, v33
    v_cvt_pk_bf16_f32 v73, v34, v35
    v_mfma_f32_32x32x16_bf16 v[48:63], v[92:95], v[64:67], v[48:63]
    v_exp_f32 v40, v40
    v_exp_f32 v41, v41
    v_exp_f32 v42, v42
    v_exp_f32 v43, v43
    v_cvt_pk_bf16_f32 v74, v36, v37
    v_cvt_pk_bf16_f32 v75, v38, v39
    v_mfma_f32_32x32x16_bf16 v[48:63], v[96:99], v[68:71], v[48:63]
    v_exp_f32 v44, v44
    v_exp_f32 v45, v45
    v_exp_f32 v46, v46
    v_exp_f32 v47, v47
    v_cvt_pk_bf16_f32 v76, v40, v41
    v_cvt_pk_bf16_f32 v77, v42, v43
    v_cvt_pk_bf16_f32 v78, v44, v45
    v_cvt_pk_bf16_f32 v79, v46, v47
    s_setprio 0
    ds_read_b128 v[80:83], v2 offset:54272
    ds_read_b64 v[88:89], v3 offset:55296
    s_mov_b64 exec, s[24:25]
    ds_read_b128 v[92:95], v10 offset:50432
    ds_read_b128 v[96:99], v10 offset:51072
    s_mov_b64 exec, -1
    s_waitcnt lgkmcnt(4)
    v_mfma_f32_32x32x16_bf16 v[32:47], v[84:87], v[4:7], 0
    v_exp_f32 v16, v16
    v_exp_f32 v17, v17
    v_exp_f32 v18, v18
    v_exp_f32 v19, v19
    v_mfma_f32_32x32x8_bf16 v[32:47], v[90:91], v[8:9], v[32:47]
    v_exp_f32 v20, v20
    v_exp_f32 v21, v21
    v_exp_f32 v22, v22
    v_exp_f32 v23, v23
    v_cvt_pk_bf16_f32 v64, v16, v17
    v_cvt_pk_bf16_f32 v65, v18, v19
    v_mfma_f32_32x32x16_bf16 v[48:63], v[100:103], v[72:75], v[48:63]
    v_exp_f32 v24, v24
    v_exp_f32 v25, v25
    v_exp_f32 v26, v26
    v_exp_f32 v27, v27
    v_cvt_pk_bf16_f32 v66, v20, v21
    v_cvt_pk_bf16_f32 v67, v22, v23
    v_mfma_f32_32x32x16_bf16 v[48:63], v[104:107], v[76:79], v[48:63]
    v_exp_f32 v28, v28
    v_exp_f32 v29, v29
    v_exp_f32 v30, v30
    v_exp_f32 v31, v31
    v_cvt_pk_bf16_f32 v68, v24, v25
    v_cvt_pk_bf16_f32 v69, v26, v27
    v_cvt_pk_bf16_f32 v70, v28, v29
    v_cvt_pk_bf16_f32 v71, v30, v31
    s_cbranch_vccz gated_mix__ssm_conv_s4__grouped_kv_mqa__prompt_kernel_p_10
    s_setprio 1
gated_mix__ssm_conv_s4__grouped_kv_mqa__prompt_kernel_p_10:
    ds_read_b128 v[84:87], v2 offset:56832
    ds_read_b64 v[90:91], v3 offset:57856
    s_mov_b64 exec, s[24:25]
    ds_read_b128 v[100:103], v10 offset:52992
    ds_read_b128 v[104:107], v10 offset:53632
    s_mov_b64 exec, -1
    s_waitcnt lgkmcnt(4)
    v_mfma_f32_32x32x16_bf16 v[16:31], v[80:83], v[4:7], 0
    v_exp_f32 v32, v32
    v_exp_f32 v33, v33
    v_exp_f32 v34, v34
    v_exp_f32 v35, v35
    v_mfma_f32_32x32x8_bf16 v[16:31], v[88:89], v[8:9], v[16:31]
    v_exp_f32 v36, v36
    v_exp_f32 v37, v37
    v_exp_f32 v38, v38
    v_exp_f32 v39, v39
    v_cvt_pk_bf16_f32 v72, v32, v33
    v_cvt_pk_bf16_f32 v73, v34, v35
    v_mfma_f32_32x32x16_bf16 v[48:63], v[92:95], v[64:67], v[48:63]
    v_exp_f32 v40, v40
    v_exp_f32 v41, v41
    v_exp_f32 v42, v42
    v_exp_f32 v43, v43
    v_cvt_pk_bf16_f32 v74, v36, v37
    v_cvt_pk_bf16_f32 v75, v38, v39
    v_mfma_f32_32x32x16_bf16 v[48:63], v[96:99], v[68:71], v[48:63]
    v_exp_f32 v44, v44
    v_exp_f32 v45, v45
    v_exp_f32 v46, v46
    v_exp_f32 v47, v47
    v_cvt_pk_bf16_f32 v76, v40, v41
    v_cvt_pk_bf16_f32 v77, v42, v43
    v_cvt_pk_bf16_f32 v78, v44, v45
    v_cvt_pk_bf16_f32 v79, v46, v47
    ds_read_b128 v[80:83], v2 offset:59392
    ds_read_b64 v[88:89], v3 offset:60416
    s_mov_b64 exec, s[24:25]
    ds_read_b128 v[92:95], v10 offset:55552
    ds_read_b128 v[96:99], v10 offset:56192
    s_mov_b64 exec, -1
    s_waitcnt lgkmcnt(4)
    v_mfma_f32_32x32x16_bf16 v[32:47], v[84:87], v[4:7], 0
    v_exp_f32 v16, v16
    v_exp_f32 v17, v17
    v_exp_f32 v18, v18
    v_exp_f32 v19, v19
    v_mfma_f32_32x32x8_bf16 v[32:47], v[90:91], v[8:9], v[32:47]
    v_exp_f32 v20, v20
    v_exp_f32 v21, v21
    v_exp_f32 v22, v22
    v_exp_f32 v23, v23
    v_cvt_pk_bf16_f32 v64, v16, v17
    v_cvt_pk_bf16_f32 v65, v18, v19
    v_mfma_f32_32x32x16_bf16 v[48:63], v[100:103], v[72:75], v[48:63]
    v_exp_f32 v24, v24
    v_exp_f32 v25, v25
    v_exp_f32 v26, v26
    v_exp_f32 v27, v27
    v_cvt_pk_bf16_f32 v66, v20, v21
    v_cvt_pk_bf16_f32 v67, v22, v23
    v_mfma_f32_32x32x16_bf16 v[48:63], v[104:107], v[76:79], v[48:63]
    v_exp_f32 v28, v28
    v_exp_f32 v29, v29
    v_exp_f32 v30, v30
    v_exp_f32 v31, v31
    v_cvt_pk_bf16_f32 v68, v24, v25
    v_cvt_pk_bf16_f32 v69, v26, v27
    v_cvt_pk_bf16_f32 v70, v28, v29
    v_cvt_pk_bf16_f32 v71, v30, v31
    ds_read_b128 v[84:87], v2 offset:61952
    ds_read_b64 v[90:91], v3 offset:62976
    s_mov_b64 exec, s[24:25]
    ds_read_b128 v[100:103], v10 offset:58112
    ds_read_b128 v[104:107], v10 offset:58752
    s_mov_b64 exec, -1
    s_waitcnt lgkmcnt(4)
    v_mfma_f32_32x32x16_bf16 v[16:31], v[80:83], v[4:7], 0
    v_exp_f32 v32, v32
    v_exp_f32 v33, v33
    v_exp_f32 v34, v34
    v_exp_f32 v35, v35
    v_mfma_f32_32x32x8_bf16 v[16:31], v[88:89], v[8:9], v[16:31]
    v_exp_f32 v36, v36
    v_exp_f32 v37, v37
    v_exp_f32 v38, v38
    v_exp_f32 v39, v39
    v_cvt_pk_bf16_f32 v72, v32, v33
    v_cvt_pk_bf16_f32 v73, v34, v35
    v_mfma_f32_32x32x16_bf16 v[48:63], v[92:95], v[64:67], v[48:63]
    v_exp_f32 v40, v40
    v_exp_f32 v41, v41
    v_exp_f32 v42, v42
    v_exp_f32 v43, v43
    v_cvt_pk_bf16_f32 v74, v36, v37
    v_cvt_pk_bf16_f32 v75, v38, v39
    v_mfma_f32_32x32x16_bf16 v[48:63], v[96:99], v[68:71], v[48:63]
    v_exp_f32 v44, v44
    v_exp_f32 v45, v45
    v_exp_f32 v46, v46
    v_exp_f32 v47, v47
    v_cvt_pk_bf16_f32 v76, v40, v41
    v_cvt_pk_bf16_f32 v77, v42, v43
    v_cvt_pk_bf16_f32 v78, v44, v45
    v_cvt_pk_bf16_f32 v79, v46, v47
    s_setprio 0
    v_add_u32 v2, 32768, v2
    v_add_u32 v3, 32768, v3
    ds_read_b128 v[80:83], v2 offset:31744
    ds_read_b64 v[88:89], v3 offset:32768
    s_mov_b64 exec, s[24:25]
    ds_read_b128 v[92:95], v10 offset:60672
    ds_read_b128 v[96:99], v10 offset:61312
    s_mov_b64 exec, -1
    s_waitcnt lgkmcnt(4)
    v_mfma_f32_32x32x16_bf16 v[32:47], v[84:87], v[4:7], 0
    v_exp_f32 v16, v16
    v_exp_f32 v17, v17
    v_exp_f32 v18, v18
    v_exp_f32 v19, v19
    v_mfma_f32_32x32x8_bf16 v[32:47], v[90:91], v[8:9], v[32:47]
    v_exp_f32 v20, v20
    v_exp_f32 v21, v21
    v_exp_f32 v22, v22
    v_exp_f32 v23, v23
    v_cvt_pk_bf16_f32 v64, v16, v17
    v_cvt_pk_bf16_f32 v65, v18, v19
    v_mfma_f32_32x32x16_bf16 v[48:63], v[100:103], v[72:75], v[48:63]
    v_exp_f32 v24, v24
    v_exp_f32 v25, v25
    v_exp_f32 v26, v26
    v_exp_f32 v27, v27
    v_cvt_pk_bf16_f32 v66, v20, v21
    v_cvt_pk_bf16_f32 v67, v22, v23
    v_mfma_f32_32x32x16_bf16 v[48:63], v[104:107], v[76:79], v[48:63]
    v_exp_f32 v28, v28
    v_exp_f32 v29, v29
    v_exp_f32 v30, v30
    v_exp_f32 v31, v31
    v_cvt_pk_bf16_f32 v68, v24, v25
    v_cvt_pk_bf16_f32 v69, v26, v27
    v_cvt_pk_bf16_f32 v70, v28, v29
    v_cvt_pk_bf16_f32 v71, v30, v31
    s_cbranch_vccz gated_mix__ssm_conv_s4__grouped_kv_mqa__prompt_kernel_p_11
    s_setprio 1
gated_mix__ssm_conv_s4__grouped_kv_mqa__prompt_kernel_p_11:
    ds_read_b128 v[84:87], v2 offset:34304
    ds_read_b64 v[90:91], v3 offset:35328
    s_mov_b64 exec, s[24:25]
    ds_read_b128 v[100:103], v10 offset:63232
    ds_read_b128 v[104:107], v10 offset:63872
    s_mov_b64 exec, -1
    s_waitcnt lgkmcnt(4)
    v_mfma_f32_32x32x16_bf16 v[16:31], v[80:83], v[4:7], 0
    v_exp_f32 v32, v32
    v_exp_f32 v33, v33
    v_exp_f32 v34, v34
    v_exp_f32 v35, v35
    v_mfma_f32_32x32x8_bf16 v[16:31], v[88:89], v[8:9], v[16:31]
    v_exp_f32 v36, v36
    v_exp_f32 v37, v37
    v_exp_f32 v38, v38
    v_exp_f32 v39, v39
    v_cvt_pk_bf16_f32 v72, v32, v33
    v_cvt_pk_bf16_f32 v73, v34, v35
    v_mfma_f32_32x32x16_bf16 v[48:63], v[92:95], v[64:67], v[48:63]
    v_exp_f32 v40, v40
    v_exp_f32 v41, v41
    v_exp_f32 v42, v42
    v_exp_f32 v43, v43
    v_cvt_pk_bf16_f32 v74, v36, v37
    v_cvt_pk_bf16_f32 v75, v38, v39
    v_mfma_f32_32x32x16_bf16 v[48:63], v[96:99], v[68:71], v[48:63]
    v_exp_f32 v44, v44
    v_exp_f32 v45, v45
    v_exp_f32 v46, v46
    v_exp_f32 v47, v47
    v_cvt_pk_bf16_f32 v76, v40, v41
    v_cvt_pk_bf16_f32 v77, v42, v43
    v_cvt_pk_bf16_f32 v78, v44, v45
    v_cvt_pk_bf16_f32 v79, v46, v47
    ds_read_b128 v[80:83], v2 offset:36864
    ds_read_b64 v[88:89], v3 offset:37888
    v_add_u32 v10, 32768, v10
    s_mov_b64 exec, s[24:25]
    ds_read_b128 v[92:95], v10 offset:33024
    ds_read_b128 v[96:99], v10 offset:33664
    s_mov_b64 exec, -1
    s_waitcnt lgkmcnt(4)
    v_mfma_f32_32x32x16_bf16 v[32:47], v[84:87], v[4:7], 0
    v_exp_f32 v16, v16
    v_exp_f32 v17, v17
    v_exp_f32 v18, v18
    v_exp_f32 v19, v19
    v_mfma_f32_32x32x8_bf16 v[32:47], v[90:91], v[8:9], v[32:47]
    v_exp_f32 v20, v20
    v_exp_f32 v21, v21
    v_exp_f32 v22, v22
    v_exp_f32 v23, v23
    v_cvt_pk_bf16_f32 v64, v16, v17
    v_cvt_pk_bf16_f32 v65, v18, v19
    v_mfma_f32_32x32x16_bf16 v[48:63], v[100:103], v[72:75], v[48:63]
    v_exp_f32 v24, v24
    v_exp_f32 v25, v25
    v_exp_f32 v26, v26
    v_exp_f32 v27, v27
    v_cvt_pk_bf16_f32 v66, v20, v21
    v_cvt_pk_bf16_f32 v67, v22, v23
    v_mfma_f32_32x32x16_bf16 v[48:63], v[104:107], v[76:79], v[48:63]
    v_exp_f32 v28, v28
    v_exp_f32 v29, v29
    v_exp_f32 v30, v30
    v_exp_f32 v31, v31
    v_cvt_pk_bf16_f32 v68, v24, v25
    v_cvt_pk_bf16_f32 v69, v26, v27
    v_cvt_pk_bf16_f32 v70, v28, v29
    v_cvt_pk_bf16_f32 v71, v30, v31
    ds_read_b128 v[84:87], v2 offset:39424
    ds_read_b64 v[90:91], v3 offset:40448
    s_mov_b64 exec, s[24:25]
    ds_read_b128 v[100:103], v10 offset:35584
    ds_read_b128 v[104:107], v10 offset:36224
    s_mov_b64 exec, -1
    s_waitcnt lgkmcnt(4)
    v_mfma_f32_32x32x16_bf16 v[16:31], v[80:83], v[4:7], 0
    v_exp_f32 v32, v32
    v_exp_f32 v33, v33
    v_exp_f32 v34, v34
    v_exp_f32 v35, v35
    v_mfma_f32_32x32x8_bf16 v[16:31], v[88:89], v[8:9], v[16:31]
    v_exp_f32 v36, v36
    v_exp_f32 v37, v37
    v_exp_f32 v38, v38
    v_exp_f32 v39, v39
    v_cvt_pk_bf16_f32 v72, v32, v33
    v_cvt_pk_bf16_f32 v73, v34, v35
    v_mfma_f32_32x32x16_bf16 v[48:63], v[92:95], v[64:67], v[48:63]
    v_exp_f32 v40, v40
    v_exp_f32 v41, v41
    v_exp_f32 v42, v42
    v_exp_f32 v43, v43
    v_cvt_pk_bf16_f32 v74, v36, v37
    v_cvt_pk_bf16_f32 v75, v38, v39
    v_mfma_f32_32x32x16_bf16 v[48:63], v[96:99], v[68:71], v[48:63]
    v_exp_f32 v44, v44
    v_exp_f32 v45, v45
    v_exp_f32 v46, v46
    v_exp_f32 v47, v47
    v_cvt_pk_bf16_f32 v76, v40, v41
    v_cvt_pk_bf16_f32 v77, v42, v43
    v_cvt_pk_bf16_f32 v78, v44, v45
    v_cvt_pk_bf16_f32 v79, v46, v47
    s_setprio 0
    ds_read_b128 v[80:83], v2 offset:41984
    ds_read_b64 v[88:89], v3 offset:43008
    s_mov_b64 exec, s[24:25]
    ds_read_b128 v[92:95], v10 offset:38144
    ds_read_b128 v[96:99], v10 offset:38784
    s_mov_b64 exec, -1
    s_waitcnt lgkmcnt(4)
    v_mfma_f32_32x32x16_bf16 v[32:47], v[84:87], v[4:7], 0
    v_exp_f32 v16, v16
    v_exp_f32 v17, v17
    v_exp_f32 v18, v18
    v_exp_f32 v19, v19
    v_mfma_f32_32x32x8_bf16 v[32:47], v[90:91], v[8:9], v[32:47]
    v_exp_f32 v20, v20
    v_exp_f32 v21, v21
    v_exp_f32 v22, v22
    v_exp_f32 v23, v23
    v_cvt_pk_bf16_f32 v64, v16, v17
    v_cvt_pk_bf16_f32 v65, v18, v19
    v_mfma_f32_32x32x16_bf16 v[48:63], v[100:103], v[72:75], v[48:63]
    v_exp_f32 v24, v24
    v_exp_f32 v25, v25
    v_exp_f32 v26, v26
    v_exp_f32 v27, v27
    v_cvt_pk_bf16_f32 v66, v20, v21
    v_cvt_pk_bf16_f32 v67, v22, v23
    v_mfma_f32_32x32x16_bf16 v[48:63], v[104:107], v[76:79], v[48:63]
    v_exp_f32 v28, v28
    v_exp_f32 v29, v29
    v_exp_f32 v30, v30
    v_exp_f32 v31, v31
    v_cvt_pk_bf16_f32 v68, v24, v25
    v_cvt_pk_bf16_f32 v69, v26, v27
    v_cvt_pk_bf16_f32 v70, v28, v29
    v_cvt_pk_bf16_f32 v71, v30, v31
    s_cbranch_vccz gated_mix__ssm_conv_s4__grouped_kv_mqa__prompt_kernel_p_12
    s_setprio 1
gated_mix__ssm_conv_s4__grouped_kv_mqa__prompt_kernel_p_12:
    ds_read_b128 v[84:87], v2 offset:44544
    ds_read_b64 v[90:91], v3 offset:45568
    s_mov_b64 exec, s[24:25]
    ds_read_b128 v[100:103], v10 offset:40704
    ds_read_b128 v[104:107], v10 offset:41344
    s_mov_b64 exec, -1
    s_waitcnt lgkmcnt(4)
    v_mfma_f32_32x32x16_bf16 v[16:31], v[80:83], v[4:7], 0
    v_exp_f32 v32, v32
    v_exp_f32 v33, v33
    v_exp_f32 v34, v34
    v_exp_f32 v35, v35
    v_mfma_f32_32x32x8_bf16 v[16:31], v[88:89], v[8:9], v[16:31]
    v_exp_f32 v36, v36
    v_exp_f32 v37, v37
    v_exp_f32 v38, v38
    v_exp_f32 v39, v39
    v_cvt_pk_bf16_f32 v72, v32, v33
    v_cvt_pk_bf16_f32 v73, v34, v35
    v_mfma_f32_32x32x16_bf16 v[48:63], v[92:95], v[64:67], v[48:63]
    v_exp_f32 v40, v40
    v_exp_f32 v41, v41
    v_exp_f32 v42, v42
    v_exp_f32 v43, v43
    v_cvt_pk_bf16_f32 v74, v36, v37
    v_cvt_pk_bf16_f32 v75, v38, v39
    v_mfma_f32_32x32x16_bf16 v[48:63], v[96:99], v[68:71], v[48:63]
    v_exp_f32 v44, v44
    v_exp_f32 v45, v45
    v_exp_f32 v46, v46
    v_exp_f32 v47, v47
    v_cvt_pk_bf16_f32 v76, v40, v41
    v_cvt_pk_bf16_f32 v77, v42, v43
    v_cvt_pk_bf16_f32 v78, v44, v45
    v_cvt_pk_bf16_f32 v79, v46, v47
    ds_read_b128 v[80:83], v2 offset:47104
    ds_read_b64 v[88:89], v3 offset:48128
    s_mov_b64 exec, s[24:25]
    ds_read_b128 v[92:95], v10 offset:43264
    ds_read_b128 v[96:99], v10 offset:43904
    s_mov_b64 exec, -1
    s_waitcnt lgkmcnt(4)
    v_mfma_f32_32x32x16_bf16 v[32:47], v[84:87], v[4:7], 0
    v_exp_f32 v16, v16
    v_exp_f32 v17, v17
    v_exp_f32 v18, v18
    v_exp_f32 v19, v19
    v_mfma_f32_32x32x8_bf16 v[32:47], v[90:91], v[8:9], v[32:47]
    v_exp_f32 v20, v20
    v_exp_f32 v21, v21
    v_exp_f32 v22, v22
    v_exp_f32 v23, v23
    v_cvt_pk_bf16_f32 v64, v16, v17
    v_cvt_pk_bf16_f32 v65, v18, v19
    v_mfma_f32_32x32x16_bf16 v[48:63], v[100:103], v[72:75], v[48:63]
    v_exp_f32 v24, v24
    v_exp_f32 v25, v25
    v_exp_f32 v26, v26
    v_exp_f32 v27, v27
    v_cvt_pk_bf16_f32 v66, v20, v21
    v_cvt_pk_bf16_f32 v67, v22, v23
    v_mfma_f32_32x32x16_bf16 v[48:63], v[104:107], v[76:79], v[48:63]
    v_exp_f32 v28, v28
    v_exp_f32 v29, v29
    v_exp_f32 v30, v30
    v_exp_f32 v31, v31
    v_cvt_pk_bf16_f32 v68, v24, v25
    v_cvt_pk_bf16_f32 v69, v26, v27
    v_cvt_pk_bf16_f32 v70, v28, v29
    v_cvt_pk_bf16_f32 v71, v30, v31
    ds_read_b128 v[84:87], v2 offset:49664
    ds_read_b64 v[90:91], v3 offset:50688
    s_mov_b64 exec, s[24:25]
    ds_read_b128 v[100:103], v10 offset:45824
    ds_read_b128 v[104:107], v10 offset:46464
    s_mov_b64 exec, -1
    s_waitcnt lgkmcnt(4)
    v_mfma_f32_32x32x16_bf16 v[16:31], v[80:83], v[4:7], 0
    v_exp_f32 v32, v32
    v_exp_f32 v33, v33
    v_exp_f32 v34, v34
    v_exp_f32 v35, v35
    v_mfma_f32_32x32x8_bf16 v[16:31], v[88:89], v[8:9], v[16:31]
    v_exp_f32 v36, v36
    v_exp_f32 v37, v37
    v_exp_f32 v38, v38
    v_exp_f32 v39, v39
    v_cvt_pk_bf16_f32 v72, v32, v33
    v_cvt_pk_bf16_f32 v73, v34, v35
    v_mfma_f32_32x32x16_bf16 v[48:63], v[92:95], v[64:67], v[48:63]
    v_exp_f32 v40, v40
    v_exp_f32 v41, v41
    v_exp_f32 v42, v42
    v_exp_f32 v43, v43
    v_cvt_pk_bf16_f32 v74, v36, v37
    v_cvt_pk_bf16_f32 v75, v38, v39
    v_mfma_f32_32x32x16_bf16 v[48:63], v[96:99], v[68:71], v[48:63]
    v_exp_f32 v44, v44
    v_exp_f32 v45, v45
    v_exp_f32 v46, v46
    v_exp_f32 v47, v47
    v_cvt_pk_bf16_f32 v76, v40, v41
    v_cvt_pk_bf16_f32 v77, v42, v43
    v_cvt_pk_bf16_f32 v78, v44, v45
    v_cvt_pk_bf16_f32 v79, v46, v47
    s_setprio 0
    ds_read_b128 v[80:83], v2 offset:52224
    ds_read_b64 v[88:89], v3 offset:53248
    s_mov_b64 exec, s[24:25]
    ds_read_b128 v[92:95], v10 offset:48384
    ds_read_b128 v[96:99], v10 offset:49024
    s_mov_b64 exec, -1
    s_waitcnt lgkmcnt(4)
    v_mfma_f32_32x32x16_bf16 v[32:47], v[84:87], v[4:7], 0
    v_exp_f32 v16, v16
    v_exp_f32 v17, v17
    v_exp_f32 v18, v18
    v_exp_f32 v19, v19
    v_mfma_f32_32x32x8_bf16 v[32:47], v[90:91], v[8:9], v[32:47]
    v_exp_f32 v20, v20
    v_exp_f32 v21, v21
    v_exp_f32 v22, v22
    v_exp_f32 v23, v23
    v_cvt_pk_bf16_f32 v64, v16, v17
    v_cvt_pk_bf16_f32 v65, v18, v19
    v_mfma_f32_32x32x16_bf16 v[48:63], v[100:103], v[72:75], v[48:63]
    v_exp_f32 v24, v24
    v_exp_f32 v25, v25
    v_exp_f32 v26, v26
    v_exp_f32 v27, v27
    v_cvt_pk_bf16_f32 v66, v20, v21
    v_cvt_pk_bf16_f32 v67, v22, v23
    v_mfma_f32_32x32x16_bf16 v[48:63], v[104:107], v[76:79], v[48:63]
    v_exp_f32 v28, v28
    v_exp_f32 v29, v29
    v_exp_f32 v30, v30
    v_exp_f32 v31, v31
    v_cvt_pk_bf16_f32 v68, v24, v25
    v_cvt_pk_bf16_f32 v69, v26, v27
    v_cvt_pk_bf16_f32 v70, v28, v29
    v_cvt_pk_bf16_f32 v71, v30, v31
    s_cbranch_vccz gated_mix__ssm_conv_s4__grouped_kv_mqa__prompt_kernel_p_13
    s_setprio 1
gated_mix__ssm_conv_s4__grouped_kv_mqa__prompt_kernel_p_13:
    ds_read_b128 v[84:87], v2 offset:54784
    ds_read_b64 v[90:91], v3 offset:55808
    s_mov_b64 exec, s[24:25]
    ds_read_b128 v[100:103], v10 offset:50944
    ds_read_b128 v[104:107], v10 offset:51584
    s_mov_b64 exec, -1
    s_waitcnt lgkmcnt(4)
    v_mfma_f32_32x32x16_bf16 v[16:31], v[80:83], v[4:7], 0
    v_exp_f32 v32, v32
    v_exp_f32 v33, v33
    v_exp_f32 v34, v34
    v_exp_f32 v35, v35
    v_mfma_f32_32x32x8_bf16 v[16:31], v[88:89], v[8:9], v[16:31]
    v_exp_f32 v36, v36
    v_exp_f32 v37, v37
    v_exp_f32 v38, v38
    v_exp_f32 v39, v39
    v_cvt_pk_bf16_f32 v72, v32, v33
    v_cvt_pk_bf16_f32 v73, v34, v35
    v_mfma_f32_32x32x16_bf16 v[48:63], v[92:95], v[64:67], v[48:63]
    v_exp_f32 v40, v40
    v_exp_f32 v41, v41
    v_exp_f32 v42, v42
    v_exp_f32 v43, v43
    v_cvt_pk_bf16_f32 v74, v36, v37
    v_cvt_pk_bf16_f32 v75, v38, v39
    v_mfma_f32_32x32x16_bf16 v[48:63], v[96:99], v[68:71], v[48:63]
    v_exp_f32 v44, v44
    v_exp_f32 v45, v45
    v_exp_f32 v46, v46
    v_exp_f32 v47, v47
    v_cvt_pk_bf16_f32 v76, v40, v41
    v_cvt_pk_bf16_f32 v77, v42, v43
    v_cvt_pk_bf16_f32 v78, v44, v45
    v_cvt_pk_bf16_f32 v79, v46, v47
    ds_read_b128 v[80:83], v2 offset:57344
    ds_read_b64 v[88:89], v3 offset:58368
    s_mov_b64 exec, s[24:25]
    ds_read_b128 v[92:95], v10 offset:53504
    ds_read_b128 v[96:99], v10 offset:54144
    s_mov_b64 exec, -1
    s_waitcnt lgkmcnt(4)
    v_mfma_f32_32x32x16_bf16 v[32:47], v[84:87], v[4:7], 0
    v_exp_f32 v16, v16
    v_exp_f32 v17, v17
    v_exp_f32 v18, v18
    v_exp_f32 v19, v19
    v_mfma_f32_32x32x8_bf16 v[32:47], v[90:91], v[8:9], v[32:47]
    v_exp_f32 v20, v20
    v_exp_f32 v21, v21
    v_exp_f32 v22, v22
    v_exp_f32 v23, v23
    v_cvt_pk_bf16_f32 v64, v16, v17
    v_cvt_pk_bf16_f32 v65, v18, v19
    v_mfma_f32_32x32x16_bf16 v[48:63], v[100:103], v[72:75], v[48:63]
    v_exp_f32 v24, v24
    v_exp_f32 v25, v25
    v_exp_f32 v26, v26
    v_exp_f32 v27, v27
    v_cvt_pk_bf16_f32 v66, v20, v21
    v_cvt_pk_bf16_f32 v67, v22, v23
    v_mfma_f32_32x32x16_bf16 v[48:63], v[104:107], v[76:79], v[48:63]
    v_exp_f32 v28, v28
    v_exp_f32 v29, v29
    v_exp_f32 v30, v30
    v_exp_f32 v31, v31
    v_cvt_pk_bf16_f32 v68, v24, v25
    v_cvt_pk_bf16_f32 v69, v26, v27
    v_cvt_pk_bf16_f32 v70, v28, v29
    v_cvt_pk_bf16_f32 v71, v30, v31
    ds_read_b128 v[84:87], v2 offset:59904
    ds_read_b64 v[90:91], v3 offset:60928
    s_mov_b64 exec, s[24:25]
    ds_read_b128 v[100:103], v10 offset:56064
    ds_read_b128 v[104:107], v10 offset:56704
    s_mov_b64 exec, -1
    s_waitcnt lgkmcnt(4)
    v_mfma_f32_32x32x16_bf16 v[16:31], v[80:83], v[4:7], 0
    v_exp_f32 v32, v32
    v_exp_f32 v33, v33
    v_exp_f32 v34, v34
    v_exp_f32 v35, v35
    v_mfma_f32_32x32x8_bf16 v[16:31], v[88:89], v[8:9], v[16:31]
    v_exp_f32 v36, v36
    v_exp_f32 v37, v37
    v_exp_f32 v38, v38
    v_exp_f32 v39, v39
    v_cvt_pk_bf16_f32 v72, v32, v33
    v_cvt_pk_bf16_f32 v73, v34, v35
    v_mfma_f32_32x32x16_bf16 v[48:63], v[92:95], v[64:67], v[48:63]
    v_exp_f32 v40, v40
    v_exp_f32 v41, v41
    v_exp_f32 v42, v42
    v_exp_f32 v43, v43
    v_cvt_pk_bf16_f32 v74, v36, v37
    v_cvt_pk_bf16_f32 v75, v38, v39
    v_mfma_f32_32x32x16_bf16 v[48:63], v[96:99], v[68:71], v[48:63]
    v_exp_f32 v44, v44
    v_exp_f32 v45, v45
    v_exp_f32 v46, v46
    v_exp_f32 v47, v47
    v_cvt_pk_bf16_f32 v76, v40, v41
    v_cvt_pk_bf16_f32 v77, v42, v43
    v_cvt_pk_bf16_f32 v78, v44, v45
    v_cvt_pk_bf16_f32 v79, v46, v47
    s_setprio 0
    ds_read_b128 v[80:83], v2 offset:62464
    ds_read_b64 v[88:89], v3 offset:63488
    s_mov_b64 exec, s[24:25]
    ds_read_b128 v[92:95], v10 offset:58624
    ds_read_b128 v[96:99], v10 offset:59264
    s_mov_b64 exec, -1
    s_waitcnt lgkmcnt(4)
    v_mfma_f32_32x32x16_bf16 v[32:47], v[84:87], v[4:7], 0
    v_exp_f32 v16, v16
    v_exp_f32 v17, v17
    v_exp_f32 v18, v18
    v_exp_f32 v19, v19
    v_mfma_f32_32x32x8_bf16 v[32:47], v[90:91], v[8:9], v[32:47]
    v_exp_f32 v20, v20
    v_exp_f32 v21, v21
    v_exp_f32 v22, v22
    v_exp_f32 v23, v23
    v_cvt_pk_bf16_f32 v64, v16, v17
    v_cvt_pk_bf16_f32 v65, v18, v19
    v_mfma_f32_32x32x16_bf16 v[48:63], v[100:103], v[72:75], v[48:63]
    v_exp_f32 v24, v24
    v_exp_f32 v25, v25
    v_exp_f32 v26, v26
    v_exp_f32 v27, v27
    v_cvt_pk_bf16_f32 v66, v20, v21
    v_cvt_pk_bf16_f32 v67, v22, v23
    v_mfma_f32_32x32x16_bf16 v[48:63], v[104:107], v[76:79], v[48:63]
    v_exp_f32 v28, v28
    v_exp_f32 v29, v29
    v_exp_f32 v30, v30
    v_exp_f32 v31, v31
    v_cvt_pk_bf16_f32 v68, v24, v25
    v_cvt_pk_bf16_f32 v69, v26, v27
    v_cvt_pk_bf16_f32 v70, v28, v29
    v_cvt_pk_bf16_f32 v71, v30, v31
    s_cbranch_vccz gated_mix__ssm_conv_s4__grouped_kv_mqa__prompt_kernel_p_14
    s_setprio 1
gated_mix__ssm_conv_s4__grouped_kv_mqa__prompt_kernel_p_14:
    v_add_u32 v2, 32768, v2
    v_add_u32 v3, 32768, v3
    ds_read_b128 v[84:87], v2 offset:32256
    ds_read_b64 v[90:91], v3 offset:33280
    s_mov_b64 exec, s[24:25]
    ds_read_b128 v[100:103], v10 offset:61184
    ds_read_b128 v[104:107], v10 offset:61824
    s_mov_b64 exec, -1
    s_waitcnt lgkmcnt(4)
    v_mfma_f32_32x32x16_bf16 v[16:31], v[80:83], v[4:7], 0
    v_exp_f32 v32, v32
    v_exp_f32 v33, v33
    v_exp_f32 v34, v34
    v_exp_f32 v35, v35
    v_mfma_f32_32x32x8_bf16 v[16:31], v[88:89], v[8:9], v[16:31]
    v_exp_f32 v36, v36
    v_exp_f32 v37, v37
    v_exp_f32 v38, v38
    v_exp_f32 v39, v39
    v_cvt_pk_bf16_f32 v72, v32, v33
    v_cvt_pk_bf16_f32 v73, v34, v35
    v_mfma_f32_32x32x16_bf16 v[48:63], v[92:95], v[64:67], v[48:63]
    v_exp_f32 v40, v40
    v_exp_f32 v41, v41
    v_exp_f32 v42, v42
    v_exp_f32 v43, v43
    v_cvt_pk_bf16_f32 v74, v36, v37
    v_cvt_pk_bf16_f32 v75, v38, v39
    v_mfma_f32_32x32x16_bf16 v[48:63], v[96:99], v[68:71], v[48:63]
    v_exp_f32 v44, v44
    v_exp_f32 v45, v45
    v_exp_f32 v46, v46
    v_exp_f32 v47, v47
    v_cvt_pk_bf16_f32 v76, v40, v41
    v_cvt_pk_bf16_f32 v77, v42, v43
    v_cvt_pk_bf16_f32 v78, v44, v45
    v_cvt_pk_bf16_f32 v79, v46, v47
    ds_read_b128 v[80:83], v2 offset:39936
    ds_read_b64 v[88:89], v3 offset:40960
    s_mov_b64 exec, s[24:25]
    ds_read_b128 v[92:95], v10 offset:63744
    ds_read_b128 v[96:99], v10 offset:64384
    s_mov_b64 exec, -1
    s_waitcnt lgkmcnt(4)
    v_mfma_f32_32x32x16_bf16 v[32:47], v[84:87], v[4:7], 0
    v_exp_f32 v16, v16
    v_exp_f32 v17, v17
    v_exp_f32 v18, v18
    v_exp_f32 v19, v19
    v_mfma_f32_32x32x8_bf16 v[32:47], v[90:91], v[8:9], v[32:47]
    v_exp_f32 v20, v20
    v_exp_f32 v21, v21
    v_exp_f32 v22, v22
    v_exp_f32 v23, v23
    v_cvt_pk_bf16_f32 v64, v16, v17
    v_cvt_pk_bf16_f32 v65, v18, v19
    v_mfma_f32_32x32x16_bf16 v[48:63], v[100:103], v[72:75], v[48:63]
    v_exp_f32 v24, v24
    v_exp_f32 v25, v25
    v_exp_f32 v26, v26
    v_exp_f32 v27, v27
    v_cvt_pk_bf16_f32 v66, v20, v21
    v_cvt_pk_bf16_f32 v67, v22, v23
    v_mfma_f32_32x32x16_bf16 v[48:63], v[104:107], v[76:79], v[48:63]
    v_exp_f32 v28, v28
    v_exp_f32 v29, v29
    v_exp_f32 v30, v30
    v_exp_f32 v31, v31
    v_cvt_pk_bf16_f32 v68, v24, v25
    v_cvt_pk_bf16_f32 v69, v26, v27
    v_cvt_pk_bf16_f32 v70, v28, v29
    v_cvt_pk_bf16_f32 v71, v30, v31
    ds_read_b128 v[84:87], v2 offset:42496
    ds_read_b64 v[90:91], v3 offset:43520
    v_add_u32 v10, 32768, v10
    s_mov_b64 exec, s[24:25]
    ds_read_b128 v[100:103], v10 offset:33536
    ds_read_b128 v[104:107], v10 offset:34176
    s_mov_b64 exec, -1
    s_waitcnt lgkmcnt(4)
    v_mfma_f32_32x32x16_bf16 v[16:31], v[80:83], v[4:7], 0
    v_exp_f32 v32, v32
    v_exp_f32 v33, v33
    v_exp_f32 v34, v34
    v_exp_f32 v35, v35
    v_mfma_f32_32x32x8_bf16 v[16:31], v[88:89], v[8:9], v[16:31]
    v_exp_f32 v36, v36
    v_exp_f32 v37, v37
    v_exp_f32 v38, v38
    v_exp_f32 v39, v39
    v_cvt_pk_bf16_f32 v72, v32, v33
    v_cvt_pk_bf16_f32 v73, v34, v35
    v_mfma_f32_32x32x16_bf16 v[48:63], v[92:95], v[64:67], v[48:63]
    v_exp_f32 v40, v40
    v_exp_f32 v41, v41
    v_exp_f32 v42, v42
    v_exp_f32 v43, v43
    v_cvt_pk_bf16_f32 v74, v36, v37
    v_cvt_pk_bf16_f32 v75, v38, v39
    v_mfma_f32_32x32x16_bf16 v[48:63], v[96:99], v[68:71], v[48:63]
    v_exp_f32 v44, v44
    v_exp_f32 v45, v45
    v_exp_f32 v46, v46
    v_exp_f32 v47, v47
    v_cvt_pk_bf16_f32 v76, v40, v41
    v_cvt_pk_bf16_f32 v77, v42, v43
    v_cvt_pk_bf16_f32 v78, v44, v45
    v_cvt_pk_bf16_f32 v79, v46, v47
    s_setprio 0
    ds_read_b128 v[80:83], v2 offset:45056
    ds_read_b64 v[88:89], v3 offset:46080
    s_mov_b64 exec, s[24:25]
    ds_read_b128 v[92:95], v10 offset:41216
    ds_read_b128 v[96:99], v10 offset:41856
    s_mov_b64 exec, -1
    s_waitcnt lgkmcnt(4)
    v_mfma_f32_32x32x16_bf16 v[32:47], v[84:87], v[4:7], 0
    v_exp_f32 v16, v16
    v_exp_f32 v17, v17
    v_exp_f32 v18, v18
    v_exp_f32 v19, v19
    v_mfma_f32_32x32x8_bf16 v[32:47], v[90:91], v[8:9], v[32:47]
    v_exp_f32 v20, v20
    v_exp_f32 v21, v21
    v_exp_f32 v22, v22
    v_exp_f32 v23, v23
    v_cvt_pk_bf16_f32 v64, v16, v17
    v_cvt_pk_bf16_f32 v65, v18, v19
    v_mfma_f32_32x32x16_bf16 v[48:63], v[100:103], v[72:75], v[48:63]
    v_exp_f32 v24, v24
    v_exp_f32 v25, v25
    v_exp_f32 v26, v26
    v_exp_f32 v27, v27
    v_cvt_pk_bf16_f32 v66, v20, v21
    v_cvt_pk_bf16_f32 v67, v22, v23
    v_mfma_f32_32x32x16_bf16 v[48:63], v[104:107], v[76:79], v[48:63]
    v_exp_f32 v28, v28
    v_exp_f32 v29, v29
    v_exp_f32 v30, v30
    v_exp_f32 v31, v31
    v_cvt_pk_bf16_f32 v68, v24, v25
    v_cvt_pk_bf16_f32 v69, v26, v27
    v_cvt_pk_bf16_f32 v70, v28, v29
    v_cvt_pk_bf16_f32 v71, v30, v31
    s_cbranch_vccz gated_mix__ssm_conv_s4__grouped_kv_mqa__prompt_kernel_p_15
    s_setprio 1
gated_mix__ssm_conv_s4__grouped_kv_mqa__prompt_kernel_p_15:
    ds_read_b128 v[84:87], v2 offset:47616
    ds_read_b64 v[90:91], v3 offset:48640
    s_mov_b64 exec, s[24:25]
    ds_read_b128 v[100:103], v10 offset:43776
    ds_read_b128 v[104:107], v10 offset:44416
    s_mov_b64 exec, -1
    s_waitcnt lgkmcnt(4)
    v_mfma_f32_32x32x16_bf16 v[16:31], v[80:83], v[4:7], 0
    v_exp_f32 v32, v32
    v_exp_f32 v33, v33
    v_exp_f32 v34, v34
    v_exp_f32 v35, v35
    v_mfma_f32_32x32x8_bf16 v[16:31], v[88:89], v[8:9], v[16:31]
    v_exp_f32 v36, v36
    v_exp_f32 v37, v37
    v_exp_f32 v38, v38
    v_exp_f32 v39, v39
    v_cvt_pk_bf16_f32 v72, v32, v33
    v_cvt_pk_bf16_f32 v73, v34, v35
    v_mfma_f32_32x32x16_bf16 v[48:63], v[92:95], v[64:67], v[48:63]
    v_exp_f32 v40, v40
    v_exp_f32 v41, v41
    v_exp_f32 v42, v42
    v_exp_f32 v43, v43
    v_cvt_pk_bf16_f32 v74, v36, v37
    v_cvt_pk_bf16_f32 v75, v38, v39
    v_mfma_f32_32x32x16_bf16 v[48:63], v[96:99], v[68:71], v[48:63]
    v_exp_f32 v44, v44
    v_exp_f32 v45, v45
    v_exp_f32 v46, v46
    v_exp_f32 v47, v47
    v_cvt_pk_bf16_f32 v76, v40, v41
    v_cvt_pk_bf16_f32 v77, v42, v43
    v_cvt_pk_bf16_f32 v78, v44, v45
    v_cvt_pk_bf16_f32 v79, v46, v47
    ds_read_b128 v[80:83], v2 offset:50176
    ds_read_b64 v[88:89], v3 offset:51200
    s_mov_b64 exec, s[24:25]
    ds_read_b128 v[92:95], v10 offset:46336
    ds_read_b128 v[96:99], v10 offset:46976
    s_mov_b64 exec, -1
    s_waitcnt lgkmcnt(4)
    v_mfma_f32_32x32x16_bf16 v[32:47], v[84:87], v[4:7], 0
    v_exp_f32 v16, v16
    v_exp_f32 v17, v17
    v_exp_f32 v18, v18
    v_exp_f32 v19, v19
    v_mfma_f32_32x32x8_bf16 v[32:47], v[90:91], v[8:9], v[32:47]
    v_exp_f32 v20, v20
    v_exp_f32 v21, v21
    v_exp_f32 v22, v22
    v_exp_f32 v23, v23
    v_cvt_pk_bf16_f32 v64, v16, v17
    v_cvt_pk_bf16_f32 v65, v18, v19
    v_mfma_f32_32x32x16_bf16 v[48:63], v[100:103], v[72:75], v[48:63]
    v_exp_f32 v24, v24
    v_exp_f32 v25, v25
    v_exp_f32 v26, v26
    v_exp_f32 v27, v27
    v_cvt_pk_bf16_f32 v66, v20, v21
    v_cvt_pk_bf16_f32 v67, v22, v23
    v_mfma_f32_32x32x16_bf16 v[48:63], v[104:107], v[76:79], v[48:63]
    v_exp_f32 v28, v28
    v_exp_f32 v29, v29
    v_exp_f32 v30, v30
    v_exp_f32 v31, v31
    v_cvt_pk_bf16_f32 v68, v24, v25
    v_cvt_pk_bf16_f32 v69, v26, v27
    v_cvt_pk_bf16_f32 v70, v28, v29
    v_cvt_pk_bf16_f32 v71, v30, v31
    ds_read_b128 v[84:87], v2 offset:52736
    ds_read_b64 v[90:91], v3 offset:53760
    s_mov_b64 exec, s[24:25]
    ds_read_b128 v[100:103], v10 offset:48896
    ds_read_b128 v[104:107], v10 offset:49536
    s_mov_b64 exec, -1
    s_waitcnt lgkmcnt(4)
    v_mfma_f32_32x32x16_bf16 v[16:31], v[80:83], v[4:7], 0
    v_exp_f32 v32, v32
    v_exp_f32 v33, v33
    v_exp_f32 v34, v34
    v_exp_f32 v35, v35
    v_mfma_f32_32x32x8_bf16 v[16:31], v[88:89], v[8:9], v[16:31]
    v_exp_f32 v36, v36
    v_exp_f32 v37, v37
    v_exp_f32 v38, v38
    v_exp_f32 v39, v39
    v_cvt_pk_bf16_f32 v72, v32, v33
    v_cvt_pk_bf16_f32 v73, v34, v35
    v_mfma_f32_32x32x16_bf16 v[48:63], v[92:95], v[64:67], v[48:63]
    v_exp_f32 v40, v40
    v_exp_f32 v41, v41
    v_exp_f32 v42, v42
    v_exp_f32 v43, v43
    v_cvt_pk_bf16_f32 v74, v36, v37
    v_cvt_pk_bf16_f32 v75, v38, v39
    v_mfma_f32_32x32x16_bf16 v[48:63], v[96:99], v[68:71], v[48:63]
    v_exp_f32 v44, v44
    v_exp_f32 v45, v45
    v_exp_f32 v46, v46
    v_exp_f32 v47, v47
    v_cvt_pk_bf16_f32 v76, v40, v41
    v_cvt_pk_bf16_f32 v77, v42, v43
    v_cvt_pk_bf16_f32 v78, v44, v45
    v_cvt_pk_bf16_f32 v79, v46, v47
    s_setprio 0
    ds_read_b128 v[80:83], v2 offset:55296
    ds_read_b64 v[88:89], v3 offset:56320
    s_mov_b64 exec, s[24:25]
    ds_read_b128 v[92:95], v10 offset:51456
    ds_read_b128 v[96:99], v10 offset:52096
    s_mov_b64 exec, -1
    s_waitcnt lgkmcnt(4)
    v_mfma_f32_32x32x16_bf16 v[32:47], v[84:87], v[4:7], 0
    v_exp_f32 v16, v16
    v_exp_f32 v17, v17
    v_exp_f32 v18, v18
    v_exp_f32 v19, v19
    v_mfma_f32_32x32x8_bf16 v[32:47], v[90:91], v[8:9], v[32:47]
    v_exp_f32 v20, v20
    v_exp_f32 v21, v21
    v_exp_f32 v22, v22
    v_exp_f32 v23, v23
    v_cvt_pk_bf16_f32 v64, v16, v17
    v_cvt_pk_bf16_f32 v65, v18, v19
    v_mfma_f32_32x32x16_bf16 v[48:63], v[100:103], v[72:75], v[48:63]
    v_exp_f32 v24, v24
    v_exp_f32 v25, v25
    v_exp_f32 v26, v26
    v_exp_f32 v27, v27
    v_cvt_pk_bf16_f32 v66, v20, v21
    v_cvt_pk_bf16_f32 v67, v22, v23
    v_mfma_f32_32x32x16_bf16 v[48:63], v[104:107], v[76:79], v[48:63]
    v_exp_f32 v28, v28
    v_exp_f32 v29, v29
    v_exp_f32 v30, v30
    v_exp_f32 v31, v31
    v_cvt_pk_bf16_f32 v68, v24, v25
    v_cvt_pk_bf16_f32 v69, v26, v27
    v_cvt_pk_bf16_f32 v70, v28, v29
    v_cvt_pk_bf16_f32 v71, v30, v31
    s_cbranch_vccz gated_mix__ssm_conv_s4__grouped_kv_mqa__prompt_kernel_p_16
    s_setprio 1
gated_mix__ssm_conv_s4__grouped_kv_mqa__prompt_kernel_p_16:
    ds_read_b128 v[84:87], v2 offset:57856
    ds_read_b64 v[90:91], v3 offset:58880
    s_mov_b64 exec, s[24:25]
    ds_read_b128 v[100:103], v10 offset:54016
    ds_read_b128 v[104:107], v10 offset:54656
    s_mov_b64 exec, -1
    s_waitcnt lgkmcnt(4)
    v_mfma_f32_32x32x16_bf16 v[16:31], v[80:83], v[4:7], 0
    v_exp_f32 v32, v32
    v_exp_f32 v33, v33
    v_exp_f32 v34, v34
    v_exp_f32 v35, v35
    v_mfma_f32_32x32x8_bf16 v[16:31], v[88:89], v[8:9], v[16:31]
    v_exp_f32 v36, v36
    v_exp_f32 v37, v37
    v_exp_f32 v38, v38
    v_exp_f32 v39, v39
    v_cvt_pk_bf16_f32 v72, v32, v33
    v_cvt_pk_bf16_f32 v73, v34, v35
    v_mfma_f32_32x32x16_bf16 v[48:63], v[92:95], v[64:67], v[48:63]
    v_exp_f32 v40, v40
    v_exp_f32 v41, v41
    v_exp_f32 v42, v42
    v_exp_f32 v43, v43
    v_cvt_pk_bf16_f32 v74, v36, v37
    v_cvt_pk_bf16_f32 v75, v38, v39
    v_mfma_f32_32x32x16_bf16 v[48:63], v[96:99], v[68:71], v[48:63]
    v_exp_f32 v44, v44
    v_exp_f32 v45, v45
    v_exp_f32 v46, v46
    v_exp_f32 v47, v47
    v_cvt_pk_bf16_f32 v76, v40, v41
    v_cvt_pk_bf16_f32 v77, v42, v43
    v_cvt_pk_bf16_f32 v78, v44, v45
    v_cvt_pk_bf16_f32 v79, v46, v47
    s_mov_b64 exec, s[24:25]
    ds_read_b128 v[92:95], v10 offset:56576
    ds_read_b128 v[96:99], v10 offset:57216
    s_mov_b64 exec, -1
    s_waitcnt lgkmcnt(2)
    v_mfma_f32_32x32x16_bf16 v[32:47], v[84:87], v[4:7], 0
    v_exp_f32 v16, v16
    v_exp_f32 v17, v17
    v_exp_f32 v18, v18
    v_exp_f32 v19, v19
    v_mfma_f32_32x32x8_bf16 v[32:47], v[90:91], v[8:9], v[32:47]
    v_exp_f32 v20, v20
    v_exp_f32 v21, v21
    v_exp_f32 v22, v22
    v_exp_f32 v23, v23
    v_cvt_pk_bf16_f32 v64, v16, v17
    v_cvt_pk_bf16_f32 v65, v18, v19
    v_mfma_f32_32x32x16_bf16 v[48:63], v[100:103], v[72:75], v[48:63]
    v_exp_f32 v24, v24
    v_exp_f32 v25, v25
    v_exp_f32 v26, v26
    v_exp_f32 v27, v27
    v_cvt_pk_bf16_f32 v66, v20, v21
    v_cvt_pk_bf16_f32 v67, v22, v23
    v_mfma_f32_32x32x16_bf16 v[48:63], v[104:107], v[76:79], v[48:63]
    v_exp_f32 v28, v28
    v_exp_f32 v29, v29
    v_exp_f32 v30, v30
    v_exp_f32 v31, v31
    v_cvt_pk_bf16_f32 v68, v24, v25
    v_cvt_pk_bf16_f32 v69, v26, v27
    v_cvt_pk_bf16_f32 v70, v28, v29
    v_cvt_pk_bf16_f32 v71, v30, v31
    s_mov_b64 exec, s[24:25]
    ds_read_b128 v[100:103], v10 offset:59136
    ds_read_b128 v[104:107], v10 offset:59776
    s_mov_b64 exec, -1
    s_waitcnt lgkmcnt(2)
    v_exp_f32 v32, v32
    v_exp_f32 v33, v33
    v_exp_f32 v34, v34
    v_exp_f32 v35, v35
    v_exp_f32 v36, v36
    v_exp_f32 v37, v37
    v_exp_f32 v38, v38
    v_exp_f32 v39, v39
    v_cvt_pk_bf16_f32 v72, v32, v33
    v_cvt_pk_bf16_f32 v73, v34, v35
    v_mfma_f32_32x32x16_bf16 v[48:63], v[92:95], v[64:67], v[48:63]
    v_exp_f32 v40, v40
    v_exp_f32 v41, v41
    v_exp_f32 v42, v42
    v_exp_f32 v43, v43
    v_cvt_pk_bf16_f32 v74, v36, v37
    v_cvt_pk_bf16_f32 v75, v38, v39
    v_mfma_f32_32x32x16_bf16 v[48:63], v[96:99], v[68:71], v[48:63]
    v_exp_f32 v44, v44
    v_exp_f32 v45, v45
    v_exp_f32 v46, v46
    v_exp_f32 v47, v47
    v_cvt_pk_bf16_f32 v76, v40, v41
    v_cvt_pk_bf16_f32 v77, v42, v43
    v_cvt_pk_bf16_f32 v78, v44, v45
    v_cvt_pk_bf16_f32 v79, v46, v47
    s_waitcnt lgkmcnt(0)
    s_nop 1
    v_mfma_f32_32x32x16_bf16 v[48:63], v[100:103], v[72:75], v[48:63]
    v_mfma_f32_32x32x16_bf16 v[48:63], v[104:107], v[76:79], v[48:63]
    s_setprio 0
    s_mov_b32 s32, 0
    v_and_b32 v22, 7, v1
    v_lshlrev_b32 v22, 4, v22
    v_bfe_u32 v30, v1, 4, 1
    v_mul_u32_u24 v30, 1280, v30
    v_add_u32 v22, v22, v30
    v_bfe_u32 v30, v1, 3, 1
    v_lshl_add_u32 v23, v30, 9, v22
    v_lshl_add_u32 v23, v111, 8, v23
    v_lshl_add_u32 v22, v30, 3, v22
    v_lshlrev_b32 v30, 30, v111
    v_add3_u32 v22, v22, v30, 0
    s_lshr_b32 s27, s2, 1
    s_mul_i32 s27, s27, 20480
    s_and_b32 s26, s2, 1
    s_lshl_b32 s26, s26, 7
    s_add_u32 s27, s27, s26
    s_mul_i32 s26, s6, 2560
    s_add_u32 s27, s27, s26
    s_nop 7
    s_nop 1
gated_mix__ssm_conv_s4__grouped_kv_mqa__prompt_kernel_norm:
    v_mov_b32 v16, v56
    v_mov_b32 v17, v56
    s_nop 1
    v_permlane32_swap_b32 v16, v17
    s_cmp_eq_u32 s32, 1
    s_cbranch_scc1 gated_mix__ssm_conv_s4__grouped_kv_mqa__prompt_kernel_st
    v_max3_f32 v18, |v48|, |v49|, |v50|
    v_max3_f32 v19, |v51|, |v52|, |v53|
    v_max3_f32 v20, |v54|, |v55|, |v56|
    v_max3_f32 v21, |v57|, |v58|, |v59|
    v_max3_f32 v18, v18, v19, v20
    v_max_f32 v18, v18, v21
    v_mov_b32 v19, 0x30800000
    v_mov_b32 v20, 0x4e800000
    v_mov_b32 v21, 0x7b800000
    v_cmp_ge_f32 s[34:35], v17, v19
    v_cmp_le_f32 s[36:37], v17, v20
    v_cmp_le_f32 s[38:39], v18, v21
    s_nop 1
    s_and_b64 s[34:35], s[34:35], s[36:37]
    s_and_b64 s[34:35], s[34:35], s[38:39]
    s_cmp_eq_u64 s[34:35], -1
    s_cbranch_scc0 gated_mix__ssm_conv_s4__grouped_kv_mqa__prompt_kernel_fb
gated_mix__ssm_conv_s4__grouped_kv_mqa__prompt_kernel_st:
    v_rcp_f32 v17, v17
    s_nop 0
    v_mul_f32 v48, v48, v17
    v_mul_f32 v49, v49, v17
    v_mul_f32 v50, v50, v17
    v_mul_f32 v51, v51, v17
    v_mul_f32 v52, v52, v17
    v_mul_f32 v53, v53, v17
    v_mul_f32 v54, v54, v17
    v_mul_f32 v55, v55, v17
    v_mul_f32 v56, v56, v17
    v_mul_f32 v57, v57, v17
    v_mul_f32 v58, v58, v17
    v_mul_f32 v59, v59, v17
    v_cvt_pk_bf16_f32 v24, v48, v49
    v_cvt_pk_bf16_f32 v25, v50, v51
    v_cvt_pk_bf16_f32 v26, v52, v53
    v_cvt_pk_bf16_f32 v27, v54, v55
    v_cvt_pk_bf16_f32 v28, v56, v57
    v_cvt_pk_bf16_f32 v29, v58, v59
    buffer_store_dwordx4 v[24:27], v23, s[16:19], s27 offen sc1
    buffer_store_dwordx2 v[28:29], v22, s[16:19], s27 offen offset:1024 sc1
    s_waitcnt vmcnt(0)
    s_barrier
    s_lshr_b32 s7, s6, 2
    s_and_b32 s20, s6, 3
    s_mul_i32 s76, s78, 80
    s_lshl_b32 s77, s79, 6
    s_lshl_b32 s30, s7, 5
    s_add_u32 s77, s77, s30
    s_add_u32 s86, s20, 0
    s_cmp_ge_u32 s86, 5
    s_cselect_b32 s80, 1, 0
    s_mul_i32 s30, s80, 5
    s_sub_u32 s83, s86, s30
    s_add_u32 s87, s20, 4
    s_cmp_ge_u32 s87, 5
    s_cselect_b32 s81, 1, 0
    s_mul_i32 s30, s81, 5
    s_sub_u32 s84, s87, s30
    s_add_u32 s88, s20, 8
    s_sub_u32 s30, s88, 4
    s_cmp_lt_u32 s88, 10
    s_cselect_b32 s88, s88, s30
    s_cmp_ge_u32 s88, 5
    s_cselect_b32 s82, 1, 0
    s_mul_i32 s30, s82, 5
    s_sub_u32 s85, s88, s30
    v_lshrrev_b32 v2, 4, v1
    v_and_b32 v3, 15, v1
    v_mul_u32_u24 v8, 1280, v3
    v_lshl_add_u32 v8, v2, 3, v8
    v_lshlrev_b32 v2, 14, v2
    v_lshl_add_u32 v2, v3, 1, v2
    v_lshlrev_b32 v3, 2, v3
    s_lshl_b32 s31, s80, 4
    s_add_u32 s31, s31, s77
    s_lshl_b32 s32, s83, 4
    s_add_u32 s32, s32, s76
    s_mul_i32 s33, s31, 1280
    s_lshl_b32 s30, s32, 1
    s_add_u32 s36, s33, s30
    s_lshl_b32 s32, s32, 12
    s_lshl_b32 s33, s31, 1
    s_add_u32 s32, s32, s33
    s_add_u32 s30, s32, 0
    buffer_load_short_d16_hi v64, v2, s[64:67], s30 offen sc1
    s_add_u32 s30, s32, 4096
    buffer_load_short_d16_hi v65, v2, s[64:67], s30 offen sc1
    s_add_u32 s30, s32, 8192
    buffer_load_short_d16_hi v66, v2, s[64:67], s30 offen sc1
    s_add_u32 s30, s32, 12288
    buffer_load_short_d16_hi v67, v2, s[64:67], s30 offen sc1
    s_lshl_b32 s33, s31, 2
    buffer_load_dword v76, v3, s[68:71], s33 offen sc1
    s_lshl_b32 s31, s81, 4
    s_add_u32 s31, s31, s77
    s_lshl_b32 s32, s84, 4
    s_add_u32 s32, s32, s76
    s_mul_i32 s33, s31, 1280
    s_lshl_b32 s30, s32, 1
    s_add_u32 s37, s33, s30
    s_lshl_b32 s32, s32, 12
    s_lshl_b32 s33, s31, 1
    s_add_u32 s32, s32, s33
    s_add_u32 s30, s32, 0
    buffer_load_short_d16_hi v68, v2, s[64:67], s30 offen sc1
    s_add_u32 s30, s32, 4096
    buffer_load_short_d16_hi v69, v2, s[64:67], s30 offen sc1
    s_add_u32 s30, s32, 8192
    buffer_load_short_d16_hi v70, v2, s[64:67], s30 offen sc1
    s_add_u32 s30, s32, 12288
    buffer_load_short_d16_hi v71, v2, s[64:67], s30 offen sc1
    s_lshl_b32 s33, s31, 2
    buffer_load_dword v77, v3, s[68:71], s33 offen sc1
    s_lshl_b32 s31, s82, 4
    s_add_u32 s31, s31, s77
    s_lshl_b32 s32, s85, 4
    s_add_u32 s32, s32, s76
    s_mul_i32 s33, s31, 1280
    s_lshl_b32 s30, s32, 1
    s_add_u32 s38, s33, s30
    s_lshl_b32 s32, s32, 12
    s_lshl_b32 s33, s31, 1
    s_add_u32 s32, s32, s33
    s_add_u32 s30, s32, 0
    buffer_load_short_d16_hi v72, v2, s[64:67], s30 offen sc1
    s_add_u32 s30, s32, 4096
    buffer_load_short_d16_hi v73, v2, s[64:67], s30 offen sc1
    s_add_u32 s30, s32, 8192
    buffer_load_short_d16_hi v74, v2, s[64:67], s30 offen sc1
    s_add_u32 s30, s32, 12288
    buffer_load_short_d16_hi v75, v2, s[64:67], s30 offen sc1
    s_lshl_b32 s33, s31, 2
    buffer_load_dword v78, v3, s[68:71], s33 offen sc1
    s_mul_i32 s30, s7, 40960
    s_add_u32 s30, s30, 40960
    v_lshlrev_b32 v10, 4, v1
    v_add_u32 v10, s30, v10
    s_lshl_b32 s30, s86, 12
    v_add_u32 v4, s30, v10
    s_lshl_b32 s30, s87, 12
    v_add_u32 v5, s30, v10
    s_lshl_b32 s30, s88, 12
    v_add_u32 v6, s30, v10
    s_waitcnt vmcnt(0)
    v_and_b32 v64, 0xffff0000, v64
    v_and_b32 v65, 0xffff0000, v65
    v_and_b32 v66, 0xffff0000, v66
    v_and_b32 v67, 0xffff0000, v67
    v_and_b32 v68, 0xffff0000, v68
    v_and_b32 v69, 0xffff0000, v69
    v_and_b32 v70, 0xffff0000, v70
    v_and_b32 v71, 0xffff0000, v71
    v_and_b32 v72, 0xffff0000, v72
    v_and_b32 v73, 0xffff0000, v73
    v_and_b32 v74, 0xffff0000, v74
    v_and_b32 v75, 0xffff0000, v75
    v_sub_f32 v80, 1.0, v76
    v_mul_f32 v64, v64, v76
    v_mul_f32 v65, v65, v76
    v_mul_f32 v66, v66, v76
    v_mul_f32 v67, v67, v76
    v_sub_f32 v81, 1.0, v77
    v_mul_f32 v68, v68, v77
    v_mul_f32 v69, v69, v77
    v_mul_f32 v70, v70, v77
    v_mul_f32 v71, v71, v77
    v_sub_f32 v82, 1.0, v78
    v_mul_f32 v72, v72, v78
    v_mul_f32 v73, v73, v78
    v_mul_f32 v74, v74, v78
    v_mul_f32 v75, v75, v78
    v_cvt_pk_bf16_f32 v80, v80, v80
    v_cvt_pk_bf16_f32 v84, v64, v65
    v_cvt_pk_bf16_f32 v85, v66, v67
    v_cvt_pk_bf16_f32 v81, v81, v81
    v_cvt_pk_bf16_f32 v86, v68, v69
    v_cvt_pk_bf16_f32 v87, v70, v71
    v_cvt_pk_bf16_f32 v82, v82, v82
    v_cvt_pk_bf16_f32 v88, v72, v73
    v_cvt_pk_bf16_f32 v89, v74, v75
    v_and_b32 v80, 0xffff0000, v80
    v_lshlrev_b32 v64, 16, v84
    v_and_b32 v65, 0xffff0000, v84
    v_lshlrev_b32 v66, 16, v85
    v_and_b32 v67, 0xffff0000, v85
    v_and_b32 v81, 0xffff0000, v81
    v_lshlrev_b32 v68, 16, v86
    v_and_b32 v69, 0xffff0000, v86
    v_lshlrev_b32 v70, 16, v87
    v_and_b32 v71, 0xffff0000, v87
    v_and_b32 v82, 0xffff0000, v82
    v_lshlrev_b32 v72, 16, v88
    v_and_b32 v73, 0xffff0000, v88
    v_lshlrev_b32 v74, 16, v89
    v_and_b32 v75, 0xffff0000, v89
    s_barrier
    ds_read_b128 v[16:19], v4 offset:0
    ds_read_b128 v[20:23], v4 offset:1024
    ds_read_b128 v[24:27], v4 offset:2048
    ds_read_b128 v[28:31], v4 offset:3072
    ds_read_b128 v[32:35], v5 offset:0
    ds_read_b128 v[36:39], v5 offset:1024
    ds_read_b128 v[40:43], v5 offset:2048
    ds_read_b128 v[44:47], v5 offset:3072
    ds_read_b128 v[48:51], v6 offset:0
    ds_read_b128 v[52:55], v6 offset:1024
    ds_read_b128 v[56:59], v6 offset:2048
    ds_read_b128 v[60:63], v6 offset:3072
    s_waitcnt lgkmcnt(8)
    v_add_f32 v16, v16, v20
    v_add_f32 v17, v17, v21
    v_add_f32 v18, v18, v22
    v_add_f32 v19, v19, v23
    v_add_f32 v24, v24, v28
    v_add_f32 v25, v25, v29
    v_add_f32 v26, v26, v30
    v_add_f32 v27, v27, v31
    v_add_f32 v16, v16, v24
    v_add_f32 v17, v17, v25
    v_add_f32 v18, v18, v26
    v_add_f32 v19, v19, v27
    v_cvt_pk_bf16_f32 v20, v16, v17
    v_cvt_pk_bf16_f32 v21, v18, v19
    v_lshlrev_b32 v16, 16, v20
    v_and_b32 v17, 0xffff0000, v20
    v_lshlrev_b32 v18, 16, v21
    v_and_b32 v19, 0xffff0000, v21
    v_mul_f32 v16, v16, v80
    v_mul_f32 v17, v17, v80
    v_mul_f32 v18, v18, v80
    v_mul_f32 v19, v19, v80
    v_cvt_pk_bf16_f32 v20, v16, v17
    v_cvt_pk_bf16_f32 v21, v18, v19
    v_lshlrev_b32 v16, 16, v20
    v_and_b32 v17, 0xffff0000, v20
    v_lshlrev_b32 v18, 16, v21
    v_and_b32 v19, 0xffff0000, v21
    v_add_f32 v16, v16, v64
    v_add_f32 v17, v17, v65
    v_add_f32 v18, v18, v66
    v_add_f32 v19, v19, v67
    v_cvt_pk_bf16_f32 v20, v16, v17
    v_cvt_pk_bf16_f32 v21, v18, v19
    buffer_store_dwordx2 v[20:21], v8, s[72:75], s36 offen
    s_waitcnt lgkmcnt(4)
    v_add_f32 v32, v32, v36
    v_add_f32 v33, v33, v37
    v_add_f32 v34, v34, v38
    v_add_f32 v35, v35, v39
    v_add_f32 v40, v40, v44
    v_add_f32 v41, v41, v45
    v_add_f32 v42, v42, v46
    v_add_f32 v43, v43, v47
    v_add_f32 v32, v32, v40
    v_add_f32 v33, v33, v41
    v_add_f32 v34, v34, v42
    v_add_f32 v35, v35, v43
    v_cvt_pk_bf16_f32 v36, v32, v33
    v_cvt_pk_bf16_f32 v37, v34, v35
    v_lshlrev_b32 v32, 16, v36
    v_and_b32 v33, 0xffff0000, v36
    v_lshlrev_b32 v34, 16, v37
    v_and_b32 v35, 0xffff0000, v37
    v_mul_f32 v32, v32, v81
    v_mul_f32 v33, v33, v81
    v_mul_f32 v34, v34, v81
    v_mul_f32 v35, v35, v81
    v_cvt_pk_bf16_f32 v36, v32, v33
    v_cvt_pk_bf16_f32 v37, v34, v35
    v_lshlrev_b32 v32, 16, v36
    v_and_b32 v33, 0xffff0000, v36
    v_lshlrev_b32 v34, 16, v37
    v_and_b32 v35, 0xffff0000, v37
    v_add_f32 v32, v32, v68
    v_add_f32 v33, v33, v69
    v_add_f32 v34, v34, v70
    v_add_f32 v35, v35, v71
    v_cvt_pk_bf16_f32 v36, v32, v33
    v_cvt_pk_bf16_f32 v37, v34, v35
    buffer_store_dwordx2 v[36:37], v8, s[72:75], s37 offen
    s_waitcnt lgkmcnt(0)
    v_add_f32 v48, v48, v52
    v_add_f32 v49, v49, v53
    v_add_f32 v50, v50, v54
    v_add_f32 v51, v51, v55
    v_add_f32 v56, v56, v60
    v_add_f32 v57, v57, v61
    v_add_f32 v58, v58, v62
    v_add_f32 v59, v59, v63
    v_add_f32 v48, v48, v56
    v_add_f32 v49, v49, v57
    v_add_f32 v50, v50, v58
    v_add_f32 v51, v51, v59
    v_cvt_pk_bf16_f32 v52, v48, v49
    v_cvt_pk_bf16_f32 v53, v50, v51
    v_lshlrev_b32 v48, 16, v52
    v_and_b32 v49, 0xffff0000, v52
    v_lshlrev_b32 v50, 16, v53
    v_and_b32 v51, 0xffff0000, v53
    v_mul_f32 v48, v48, v82
    v_mul_f32 v49, v49, v82
    v_mul_f32 v50, v50, v82
    v_mul_f32 v51, v51, v82
    v_cvt_pk_bf16_f32 v52, v48, v49
    v_cvt_pk_bf16_f32 v53, v50, v51
    v_lshlrev_b32 v48, 16, v52
    v_and_b32 v49, 0xffff0000, v52
    v_lshlrev_b32 v50, 16, v53
    v_and_b32 v51, 0xffff0000, v53
    v_add_f32 v48, v48, v72
    v_add_f32 v49, v49, v73
    v_add_f32 v50, v50, v74
    v_add_f32 v51, v51, v75
    v_cvt_pk_bf16_f32 v52, v48, v49
    v_cvt_pk_bf16_f32 v53, v50, v51
    s_cmp_ge_u32 s20, 2
    s_cbranch_scc1 gated_mix__ssm_conv_s4__grouped_kv_mqa__prompt_kernel_ns
    buffer_store_dwordx2 v[52:53], v8, s[72:75], s38 offen
gated_mix__ssm_conv_s4__grouped_kv_mqa__prompt_kernel_ns:
    s_branch gated_mix__ssm_conv_s4__grouped_kv_mqa__prompt_kernel_end
gated_mix__ssm_conv_s4__grouped_kv_mqa__prompt_kernel_fb:
    v_lshlrev_b32 v2, 4, v1
    v_lshlrev_b32 v3, 3, v110
    v_mul_u32_u24 v10, 320, v111
    v_lshl_add_u32 v10, v110, 4, v10
    v_cmp_gt_u32 vcc, 20, v110
    v_mov_b32 v16, 0x40000000
    s_nop 1
    v_cndmask_b32 v10, v16, v10, vcc
    v_mov_b32 v16, 0xff800000
    s_mov_b32 s33, 0
gated_mix__ssm_conv_s4__grouped_kv_mqa__prompt_kernel_f1:
    buffer_load_dwordx4 v[80:83], v2, s[8:11], s33 offen
    buffer_load_dwordx2 v[88:89], v3, s[8:11], s33 offen offset:1024
    s_waitcnt vmcnt(0)
    v_mfma_f32_32x32x16_bf16 v[32:47], v[80:83], v[4:7], 0
    v_mfma_f32_32x32x8_bf16 v[32:47], v[88:89], v[8:9], v[32:47]
    s_nop 7
    s_nop 7
    v_max3_f32 v16, v16, v32, v33
    v_max3_f32 v16, v16, v34, v35
    v_max3_f32 v16, v16, v36, v37
    v_max3_f32 v16, v16, v38, v39
    v_max3_f32 v16, v16, v40, v41
    v_max3_f32 v16, v16, v42, v43
    v_max3_f32 v16, v16, v44, v45
    v_max3_f32 v16, v16, v46, v47
    s_add_u32 s33, s33, 2560
    s_cmp_lt_u32 s33, 163840
    s_cbranch_scc1 gated_mix__ssm_conv_s4__grouped_kv_mqa__prompt_kernel_f1
    v_mov_b32 v17, v16
    s_nop 1
    v_permlane32_swap_b32 v16, v17
    s_nop 1
    v_max_f32 v16, v16, v17
    v_mul_f32 v112, -1.0, v16
    v_mul_f32 v113, -1.0, v16
    v_mul_f32 v114, -1.0, v16
    v_mul_f32 v115, -1.0, v16
    v_mul_f32 v116, -1.0, v16
    v_mul_f32 v117, -1.0, v16
    v_mul_f32 v118, -1.0, v16
    v_mul_f32 v119, -1.0, v16
    v_mul_f32 v120, -1.0, v16
    v_mul_f32 v121, -1.0, v16
    v_mul_f32 v122, -1.0, v16
    v_mul_f32 v123, -1.0, v16
    v_mul_f32 v124, -1.0, v16
    v_mul_f32 v125, -1.0, v16
    v_mul_f32 v126, -1.0, v16
    v_mul_f32 v127, -1.0, v16
    v_mov_b32 v48, 0
    v_mov_b32 v49, 0
    v_mov_b32 v50, 0
    v_mov_b32 v51, 0
    v_mov_b32 v52, 0
    v_mov_b32 v53, 0
    v_mov_b32 v54, 0
    v_mov_b32 v55, 0
    v_mov_b32 v56, 0
    v_mov_b32 v57, 0
    v_mov_b32 v58, 0
    v_mov_b32 v59, 0
    v_mov_b32 v60, 0
    v_mov_b32 v61, 0
    v_mov_b32 v62, 0
    v_mov_b32 v63, 0
    s_mov_b32 s33, 0
gated_mix__ssm_conv_s4__grouped_kv_mqa__prompt_kernel_f2:
    buffer_load_dwordx4 v[80:83], v2, s[8:11], s33 offen
    buffer_load_dwordx2 v[88:89], v3, s[8:11], s33 offen offset:1024
    buffer_load_dwordx4 v[92:95], v10, s[8:11], s33 offen offset:1280
    buffer_load_dwordx4 v[96:99], v10, s[8:11], s33 offen offset:1920
    s_waitcnt vmcnt(0)
    v_mfma_f32_32x32x16_bf16 v[32:47], v[80:83], v[4:7], v[112:127]
    v_mfma_f32_32x32x8_bf16 v[32:47], v[88:89], v[8:9], v[32:47]
    v_or_b32 v92, v92, v108
    v_or_b32 v93, v93, v108
    v_or_b32 v94, v94, v108
    v_or_b32 v95, v95, v108
    v_or_b32 v96, v96, v108
    v_or_b32 v97, v97, v108
    v_or_b32 v98, v98, v108
    v_or_b32 v99, v99, v108
    s_nop 7
    s_nop 7
    v_exp_f32 v32, v32
    v_exp_f32 v33, v33
    v_exp_f32 v34, v34
    v_exp_f32 v35, v35
    v_exp_f32 v36, v36
    v_exp_f32 v37, v37
    v_exp_f32 v38, v38
    v_exp_f32 v39, v39
    v_exp_f32 v40, v40
    v_exp_f32 v41, v41
    v_exp_f32 v42, v42
    v_exp_f32 v43, v43
    v_exp_f32 v44, v44
    v_exp_f32 v45, v45
    v_exp_f32 v46, v46
    v_exp_f32 v47, v47
    s_nop 0
    v_cvt_pk_bf16_f32 v64, v32, v33
    v_cvt_pk_bf16_f32 v65, v34, v35
    v_cvt_pk_bf16_f32 v66, v36, v37
    v_cvt_pk_bf16_f32 v67, v38, v39
    v_cvt_pk_bf16_f32 v68, v40, v41
    v_cvt_pk_bf16_f32 v69, v42, v43
    v_cvt_pk_bf16_f32 v70, v44, v45
    v_cvt_pk_bf16_f32 v71, v46, v47
    s_nop 1
    v_mfma_f32_32x32x16_bf16 v[48:63], v[92:95], v[64:67], v[48:63]
    v_mfma_f32_32x32x16_bf16 v[48:63], v[96:99], v[68:71], v[48:63]
    s_add_u32 s33, s33, 2560
    s_cmp_lt_u32 s33, 163840
    s_cbranch_scc1 gated_mix__ssm_conv_s4__grouped_kv_mqa__prompt_kernel_f2
    s_nop 7
    s_nop 7
    s_mov_b32 s32, 1
    s_branch gated_mix__ssm_conv_s4__grouped_kv_mqa__prompt_kernel_norm
gated_mix__ssm_conv_s4__grouped_kv_mqa__prompt_kernel_proj:
    s_sub_u32 s20, s6, 8
    s_and_b32 s21, s20, 3
    s_lshr_b32 s22, s20, 2
    v_lshlrev_b32 v0, 4, v1
    s_waitcnt lgkmcnt(0)
    s_add_u32 s8, s4, 0x280000
    s_addc_u32 s9, s5, 0
    s_mov_b32 s10, 0x28000
    s_mov_b32 s11, 0x00020000
    s_add_u32 s16, s4, 0x800000
    s_addc_u32 s17, s5, 0
    s_mov_b32 s18, 0x280000
    s_mov_b32 s19, 0x00020000
    s_mov_b32 s12, s4
    s_mov_b32 s13, s5
    s_mov_b32 s14, 0x280000
    s_mov_b32 s15, 0x00020000
    s_cmp_ge_u32 s3, 160
    s_cselect_b32 s26, 1, 0
    s_cmp_lt_u32 s3, 240
    s_cselect_b32 s26, s26, 0
    s_cmp_eq_u32 s26, 1
    s_cbranch_scc1 p_go
    v_lshrrev_b32 v2, 3, v1
    v_lshlrev_b32 v2, 8, v2
    v_and_b32 v3, 7, v1
    v_lshl_add_u32 v2, v3, 4, v2
    v_mov_b32 v4, -1
    v_mov_b32 v5, -1
    v_mov_b32 v6, -1
    v_mov_b32 v7, -1
    s_lshr_b32 s27, s2, 1
    s_mul_i32 s27, s27, 20480
    s_and_b32 s26, s2, 1
    s_lshl_b32 s26, s26, 7
    s_add_u32 s27, s27, s26
    s_lshl_b32 s26, s20, 11
    s_add_u32 s27, s27, s26
    buffer_store_dwordx4 v[4:7], v2, s[16:19], s27 offen sc1
    s_cmp_lt_u32 s20, 2
    s_cbranch_scc0 p_np2
    s_add_u32 s27, s27, 16384
    buffer_store_dwordx4 v[4:7], v2, s[16:19], s27 offen sc1
p_np2:
    s_cmp_lt_u32 s3, 160
    s_cbranch_scc0 p_go
    s_cmp_eq_u32 s20, 1
    s_cbranch_scc0 p_nw
    v_min_u32 v2, 1, v1
    v_lshlrev_b32 v2, 2, v2
    s_mov_b32 s26, 0
p_pf:
    global_load_dword v5, v2, s[94:95] offset:128 sc1
    s_waitcnt vmcnt(0)
    v_cmp_eq_u32 vcc, 1, v5
    s_add_u32 s26, s26, 1
    s_nop 3
    s_cmp_eq_u64 vcc, -1
    s_cbranch_scc1 p_pf_d
    s_cmp_lt_u32 s26, 20000
    s_cbranch_scc0 p_pf_d
    s_sleep 4
    s_branch p_pf
p_pf_d:
    v_mov_b32 v2, 157856
    v_mov_b32 v3, 4
    s_mov_b64 exec, 1
    ds_write_b32 v2, v3
    s_mov_b64 exec, -1
p_nw:
    v_mov_b32 v4, 157856
    v_lshlrev_b32 v5, 2, v1
    v_add_u32 v5, 157760, v5
    v_cmp_gt_u32 vcc, 8, v1
    s_nop 1
    v_cndmask_b32 v4, v4, v5, vcc
    s_mov_b32 s59, 0
p_fk:
    ds_read_b32 v2, v4 offset:0
    s_waitcnt lgkmcnt(0)
    v_cmp_le_u32 vcc, 4, v2
    s_nop 3
    s_cmp_eq_u64 vcc, -1
    s_cbranch_scc1 p_fk_d
    s_add_u32 s59, s59, 1
    s_cmp_lt_u32 s59, 100000
    s_cbranch_scc0 p_fk_d
    s_sleep 1
    s_branch p_fk
p_fk_d:
p_go:
    s_lshl_b32 s23, s78, 2
    s_add_u32 s23, s23, s79
    s_cmp_ge_u32 s20, 4
    s_cbranch_scc0 p_ne
    s_mov_b32 s26, 0x9a600000
    s_mov_b32 s27, 0xfe
    s_mul_i32 s28, s20, 5
    s_lshr_b64 s[26:27], s[26:27], s28
    s_and_b32 s26, s26, 31
    s_mul_i32 s26, s26, 5120
    s_add_u32 s28, s20, 28
    s_add_u32 s28, s28, s23
    s_and_b32 s28, s28, 31
    s_mul_i32 s28, s28, 5120
    s_mov_b32 m0, s26
    s_add_u32 s29, s28, 4096
    buffer_load_dwordx4 v0, s[8:11], s28 offen offset:0 lds
    buffer_load_dwordx4 v0, s[8:11], s28 offen offset:1024 lds
    buffer_load_dwordx4 v0, s[8:11], s28 offen offset:2048 lds
    buffer_load_dwordx4 v0, s[8:11], s28 offen offset:3072 lds
    s_add_u32 m0, s26, 4096
    s_nop 0
    buffer_load_dwordx4 v0, s[8:11], s29 offen lds
p_ne:
    s_lshr_b32 s26, s2, 1
    s_lshl_b32 s26, s26, 8
    s_add_u32 s26, s26, 0x2d0000
    v_min_u32 v2, 4, v1
    v_lshlrev_b32 v2, 2, v2
    v_add_u32 v2, s26, v2
    s_mov_b32 s26, 0
p_hl:
    global_load_dword v5, v2, s[4:5] sc1
    s_waitcnt vmcnt(0)
    v_cmp_eq_u32 vcc, 1, v5
    s_add_u32 s26, s26, 1
    s_nop 3
    s_cmp_eq_u64 vcc, -1
    s_cbranch_scc1 p_q
    s_cmp_lt_u32 s26, 20000
    s_cbranch_scc0 p_q
    s_sleep 2
    s_branch p_hl
p_q:
    v_lshrrev_b32 v11, 5, v1
    v_and_b32 v18, 7, v1
    v_bfe_u32 v19, v1, 3, 2
    v_mul_u32_u24 v14, 1280, v18
    v_mul_u32_u24 v19, 40, v19
    v_add_u32 v14, v14, v19
    v_lshlrev_b32 v15, 30, v11
    v_add3_u32 v15, v15, v14, 32
    v_lshl_add_u32 v14, v11, 4, v14
    s_mul_i32 s27, s2, 10240
    s_mul_i32 s26, s20, 160
    s_add_u32 s27, s27, s26
    s_lshl_b32 s26, s20, 10
    s_add_u32 s26, s26, 98304
    v_add_u32 v16, s26, v0
    s_lshl_b32 s26, s20, 8
    s_add_u32 s26, s26, 63488
    v_lshlrev_b32 v17, 3, v1
    v_add_u32 v17, s26, v17
    buffer_load_dwordx4 v[4:7], v14, s[12:15], s27 offen sc1
    buffer_load_dwordx2 v[8:9], v15, s[12:15], s27 offen sc1
    s_lshl_b32 s30, s79, 2
    s_lshl_b32 s31, s22, 1
    s_add_u32 s30, s30, s31
    s_mul_i32 s34, s30, 20480
    s_mul_i32 s31, s21, 5120
    s_add_u32 s34, s34, s31
    s_add_u32 s35, s34, 20480
    s_add_u32 s38, s34, 4096
    s_add_u32 s39, s35, 4096
    s_mul_i32 s36, s78, 102400
    s_mul_i32 s31, s21, 5120
    s_add_u32 s36, s36, s31
    s_mul_i32 s31, s22, 20480
    s_add_u32 s37, s36, s31
    s_add_u32 s37, s37, 61440
    s_mul_i32 s30, s22, 40960
    s_lshl_b32 s31, s21, 10
    s_add_u32 s31, s31, s30
    s_add_u32 s31, s31, 40960
    v_add_u32 v3, s31, v0
    s_mul_i32 s31, s21, 10240
    v_add_u32 v12, s31, v0
    s_add_u32 s60, s4, 0x300000
    s_addc_u32 s61, s5, 0
    s_mov_b32 s62, 0xc8000
    s_mov_b32 s63, 0x00020000
    s_waitcnt vmcnt(0)
    ds_write_b128 v16, v[4:7]
    s_mov_b32 exec_hi, 0
    ds_write_b64 v17, v[8:9]
    s_mov_b64 exec, -1
    s_waitcnt lgkmcnt(0)
    s_barrier
    s_mov_b32 s26, 0xca418820
    s_mov_b32 s27, 0x41
    s_mul_i32 s28, s20, 5
    s_lshr_b64 s[26:27], s[26:27], s28
    s_and_b32 s26, s26, 31
    s_mul_i32 s26, s26, 5120
    s_add_u32 s28, s20, 36
    s_add_u32 s28, s28, s23
    s_and_b32 s28, s28, 31
    s_mul_i32 s28, s28, 5120
    s_mov_b32 m0, s26
    s_add_u32 s29, s28, 4096
    buffer_load_dwordx4 v0, s[8:11], s28 offen offset:0 lds
    buffer_load_dwordx4 v0, s[8:11], s28 offen offset:1024 lds
    buffer_load_dwordx4 v0, s[8:11], s28 offen offset:2048 lds
    buffer_load_dwordx4 v0, s[8:11], s28 offen offset:3072 lds
    s_add_u32 m0, s26, 4096
    s_nop 0
    buffer_load_dwordx4 v0, s[8:11], s29 offen lds
    s_waitcnt vmcnt(0)
    s_barrier
    s_cmp_eq_u32 s20, 4
    s_cbranch_scc0 p_nd
    v_mov_b32 v2, 8
    v_mov_b32 v10, 1
    s_mov_b64 exec, 1
    global_atomic_add v5, v2, v10, s[94:95] sc0 sc1
    s_waitcnt vmcnt(0)
    v_readfirstlane_b32 s30, v5
    s_cmp_eq_u32 s30, 255
    s_cbranch_scc0 p_ar
    global_store_dword v2, v10, s[94:95] offset:128 sc1
p_ar:
    s_mov_b64 exec, -1
p_nd:
    s_mov_b32 s26, 0x1ee62d49
    s_mov_b32 s27, 0x8c
    s_mul_i32 s28, s20, 5
    s_lshr_b64 s[26:27], s[26:27], s28
    s_and_b32 s26, s26, 31
    s_mul_i32 s26, s26, 5120
    s_add_u32 s28, s20, 44
    s_add_u32 s28, s28, s23
    s_and_b32 s28, s28, 31
    s_mul_i32 s28, s28, 5120
    s_mov_b32 m0, s26
    s_add_u32 s29, s28, 4096
    buffer_load_dwordx4 v0, s[8:11], s28 offen offset:0 lds
    buffer_load_dwordx4 v0, s[8:11], s28 offen offset:1024 lds
    buffer_load_dwordx4 v0, s[8:11], s28 offen offset:2048 lds
    buffer_load_dwordx4 v0, s[8:11], s28 offen offset:3072 lds
    s_add_u32 m0, s26, 4096
    s_nop 0
    buffer_load_dwordx4 v0, s[8:11], s29 offen lds
    s_mov_b32 s26, 0x2f6ad272
    s_mov_b32 s27, 0xce
    s_mul_i32 s28, s20, 5
    s_lshr_b64 s[26:27], s[26:27], s28
    s_and_b32 s26, s26, 31
    s_mul_i32 s26, s26, 5120
    s_add_u32 s28, s20, 52
    s_add_u32 s28, s28, s23
    s_and_b32 s28, s28, 31
    s_mul_i32 s28, s28, 5120
    s_mov_b32 m0, s26
    s_add_u32 s29, s28, 4096
    buffer_load_dwordx4 v0, s[8:11], s28 offen offset:0 lds
    buffer_load_dwordx4 v0, s[8:11], s28 offen offset:1024 lds
    buffer_load_dwordx4 v0, s[8:11], s28 offen offset:2048 lds
    buffer_load_dwordx4 v0, s[8:11], s28 offen offset:3072 lds
    s_add_u32 m0, s26, 4096
    s_nop 0
    buffer_load_dwordx4 v0, s[8:11], s29 offen lds
    s_cmp_lt_u32 s20, 4
    s_cbranch_scc0 p_nl
    s_mov_b32 s26, 0xf779b
    s_mov_b32 s27, 0x0
    s_mul_i32 s28, s20, 5
    s_lshr_b64 s[26:27], s[26:27], s28
    s_and_b32 s26, s26, 31
    s_mul_i32 s26, s26, 5120
    s_add_u32 s28, s20, 60
    s_add_u32 s28, s28, s23
    s_and_b32 s28, s28, 31
    s_mul_i32 s28, s28, 5120
    s_mov_b32 m0, s26
    s_add_u32 s29, s28, 4096
    buffer_load_dwordx4 v0, s[8:11], s28 offen offset:0 lds
    buffer_load_dwordx4 v0, s[8:11], s28 offen offset:1024 lds
    buffer_load_dwordx4 v0, s[8:11], s28 offen offset:2048 lds
    buffer_load_dwordx4 v0, s[8:11], s28 offen offset:3072 lds
    s_add_u32 m0, s26, 4096
    s_nop 0
    buffer_load_dwordx4 v0, s[8:11], s29 offen lds
p_nl:
    s_waitcnt vmcnt(0)
    s_barrier
    v_min_u32 v2, 0, v1
    v_lshlrev_b32 v2, 2, v2
    s_mov_b32 s30, 0
p_dl:
    global_load_dword v5, v2, s[94:95] offset:136 sc1
    s_waitcnt vmcnt(0)
    v_cmp_eq_u32 vcc, 1, v5
    s_add_u32 s30, s30, 1
    s_nop 3
    s_cmp_eq_u64 vcc, -1
    s_cbranch_scc1 p_dl_d
    s_cmp_lt_u32 s30, 20000
    s_cbranch_scc0 p_dl_d
    s_sleep 4
    s_branch p_dl
p_dl_d:
    s_add_u32 s30, s36, 0
    s_add_u32 s31, s30, 4096
    buffer_load_dwordx4 v[64:67], v0, s[60:63], s30 offen offset:0
    buffer_load_dwordx4 v[68:71], v0, s[60:63], s30 offen offset:1024
    buffer_load_dwordx4 v[72:75], v0, s[60:63], s30 offen offset:2048
    buffer_load_dwordx4 v[76:79], v0, s[60:63], s30 offen offset:3072
    buffer_load_dwordx4 v[80:83], v0, s[60:63], s31 offen
    s_add_u32 s30, s36, 20480
    s_add_u32 s31, s30, 4096
    buffer_load_dwordx4 v[84:87], v0, s[60:63], s30 offen offset:0
    buffer_load_dwordx4 v[88:91], v0, s[60:63], s30 offen offset:1024
    buffer_load_dwordx4 v[92:95], v0, s[60:63], s30 offen offset:2048
    buffer_load_dwordx4 v[96:99], v0, s[60:63], s30 offen offset:3072
    buffer_load_dwordx4 v[100:103], v0, s[60:63], s31 offen
    s_add_u32 s30, s36, 40960
    s_add_u32 s31, s30, 4096
    buffer_load_dwordx4 v[104:107], v0, s[60:63], s30 offen offset:0
    buffer_load_dwordx4 v[108:111], v0, s[60:63], s30 offen offset:1024
    buffer_load_dwordx4 v[112:115], v0, s[60:63], s30 offen offset:2048
    buffer_load_dwordx4 v[116:119], v0, s[60:63], s30 offen offset:3072
    buffer_load_dwordx4 v[120:123], v0, s[60:63], s31 offen
    s_waitcnt vmcnt(0)
    s_mul_i32 s30, s21, 10240
    s_mul_i32 s31, s22, 5120
    s_add_u32 s30, s30, s31
    s_mov_b32 m0, s30
    s_nop 0
    buffer_load_dwordx4 v0, s[60:63], s37 offen offset:0 lds
    buffer_load_dwordx4 v0, s[60:63], s37 offen offset:1024 lds
    buffer_load_dwordx4 v0, s[60:63], s37 offen offset:2048 lds
    buffer_load_dwordx4 v0, s[60:63], s37 offen offset:3072 lds
    s_add_u32 m0, s30, 4096
    s_add_u32 s31, s37, 4096
    buffer_load_dwordx4 v0, s[60:63], s31 offen lds
    s_waitcnt vmcnt(0)
    s_mov_b32 s30, 0
    s_barrier
    s_setprio 3
gated_mix__ssm_conv_s4__grouped_kv_mqa__prompt_kernel_pl:
    buffer_load_dwordx4 v[16:19], v0, s[16:19], s34 offen offset:0 sc1
    buffer_load_dwordx4 v[36:39], v0, s[16:19], s35 offen offset:0 sc1
    buffer_load_dwordx4 v[20:23], v0, s[16:19], s34 offen offset:1024 sc1
    buffer_load_dwordx4 v[40:43], v0, s[16:19], s35 offen offset:1024 sc1
    buffer_load_dwordx4 v[24:27], v0, s[16:19], s34 offen offset:2048 sc1
    buffer_load_dwordx4 v[44:47], v0, s[16:19], s35 offen offset:2048 sc1
    buffer_load_dwordx4 v[28:31], v0, s[16:19], s34 offen offset:3072 sc1
    buffer_load_dwordx4 v[48:51], v0, s[16:19], s35 offen offset:3072 sc1
    buffer_load_dwordx4 v[32:35], v0, s[16:19], s38 offen sc1
    buffer_load_dwordx4 v[52:55], v0, s[16:19], s39 offen sc1
    s_waitcnt vmcnt(9)
    v_mfma_f32_16x16x32_bf16 v[4:7], v[64:67], v[16:19], 0
    v_max3_u32 v13, v16, v17, v18
    v_max_u32 v13, v13, v19
    s_waitcnt vmcnt(8)
    v_mfma_f32_16x16x32_bf16 v[8:11], v[64:67], v[36:39], 0
    v_max3_u32 v13, v13, v36, v37
    v_max3_u32 v13, v13, v38, v39
    s_waitcnt vmcnt(7)
    v_mfma_f32_16x16x32_bf16 v[4:7], v[68:71], v[20:23], v[4:7]
    v_max3_u32 v13, v13, v20, v21
    v_max3_u32 v13, v13, v22, v23
    s_waitcnt vmcnt(6)
    v_mfma_f32_16x16x32_bf16 v[8:11], v[68:71], v[40:43], v[8:11]
    v_max3_u32 v13, v13, v40, v41
    v_max3_u32 v13, v13, v42, v43
    s_waitcnt vmcnt(5)
    v_mfma_f32_16x16x32_bf16 v[4:7], v[72:75], v[24:27], v[4:7]
    v_max3_u32 v13, v13, v24, v25
    v_max3_u32 v13, v13, v26, v27
    s_waitcnt vmcnt(4)
    v_mfma_f32_16x16x32_bf16 v[8:11], v[72:75], v[44:47], v[8:11]
    v_max3_u32 v13, v13, v44, v45
    v_max3_u32 v13, v13, v46, v47
    s_waitcnt vmcnt(3)
    v_mfma_f32_16x16x32_bf16 v[4:7], v[76:79], v[28:31], v[4:7]
    v_max3_u32 v13, v13, v28, v29
    v_max3_u32 v13, v13, v30, v31
    s_waitcnt vmcnt(2)
    v_mfma_f32_16x16x32_bf16 v[8:11], v[76:79], v[48:51], v[8:11]
    v_max3_u32 v13, v13, v48, v49
    v_max3_u32 v13, v13, v50, v51
    s_waitcnt vmcnt(1)
    v_mfma_f32_16x16x32_bf16 v[4:7], v[80:83], v[32:35], v[4:7]
    v_max3_u32 v13, v13, v32, v33
    v_max3_u32 v13, v13, v34, v35
    s_waitcnt vmcnt(0)
    v_mfma_f32_16x16x32_bf16 v[8:11], v[80:83], v[52:55], v[8:11]
    v_max3_u32 v13, v13, v52, v53
    v_max3_u32 v13, v13, v54, v55
    v_cmp_eq_u32 vcc, -1, v13
    s_add_u32 s30, s30, 1
    s_nop 3
    s_cmp_eq_u64 vcc, 0
    s_cbranch_scc1 gated_mix__ssm_conv_s4__grouped_kv_mqa__prompt_kernel_pl_d
    s_cmp_lt_u32 s30, 20000
    s_cbranch_scc1 gated_mix__ssm_conv_s4__grouped_kv_mqa__prompt_kernel_pl
gated_mix__ssm_conv_s4__grouped_kv_mqa__prompt_kernel_pl_d:
    ds_read_b128 v[64:67], v12 offset:0
    ds_read_b128 v[68:71], v12 offset:1024
    ds_read_b128 v[72:75], v12 offset:2048
    ds_read_b128 v[76:79], v12 offset:3072
    ds_read_b128 v[80:83], v12 offset:4096
    v_mfma_f32_16x16x32_bf16 v[56:59], v[84:87], v[16:19], 0
    v_mfma_f32_16x16x32_bf16 v[60:63], v[84:87], v[36:39], 0
    v_mfma_f32_16x16x32_bf16 v[56:59], v[88:91], v[20:23], v[56:59]
    v_mfma_f32_16x16x32_bf16 v[60:63], v[88:91], v[40:43], v[60:63]
    v_mfma_f32_16x16x32_bf16 v[56:59], v[92:95], v[24:27], v[56:59]
    v_mfma_f32_16x16x32_bf16 v[60:63], v[92:95], v[44:47], v[60:63]
    v_mfma_f32_16x16x32_bf16 v[56:59], v[96:99], v[28:31], v[56:59]
    v_mfma_f32_16x16x32_bf16 v[60:63], v[96:99], v[48:51], v[60:63]
    v_mfma_f32_16x16x32_bf16 v[56:59], v[100:103], v[32:35], v[56:59]
    v_mfma_f32_16x16x32_bf16 v[60:63], v[100:103], v[52:55], v[60:63]
    ds_write_b128 v3, v[4:7] offset:0
    ds_write_b128 v3, v[8:11] offset:20480
    ds_read_b128 v[84:87], v12 offset:5120
    ds_read_b128 v[88:91], v12 offset:6144
    ds_read_b128 v[92:95], v12 offset:7168
    ds_read_b128 v[96:99], v12 offset:8192
    ds_read_b128 v[100:103], v12 offset:9216
    v_mfma_f32_16x16x32_bf16 v[4:7], v[104:107], v[16:19], 0
    v_mfma_f32_16x16x32_bf16 v[8:11], v[104:107], v[36:39], 0
    v_mfma_f32_16x16x32_bf16 v[4:7], v[108:111], v[20:23], v[4:7]
    v_mfma_f32_16x16x32_bf16 v[8:11], v[108:111], v[40:43], v[8:11]
    v_mfma_f32_16x16x32_bf16 v[4:7], v[112:115], v[24:27], v[4:7]
    v_mfma_f32_16x16x32_bf16 v[8:11], v[112:115], v[44:47], v[8:11]
    v_mfma_f32_16x16x32_bf16 v[4:7], v[116:119], v[28:31], v[4:7]
    v_mfma_f32_16x16x32_bf16 v[8:11], v[116:119], v[48:51], v[8:11]
    v_mfma_f32_16x16x32_bf16 v[4:7], v[120:123], v[32:35], v[4:7]
    v_mfma_f32_16x16x32_bf16 v[8:11], v[120:123], v[52:55], v[8:11]
    ds_write_b128 v3, v[56:59] offset:4096
    ds_write_b128 v3, v[60:63] offset:24576
    s_waitcnt lgkmcnt(9)
    v_mfma_f32_16x16x32_bf16 v[56:59], v[64:67], v[16:19], 0
    v_mfma_f32_16x16x32_bf16 v[60:63], v[64:67], v[36:39], 0
    v_mfma_f32_16x16x32_bf16 v[56:59], v[68:71], v[20:23], v[56:59]
    v_mfma_f32_16x16x32_bf16 v[60:63], v[68:71], v[40:43], v[60:63]
    v_mfma_f32_16x16x32_bf16 v[56:59], v[72:75], v[24:27], v[56:59]
    v_mfma_f32_16x16x32_bf16 v[60:63], v[72:75], v[44:47], v[60:63]
    v_mfma_f32_16x16x32_bf16 v[56:59], v[76:79], v[28:31], v[56:59]
    v_mfma_f32_16x16x32_bf16 v[60:63], v[76:79], v[48:51], v[60:63]
    v_mfma_f32_16x16x32_bf16 v[56:59], v[80:83], v[32:35], v[56:59]
    v_mfma_f32_16x16x32_bf16 v[60:63], v[80:83], v[52:55], v[60:63]
    ds_write_b128 v3, v[4:7] offset:8192
    ds_write_b128 v3, v[8:11] offset:28672
    s_waitcnt lgkmcnt(4)
    v_mfma_f32_16x16x32_bf16 v[4:7], v[84:87], v[16:19], 0
    v_mfma_f32_16x16x32_bf16 v[8:11], v[84:87], v[36:39], 0
    v_mfma_f32_16x16x32_bf16 v[4:7], v[88:91], v[20:23], v[4:7]
    v_mfma_f32_16x16x32_bf16 v[8:11], v[88:91], v[40:43], v[8:11]
    v_mfma_f32_16x16x32_bf16 v[4:7], v[92:95], v[24:27], v[4:7]
    v_mfma_f32_16x16x32_bf16 v[8:11], v[92:95], v[44:47], v[8:11]
    v_mfma_f32_16x16x32_bf16 v[4:7], v[96:99], v[28:31], v[4:7]
    v_mfma_f32_16x16x32_bf16 v[8:11], v[96:99], v[48:51], v[8:11]
    v_mfma_f32_16x16x32_bf16 v[4:7], v[100:103], v[32:35], v[4:7]
    v_mfma_f32_16x16x32_bf16 v[8:11], v[100:103], v[52:55], v[8:11]
    ds_write_b128 v3, v[56:59] offset:12288
    ds_write_b128 v3, v[60:63] offset:32768
    s_nop 7
    ds_write_b128 v3, v[4:7] offset:16384
    ds_write_b128 v3, v[8:11] offset:36864
    s_waitcnt lgkmcnt(0)
    s_barrier
    s_branch gated_mix__ssm_conv_s4__grouped_kv_mqa__prompt_kernel_end
gated_mix__ssm_conv_s4__grouped_kv_mqa__prompt_kernel_end:
    s_endpgm

.section .rodata,"a"
.p2align 6
.amdhsa_kernel gated_mix__ssm_conv_s4__grouped_kv_mqa__prompt_kernel
  .amdhsa_next_free_vgpr 128
  .amdhsa_next_free_sgpr 102
  .amdhsa_accum_offset 128
  .amdhsa_group_segment_fixed_size 0
  .amdhsa_kernarg_size 144
  .amdhsa_user_sgpr_count 2
  .amdhsa_user_sgpr_kernarg_segment_ptr 1
  .amdhsa_system_sgpr_workgroup_id_x 1
.end_amdhsa_kernel
```
